```python
import torch

def _softmax(x, axis=-1):
    return torch.softmax(x, dim=axis)

def _gelu(x):
    return torch.nn.functional.gelu(x, approximate='tanh')

def _silu(x):
    return torch.nn.functional.silu(x)

def _sigmoid(x):
    return torch.sigmoid(x)

def _layernorm(x, axis=-1, eps=1e-05):
    m = x.mean(dim=axis, keepdim=True)
    v = x.var(dim=axis, keepdim=True, unbiased=False)
    return (x - m) / torch.sqrt(v + eps)

def _scatter_add(tgt, idx, src, axis=0):
    return tgt.clone().index_add_(axis, idx, src)

def _segment_sum(src, seg, n):
    out = torch.zeros((n,) + src.shape[1:], dtype=src.dtype)
    return out.index_add_(0, seg, src)

def _pad(x, pw):
    flat = tuple((v for pair in reversed(pw) for v in pair))
    return torch.nn.functional.pad(x, flat)
kernel_name = 'gated_mix__memory_aug_recurrent_mem_tr__geglu_ffn__prompt'

def setup_inputs():

    _w = lambda a: (lambda t: t.to(torch.bfloat16) if t.is_floating_point() else t)(torch.as_tensor(a))

    def _A_setup():
        B, S, Dm = (1, 2048, 512)
        H, Dh = (32, 128)
        M, seg = (8, 32)
        seg = min(seg, S)
        S = S // seg * seg
        return {'x': _w((lambda *s: torch.randn(*s, dtype=torch.bfloat16) * 0.05)(B, S, Dm)), 'mem0': _w((lambda *s: torch.randn(*s, dtype=torch.bfloat16) * 0.4)(B, M, Dm)), 'Wq': _w((lambda *s: torch.randn(*s, dtype=torch.bfloat16) * 6.4)(Dm, H, Dh) * Dm ** (-0.5)), 'Wk': _w((lambda *s: torch.randn(*s, dtype=torch.bfloat16) * 6.4)(Dm, H, Dh) * Dm ** (-0.5)), 'Wv': _w((lambda *s: torch.randn(*s, dtype=torch.bfloat16) * 0.4)(Dm, H, Dh) * Dm ** (-0.5)), 'Wo': _w((lambda *s: torch.randn(*s, dtype=torch.bfloat16) * 0.4)(H, Dh, Dm) * (H * Dh) ** (-0.5)), 'seg_len': seg}
    _A_in = _A_setup()

    def _B_setup():
        B, S, D, F = (1, 2048, 512, 1792)
        return {'x': _w((lambda *s: torch.randn(*s, dtype=torch.bfloat16) * 0.05)(B, S, D)), 'w_gate': _w((lambda *s: torch.randn(*s, dtype=torch.bfloat16) * 0.05)(D, F)), 'w_up': _w((lambda *s: torch.randn(*s, dtype=torch.bfloat16) * 0.05)(D, F)), 'w_down': _w((lambda *s: torch.randn(*s, dtype=torch.bfloat16) * 0.05)(F, D))}
    _B_in = _B_setup()
    return {'A_x': _A_in['x'], 'A_mem0': _A_in['mem0'], 'A_Wq': _A_in['Wq'], 'A_Wk': _A_in['Wk'], 'A_Wv': _A_in['Wv'], 'A_Wo': _A_in['Wo'], 'A_seg_len': _A_in['seg_len'], 'B_x': _B_in['x'], 'B_w_gate': _B_in['w_gate'], 'B_w_up': _B_in['w_up'], 'B_w_down': _B_in['w_down'], 'gate_w': _w((lambda *s: torch.randn(*s, dtype=torch.bfloat16) * 0.05)(512) * 16.0)}

def reference(A_x, A_mem0, A_Wq, A_Wk, A_Wv, A_Wo, A_seg_len, B_x, B_w_gate, B_w_up, B_w_down, gate_w):

    def _A_ref(x, mem0, Wq, Wk, Wv, Wo, seg_len):
        B, S, Dm = x.shape
        H, Dh = (Wq.shape[1], Wq.shape[2])
        M = mem0.shape[1]
        scale = Dh ** (-0.5)
        n_seg = S // seg_len
        L = M + seg_len
        idx = torch.arange(L)
        mask = (idx[:, None] < M) | (idx[:, None] >= idx[None, :])
        mem = mem0
        outs = []
        for s in range(n_seg):
            xs = x[:, s * seg_len:(s + 1) * seg_len, :].clone()
            h = torch.concatenate([mem, xs], axis=1)
            q = torch.einsum('btd,dhe->bhte', h, Wq)
            k = torch.einsum('btd,dhe->bhte', h, Wk)
            v = torch.einsum('btd,dhe->bhte', h, Wv)
            scores = torch.einsum('bhqe,bhke->bhqk', q, k) * scale
            scores = torch.where(mask[None, None], scores, -1000000000.0)
            p = _softmax(scores, axis=-1)
            o = torch.einsum('bhqk,bhke->bhqe', p, v)
            o = torch.einsum('bhte,hed->btd', o, Wo)
            mem = o[:, :M, :].clone()
            outs.append(o[:, M:, :])
        return torch.concatenate(outs, axis=1)

    def _B_ref(x, w_gate, w_up, w_down):
        return _gelu(x @ w_gate) * (x @ w_up) @ w_down
    x = A_x
    g = _sigmoid((x * gate_w).sum(-1, keepdims=True))
    a = _A_ref(x, A_mem0, A_Wq, A_Wk, A_Wv, A_Wo, A_seg_len)
    b = _B_ref(x, B_w_gate, B_w_up, B_w_down)
    return g * a + (1 - g) * b
```

```asm
; @launch grid=(256,1,1) block=(256,1,1) lds=163840
.amdgcn_target "amdgcn-amd-amdhsa--gfx950"
.text
.globl gated_mix__memory_aug_recurrent_mem_tr__geglu_ffn__prompt_kernel
.p2align 8
.type gated_mix__memory_aug_recurrent_mem_tr__geglu_ffn__prompt_kernel,@function
gated_mix__memory_aug_recurrent_mem_tr__geglu_ffn__prompt_kernel:
L_entry:
  s_cmp_ge_u32 s2, 256
  s_cbranch_scc1 L_exit
  s_load_dwordx16 s[40:55], s[0:1], 0
  s_load_dwordx8 s[56:63], s[0:1], 64
  s_load_dwordx4 s[64:67], s[0:1], 96
  s_load_dwordx2 s[68:69], s[0:1], 112
  v_lshrrev_b32 v1, 6, v0
  s_nop 0
  v_readfirstlane_b32 s21, v1
  s_mov_b32 s23, 0
  s_waitcnt lgkmcnt(0)
  s_mov_b32 s4, s68
  s_mov_b32 s5, s69
  s_mov_b32 s6, 0x10000000
  s_mov_b32 s7, 0x20000
  s_and_b32 s24, s2, 7
  s_cmp_lg_u32 s24, 0
  s_cbranch_scc1 L_follower
L_recur:
  s_lshr_b32 s20, s2, 3
  v_and_b32 v100, 63, v0
  v_and_b32 v101, 15, v100
  v_lshrrev_b32_e64 v102, 4, v100
  v_bfe_u32 v107, v100, 2, 2
  v_and_b32 v108, 3, v100
  s_lshl_b32 s71, s21, 10
  s_lshl_b32 s24, s21, 1
  v_and_b32 v109, 1, v102
  v_or_b32 v109, s24, v109
  v_lshlrev_b32 v109, 1, v109
  v_xor_b32 v103, v101, v109
  s_lshl_b32 s24, s21, 2
  v_add_u32 v104, s24, v102
  v_lshlrev_b32 v105, 4, v103
  v_lshl_add_u32 v116, v104, 13, v105
  v_lshl_add_u32 v117, v104, 10, v105
  v_lshrrev_b32 v103, 1, v102
  v_lshlrev_b32 v103, 4, v103
  v_lshrrev_b32_e64 v104, 1, v107
  v_lshl_add_u32 v103, v104, 3, v103
  v_and_b32_e64 v105, 1, v102
  v_lshl_add_u32 v103, v105, 2, v103
  v_and_b32 v109, 1, v107
  v_add_u32 v103, v103, v109
  v_lshl_add_u32 v109, v105, 1, v109
  v_lshl_add_u32 v109, v104, 2, v109
  v_lshlrev_b32 v109, 1, v109
  v_lshrrev_b32 v104, 1, v108
  v_add_u32 v104, s24, v104
  v_xor_b32 v104, v104, v109
  v_lshlrev_b32_e64 v104, 4, v104
  v_lshl_add_u32 v103, v103, 8, v104
  v_and_b32_e64 v104, 1, v108
  v_lshl_add_u32 v118, v104, 3, v103
  v_xor_b32 v119, 32, v118
  s_lshl_b32 s86, s20, 8
  s_lshl_b32 s87, s20, 17
  s_mov_b32 s8, s50
  s_mov_b32 s9, s51
  s_mov_b32 s10, 0x400000
  s_mov_b32 s11, 0x20000
  s_add_u32 m0, s71, 32768
  s_add_u32 s24, s87, 0
  buffer_load_dwordx4 v117, s[8:11], s24 offen lds
  s_add_u32 m0, s71, 36864
  s_add_u32 s24, s87, 16384
  buffer_load_dwordx4 v117, s[8:11], s24 offen lds
  s_add_u32 m0, s71, 40960
  s_add_u32 s24, s87, 32768
  buffer_load_dwordx4 v117, s[8:11], s24 offen lds
  s_add_u32 m0, s71, 45056
  s_add_u32 s24, s87, 49152
  buffer_load_dwordx4 v117, s[8:11], s24 offen lds
  s_add_u32 m0, s71, 49152
  s_add_u32 s24, s87, 65536
  buffer_load_dwordx4 v117, s[8:11], s24 offen lds
  s_add_u32 m0, s71, 53248
  s_add_u32 s24, s87, 81920
  buffer_load_dwordx4 v117, s[8:11], s24 offen lds
  s_add_u32 m0, s71, 57344
  s_add_u32 s24, s87, 98304
  buffer_load_dwordx4 v117, s[8:11], s24 offen lds
  s_add_u32 m0, s71, 61440
  s_add_u32 s24, s87, 114688
  buffer_load_dwordx4 v117, s[8:11], s24 offen lds
  s_add_u32 m0, s71, 65536
  s_add_u32 s24, s87, 256
  buffer_load_dwordx4 v117, s[8:11], s24 offen lds
  s_add_u32 m0, s71, 69632
  s_add_u32 s24, s87, 16640
  buffer_load_dwordx4 v117, s[8:11], s24 offen lds
  s_add_u32 m0, s71, 73728
  s_add_u32 s24, s87, 33024
  buffer_load_dwordx4 v117, s[8:11], s24 offen lds
  s_add_u32 m0, s71, 77824
  s_add_u32 s24, s87, 49408
  buffer_load_dwordx4 v117, s[8:11], s24 offen lds
  s_add_u32 m0, s71, 81920
  s_add_u32 s24, s87, 65792
  buffer_load_dwordx4 v117, s[8:11], s24 offen lds
  s_add_u32 m0, s71, 86016
  s_add_u32 s24, s87, 82176
  buffer_load_dwordx4 v117, s[8:11], s24 offen lds
  s_add_u32 m0, s71, 90112
  s_add_u32 s24, s87, 98560
  buffer_load_dwordx4 v117, s[8:11], s24 offen lds
  s_add_u32 m0, s71, 94208
  s_add_u32 s24, s87, 114944
  buffer_load_dwordx4 v117, s[8:11], s24 offen lds
  s_add_u32 m0, s71, 98304
  s_add_u32 s24, s87, 512
  buffer_load_dwordx4 v117, s[8:11], s24 offen lds
  s_add_u32 m0, s71, 102400
  s_add_u32 s24, s87, 16896
  buffer_load_dwordx4 v117, s[8:11], s24 offen lds
  s_add_u32 m0, s71, 106496
  s_add_u32 s24, s87, 33280
  buffer_load_dwordx4 v117, s[8:11], s24 offen lds
  s_add_u32 m0, s71, 110592
  s_add_u32 s24, s87, 49664
  buffer_load_dwordx4 v117, s[8:11], s24 offen lds
  s_add_u32 m0, s71, 114688
  s_add_u32 s24, s87, 66048
  buffer_load_dwordx4 v117, s[8:11], s24 offen lds
  s_add_u32 m0, s71, 118784
  s_add_u32 s24, s87, 82432
  buffer_load_dwordx4 v117, s[8:11], s24 offen lds
  s_add_u32 m0, s71, 122880
  s_add_u32 s24, s87, 98816
  buffer_load_dwordx4 v117, s[8:11], s24 offen lds
  s_add_u32 m0, s71, 126976
  s_add_u32 s24, s87, 115200
  buffer_load_dwordx4 v117, s[8:11], s24 offen lds
  s_mov_b32 s8, s44
  s_mov_b32 s9, s45
  s_mov_b32 s10, 0x400000
  s_mov_b32 s11, 0x20000
  s_add_u32 m0, s71, 131072
  s_add_u32 s24, s86, 1048576
  buffer_load_dwordx4 v116, s[8:11], s24 offen lds
  s_add_u32 m0, s71, 135168
  s_add_u32 s24, s86, 1179648
  buffer_load_dwordx4 v116, s[8:11], s24 offen lds
  s_add_u32 m0, s71, 139264
  s_add_u32 s24, s86, 1310720
  buffer_load_dwordx4 v116, s[8:11], s24 offen lds
  s_add_u32 m0, s71, 143360
  s_add_u32 s24, s86, 1441792
  buffer_load_dwordx4 v116, s[8:11], s24 offen lds
  v_lshlrev_b32_e64 v0, 4, v100
  v_add_u32 v15, s71, v0
  s_lshl_b32 s24, s21, 12
  s_add_u32 s24, s24, 32768
  v_add_u32_e64 v1, s24, v0
  v_add_u32 v2, 0x10000, v1
  v_lshrrev_b32_e64 v103, 5, v100
  v_bfe_u32 v104, v100, 1, 1
  v_lshl_add_u32 v103, v103, 1, v104
  v_bfe_u32 v104, v100, 2, 3
  v_lshlrev_b32_e64 v104, 5, v104
  v_lshl_add_u32 v103, v103, 8, v104
  v_and_b32_e64 v104, 1, v100
  v_lshl_add_u32 v103, v104, 4, v103
  s_lshl_b32 s24, s21, 11
  v_add_u32 v3, s24, v103
  v_mul_u32_u24 v103, 576, v102
  v_lshl_add_u32 v103, v101, 3, v103
  s_and_b32 s24, s21, 1
  s_lshl_b32 s83, s24, 7
  s_lshr_b32 s25, s21, 1
  s_lshl_b32 s25, s25, 2
  s_add_u32 s24, s83, s25
  v_add_u32 v4, s24, v103
  s_mul_i32 s25, s21, 2304
  s_add_u32 s25, s25, 12800
  v_add_u32_e64 v6, s25, v103
  v_mul_u32_u24 v103, 576, v108
  v_and_b32_e64 v105, 1, v102
  v_lshl_add_u32 v105, v105, 2, v107
  v_lshl_add_u32 v103, v105, 3, v103
  v_lshrrev_b32_e64 v104, 1, v102
  v_lshl_add_u32 v5, v104, 8, v103
  v_lshl_add_u32 v103, v104, 7, v103
  v_add_u32 v7, s25, v103
  v_lshlrev_b32 v103, 6, v107
  v_lshl_add_u32 v103, v104, 5, v103
  v_and_b32_e64 v104, 1, v108
  v_lshl_add_u32 v103, v104, 4, v103
  v_and_b32_e64 v105, 1, v102
  v_lshl_add_u32 v103, v105, 3, v103
  s_lshl_b32 s24, s21, 9
  v_add_u32 v103, s24, v103
  v_xor_b32_e64 v105, 8, v103
  v_add_u32 v105, 28160, v105
  v_add_u32 v103, 26112, v103
  v_cmp_gt_u32 vcc, 2, v108
  s_nop 0
  s_nop 0
  v_cndmask_b32 v8, v105, v103, vcc
  v_mov_b32 v103, 0x4444
  v_mov_b32 v105, 0xeeee
  v_cndmask_b32 v14, v105, v103, vcc
  v_lshl_add_u32 v103, v107, 1, v104
  v_lshlrev_b32 v103, 4, v103
  v_lshl_add_u32 v103, v102, 7, v103
  v_add_u32 v103, s24, v103
  v_mov_b32 v106, 0x40000000
  v_lshrrev_b32 v104, 1, v108
  s_lshr_b32 s25, s21, 1
  v_cmp_eq_u32 vcc, s25, v104
  s_nop 1
  v_cndmask_b32 v13, v106, v103, vcc
  v_lshrrev_b32 v103, 3, v101
  v_lshl_add_u32 v103, v102, 1, v103
  s_lshl_b32 s24, s21, 3
  v_add_u32 v103, s24, v103
  v_and_b32 v104, 7, v101
  v_lshlrev_b32 v104, 3, v104
  v_mul_u32_u24 v103, 8192, v103
  v_add_u32 v9, v103, v104
  v_lshlrev_b32 v103, 4, v102
  v_lshl_add_u32 v103, v101, 2, v103
  v_cmp_gt_u32 vcc, 4, v101
  s_nop 1
  v_cndmask_b32 v10, v106, v103, vcc
  s_lshl_b32 s24, s21, 12
  v_lshlrev_b32 v103, 9, v102
  v_add_u32 v103, s24, v103
  v_lshl_add_u32 v12, v101, 4, v103
  v_lshrrev_b32 v103, 2, v101
  v_and_b32 v104, 1, v101
  v_lshl_add_u32 v103, v104, 2, v103
  v_and_b32 v104, 1, v103
  v_lshrrev_b32 v103, 1, v103
  v_lshlrev_b32_e64 v104, 4, v104
  v_mov_b32 v105, 0x3f80
  v_lshlrev_b32 v105, v104, v105
  v_and_b32 v104, 2, v101
  v_cmp_eq_u32 vcc, 0, v104
  s_nop 1
  v_cndmask_b32 v105, 0, v105, vcc
  v_cmp_eq_u32 vcc, 0, v103
  s_nop 1
  v_cndmask_b32 v112, 0, v105, vcc
  v_cmp_eq_u32 vcc, 1, v103
  s_nop 1
  v_cndmask_b32 v113, 0, v105, vcc
  v_cmp_eq_u32 vcc, 2, v103
  s_nop 1
  v_cndmask_b32 v114, 0, v105, vcc
  v_cmp_eq_u32_e64 vcc, 3, v103
  s_nop 1
  v_cndmask_b32 v115, 0, v105, vcc
  ds_write_b128 v0, v[112:115] offset:30208
  v_mov_b64 v[120:121], 0
  v_mov_b64 v[122:123], 0
  ds_write_b128 v15, v[120:123] offset:12800
  ds_write_b128 v15, v[120:123] offset:16896
  ds_write_b128 v15, v[120:123] offset:20992
  s_waitcnt lgkmcnt(0)
  v_mov_b64 v[120:121], -1
  v_mov_b64 v[122:123], -1
  s_mul_i32 s73, s20, 64
  s_mul_i32 s24, s21, 2048
  s_add_u32 s75, s73, s24
  s_add_u32 s75, s75, 0x9080000
  s_add_u32 s76, s75, 0x4000
  s_add_u32 s73, s73, 0x9600000
  s_mul_i32 s78, s20, 8192
  s_add_u32 s78, s78, s24
  s_add_u32 s78, s78, 0x9600000
  s_add_u32 s25, s78, 0x80000
  buffer_store_dwordx4 v[120:123], v0, s[4:7], s78 offen offset:0 sc1
  buffer_store_dwordx4 v[120:123], v0, s[4:7], s78 offen offset:1024 sc1
  buffer_store_dwordx4 v[120:123], v0, s[4:7], s25 offen offset:0 sc1
  buffer_store_dwordx4 v[120:123], v0, s[4:7], s25 offen offset:1024 sc1
  buffer_store_dword v120, v10, s[4:7], s75 offen sc1
  buffer_store_dword v120, v10, s[4:7], s76 offen sc1
  s_lshl_b32 s81, s21, 8
  s_add_u32 s81, s81, 0x9090000
  s_lshl_b32 s77, s20, 2
  s_add_u32 s77, s77, s81
  s_mov_b32 s74, 1
  s_mov_b32 s75, 1
  v_mov_b32 v126, 0
  v_lshrrev_b32_e64 v127, 2, v0
  s_mov_b64 exec, s[74:75]
  buffer_store_dword v126, v127, s[4:7], s77 offen sc1
  s_mov_b64 exec, -1
  s_mov_b32 s16, s66
  s_mov_b32 s17, s67
  s_mov_b32 s18, 0x100
  s_mov_b32 s19, 0x20000
  s_getreg_b32 s24, hwreg(HW_REG_XCC_ID, 0, 4)
  s_lshl_b32 s24, 1, s24
  v_mov_b32_e64 v124, s24
  s_cmp_lg_u32 s21, 0
  s_cbranch_scc1 L_noxcc
  s_mov_b64 exec, 1
  buffer_atomic_or v124, off, s[16:19], 0 offset:128
  s_mov_b64 exec, -1
L_noxcc:
  s_mov_b32 s12, s42
  s_mov_b32 s13, s43
  s_mov_b32 s14, 0x2000
  s_mov_b32 s15, 0x20000
  v_lshrrev_b32_e64 v100, 4, v15
  v_bfe_u32 v101, v100, 2, 2
  v_and_b32_e64 v102, 1, v100
  v_lshl_add_u32 v101, v101, 1, v102
  v_bfe_u32 v102, v100, 1, 1
  v_lshrrev_b32_e64 v100, 4, v100
  v_lshl_add_u32 v100, v100, 1, v102
  v_lshlrev_b32_e64 v100, 4, v100
  v_lshl_add_u32 v100, v101, 10, v100
  buffer_load_dwordx4 v[16:19], v100, s[12:15], 0 offen offset:0
  buffer_load_dwordx4 v[20:23], v100, s[12:15], 0 offen offset:512
  s_waitcnt vmcnt(33)
  s_barrier
  s_add_u32 m0, s71, 147456
  s_add_u32 s24, s86, 1572864
  buffer_load_dwordx4 v116, s[8:11], s24 offen lds
  s_add_u32 m0, s71, 151552
  s_add_u32 s24, s86, 1703936
  buffer_load_dwordx4 v116, s[8:11], s24 offen lds
  s_add_u32 m0, s71, 155648
  s_add_u32 s24, s86, 1835008
  buffer_load_dwordx4 v116, s[8:11], s24 offen lds
  s_add_u32 m0, s71, 159744
  s_add_u32 s24, s86, 1966080
  buffer_load_dwordx4 v116, s[8:11], s24 offen lds
  v_add_u32 v114, 32768, v118
  v_add_u32 v115, 32768, v119
  ds_read_b64_tr_b16 a[0:1], v114 offset:0
  ds_read_b64_tr_b16 a[2:3], v114 offset:512
  ds_read_b64_tr_b16 a[4:5], v114 offset:8192
  ds_read_b64_tr_b16 a[6:7], v114 offset:8704
  ds_read_b64_tr_b16 a[8:9], v115 offset:0
  ds_read_b64_tr_b16 a[10:11], v115 offset:512
  ds_read_b64_tr_b16 a[12:13], v115 offset:8192
  ds_read_b64_tr_b16 a[14:15], v115 offset:8704
  s_waitcnt lgkmcnt(0)
  s_waitcnt vmcnt(33)
  s_barrier
  s_add_u32 m0, s71, 32768
  s_add_u32 s24, s86, 2097152
  buffer_load_dwordx4 v116, s[8:11], s24 offen lds
  s_add_u32 m0, s71, 36864
  s_add_u32 s24, s86, 2228224
  buffer_load_dwordx4 v116, s[8:11], s24 offen lds
  s_add_u32 m0, s71, 40960
  s_add_u32 s24, s86, 2359296
  buffer_load_dwordx4 v116, s[8:11], s24 offen lds
  s_add_u32 m0, s71, 45056
  s_add_u32 s24, s86, 2490368
  buffer_load_dwordx4 v116, s[8:11], s24 offen lds
  v_add_u32 v114, 49152, v118
  v_add_u32 v115, 49152, v119
  ds_read_b64_tr_b16 a[16:17], v114 offset:0
  ds_read_b64_tr_b16 a[18:19], v114 offset:512
  ds_read_b64_tr_b16 a[20:21], v114 offset:8192
  ds_read_b64_tr_b16 a[22:23], v114 offset:8704
  ds_read_b64_tr_b16 a[24:25], v115 offset:0
  ds_read_b64_tr_b16 a[26:27], v115 offset:512
  ds_read_b64_tr_b16 a[28:29], v115 offset:8192
  ds_read_b64_tr_b16 a[30:31], v115 offset:8704
  s_waitcnt lgkmcnt(0)
  s_waitcnt vmcnt(33)
  s_barrier
  s_add_u32 m0, s71, 49152
  s_add_u32 s24, s86, 2621440
  buffer_load_dwordx4 v116, s[8:11], s24 offen lds
  s_add_u32 m0, s71, 53248
  s_add_u32 s24, s86, 2752512
  buffer_load_dwordx4 v116, s[8:11], s24 offen lds
  s_add_u32 m0, s71, 57344
  s_add_u32 s24, s86, 2883584
  buffer_load_dwordx4 v116, s[8:11], s24 offen lds
  s_add_u32 m0, s71, 61440
  s_add_u32 s24, s86, 3014656
  buffer_load_dwordx4 v116, s[8:11], s24 offen lds
  v_add_u32 v114, 65536, v118
  v_add_u32 v115, 65536, v119
  ds_read_b64_tr_b16 a[32:33], v114 offset:0
  ds_read_b64_tr_b16 a[34:35], v114 offset:512
  ds_read_b64_tr_b16 a[36:37], v114 offset:8192
  ds_read_b64_tr_b16 a[38:39], v114 offset:8704
  ds_read_b64_tr_b16 a[40:41], v115 offset:0
  ds_read_b64_tr_b16 a[42:43], v115 offset:512
  ds_read_b64_tr_b16 a[44:45], v115 offset:8192
  ds_read_b64_tr_b16 a[46:47], v115 offset:8704
  s_waitcnt lgkmcnt(0)
  s_waitcnt vmcnt(33)
  s_barrier
  s_add_u32 m0, s71, 65536
  s_add_u32 s24, s86, 3145728
  buffer_load_dwordx4 v116, s[8:11], s24 offen lds
  s_add_u32 m0, s71, 69632
  s_add_u32 s24, s86, 3276800
  buffer_load_dwordx4 v116, s[8:11], s24 offen lds
  s_add_u32 m0, s71, 73728
  s_add_u32 s24, s86, 3407872
  buffer_load_dwordx4 v116, s[8:11], s24 offen lds
  s_add_u32 m0, s71, 77824
  s_add_u32 s24, s86, 3538944
  buffer_load_dwordx4 v116, s[8:11], s24 offen lds
  v_add_u32 v114, 81920, v118
  v_add_u32 v115, 81920, v119
  ds_read_b64_tr_b16 a[48:49], v114 offset:0
  ds_read_b64_tr_b16 a[50:51], v114 offset:512
  ds_read_b64_tr_b16 a[52:53], v114 offset:8192
  ds_read_b64_tr_b16 a[54:55], v114 offset:8704
  ds_read_b64_tr_b16 a[56:57], v115 offset:0
  ds_read_b64_tr_b16 a[58:59], v115 offset:512
  ds_read_b64_tr_b16 a[60:61], v115 offset:8192
  ds_read_b64_tr_b16 a[62:63], v115 offset:8704
  s_waitcnt lgkmcnt(0)
  s_waitcnt vmcnt(33)
  s_barrier
  s_add_u32 m0, s71, 81920
  s_add_u32 s24, s86, 3670016
  buffer_load_dwordx4 v116, s[8:11], s24 offen lds
  s_add_u32 m0, s71, 86016
  s_add_u32 s24, s86, 3801088
  buffer_load_dwordx4 v116, s[8:11], s24 offen lds
  s_add_u32 m0, s71, 90112
  s_add_u32 s24, s86, 3932160
  buffer_load_dwordx4 v116, s[8:11], s24 offen lds
  s_add_u32 m0, s71, 94208
  s_add_u32 s24, s86, 4063232
  buffer_load_dwordx4 v116, s[8:11], s24 offen lds
  v_add_u32 v114, 98304, v118
  v_add_u32 v115, 98304, v119
  ds_read_b64_tr_b16 a[64:65], v114 offset:0
  ds_read_b64_tr_b16 a[66:67], v114 offset:512
  ds_read_b64_tr_b16 a[68:69], v114 offset:8192
  ds_read_b64_tr_b16 a[70:71], v114 offset:8704
  ds_read_b64_tr_b16 a[72:73], v115 offset:0
  ds_read_b64_tr_b16 a[74:75], v115 offset:512
  ds_read_b64_tr_b16 a[76:77], v115 offset:8192
  ds_read_b64_tr_b16 a[78:79], v115 offset:8704
  s_waitcnt lgkmcnt(0)
  s_waitcnt vmcnt(33)
  s_barrier
  s_mov_b32 s8, s46
  s_mov_b32 s9, s47
  s_mov_b32 s10, 0x400000
  s_mov_b32 s11, 0x20000
  s_add_u32 m0, s71, 98304
  s_add_u32 s24, s86, 0
  buffer_load_dwordx4 v116, s[8:11], s24 offen lds
  s_add_u32 m0, s71, 102400
  s_add_u32 s24, s86, 131072
  buffer_load_dwordx4 v116, s[8:11], s24 offen lds
  s_add_u32 m0, s71, 106496
  s_add_u32 s24, s86, 262144
  buffer_load_dwordx4 v116, s[8:11], s24 offen lds
  s_add_u32 m0, s71, 110592
  s_add_u32 s24, s86, 393216
  buffer_load_dwordx4 v116, s[8:11], s24 offen lds
  v_add_u32 v114, 114688, v118
  v_add_u32 v115, 114688, v119
  ds_read_b64_tr_b16 a[80:81], v114 offset:0
  ds_read_b64_tr_b16 a[82:83], v114 offset:512
  ds_read_b64_tr_b16 a[84:85], v114 offset:8192
  ds_read_b64_tr_b16 a[86:87], v114 offset:8704
  ds_read_b64_tr_b16 a[88:89], v115 offset:0
  ds_read_b64_tr_b16 a[90:91], v115 offset:512
  ds_read_b64_tr_b16 a[92:93], v115 offset:8192
  ds_read_b64_tr_b16 a[94:95], v115 offset:8704
  s_waitcnt lgkmcnt(0)
  s_waitcnt vmcnt(33)
  s_barrier
  s_add_u32 m0, s71, 114688
  s_add_u32 s24, s86, 524288
  buffer_load_dwordx4 v116, s[8:11], s24 offen lds
  s_add_u32 m0, s71, 118784
  s_add_u32 s24, s86, 655360
  buffer_load_dwordx4 v116, s[8:11], s24 offen lds
  s_add_u32 m0, s71, 122880
  s_add_u32 s24, s86, 786432
  buffer_load_dwordx4 v116, s[8:11], s24 offen lds
  s_add_u32 m0, s71, 126976
  s_add_u32 s24, s86, 917504
  buffer_load_dwordx4 v116, s[8:11], s24 offen lds
  v_add_u32 v114, 131072, v118
  v_add_u32 v115, 131072, v119
  ds_read_b64_tr_b16 a[192:193], v114 offset:0
  ds_read_b64_tr_b16 a[194:195], v114 offset:512
  ds_read_b64_tr_b16 a[196:197], v114 offset:8192
  ds_read_b64_tr_b16 a[198:199], v114 offset:8704
  ds_read_b64_tr_b16 a[200:201], v115 offset:0
  ds_read_b64_tr_b16 a[202:203], v115 offset:512
  ds_read_b64_tr_b16 a[204:205], v115 offset:8192
  ds_read_b64_tr_b16 a[206:207], v115 offset:8704
  s_waitcnt lgkmcnt(0)
  s_waitcnt vmcnt(24)
  s_barrier
  s_add_u32 m0, s71, 131072
  s_add_u32 s24, s86, 2097152
  buffer_load_dwordx4 v116, s[8:11], s24 offen lds
  s_add_u32 m0, s71, 135168
  s_add_u32 s24, s86, 2228224
  buffer_load_dwordx4 v116, s[8:11], s24 offen lds
  s_add_u32 m0, s71, 139264
  s_add_u32 s24, s86, 2359296
  buffer_load_dwordx4 v116, s[8:11], s24 offen lds
  s_add_u32 m0, s71, 143360
  s_add_u32 s24, s86, 2490368
  buffer_load_dwordx4 v116, s[8:11], s24 offen lds
  s_mov_b32 s16, s66
  s_mov_b32 s17, s67
  s_mov_b32 s18, 0x100
  s_mov_b32 s19, 0x20000
  s_cmp_lg_u32 s21, 0
  s_cbranch_scc1 L_noarr_1
  v_mov_b32_e64 v125, 1
  s_mov_b64 exec, 1
  buffer_atomic_add v125, off, s[16:19], 0 offset:0
  s_mov_b64 exec, -1
L_noarr_1:
  v_add_u32 v114, 147456, v118
  v_add_u32 v115, 147456, v119
  ds_read_b64_tr_b16 a[208:209], v114 offset:0
  ds_read_b64_tr_b16 a[210:211], v114 offset:512
  ds_read_b64_tr_b16 a[212:213], v114 offset:8192
  ds_read_b64_tr_b16 a[214:215], v114 offset:8704
  ds_read_b64_tr_b16 a[216:217], v115 offset:0
  ds_read_b64_tr_b16 a[218:219], v115 offset:512
  ds_read_b64_tr_b16 a[220:221], v115 offset:8192
  ds_read_b64_tr_b16 a[222:223], v115 offset:8704
  s_waitcnt lgkmcnt(0)
  s_waitcnt vmcnt(24)
  s_barrier
  s_add_u32 m0, s71, 147456
  s_add_u32 s24, s86, 2621440
  buffer_load_dwordx4 v116, s[8:11], s24 offen lds
  s_add_u32 m0, s71, 151552
  s_add_u32 s24, s86, 2752512
  buffer_load_dwordx4 v116, s[8:11], s24 offen lds
  s_add_u32 m0, s71, 155648
  s_add_u32 s24, s86, 2883584
  buffer_load_dwordx4 v116, s[8:11], s24 offen lds
  s_add_u32 m0, s71, 159744
  s_add_u32 s24, s86, 3014656
  buffer_load_dwordx4 v116, s[8:11], s24 offen lds
  v_add_u32 v114, 32768, v118
  v_add_u32 v115, 32768, v119
  ds_read_b64_tr_b16 a[224:225], v114 offset:0
  ds_read_b64_tr_b16 a[226:227], v114 offset:512
  ds_read_b64_tr_b16 a[228:229], v114 offset:8192
  ds_read_b64_tr_b16 a[230:231], v114 offset:8704
  ds_read_b64_tr_b16 a[232:233], v115 offset:0
  ds_read_b64_tr_b16 a[234:235], v115 offset:512
  ds_read_b64_tr_b16 a[236:237], v115 offset:8192
  ds_read_b64_tr_b16 a[238:239], v115 offset:8704
  s_waitcnt lgkmcnt(0)
  s_waitcnt vmcnt(24)
  s_barrier
  s_add_u32 m0, s71, 32768
  s_add_u32 s24, s86, 3145728
  buffer_load_dwordx4 v116, s[8:11], s24 offen lds
  s_add_u32 m0, s71, 36864
  s_add_u32 s24, s86, 3276800
  buffer_load_dwordx4 v116, s[8:11], s24 offen lds
  s_add_u32 m0, s71, 40960
  s_add_u32 s24, s86, 3407872
  buffer_load_dwordx4 v116, s[8:11], s24 offen lds
  s_add_u32 m0, s71, 45056
  s_add_u32 s24, s86, 3538944
  buffer_load_dwordx4 v116, s[8:11], s24 offen lds
  v_add_u32 v114, 49152, v118
  v_add_u32 v115, 49152, v119
  ds_read_b64_tr_b16 a[240:241], v114 offset:0
  ds_read_b64_tr_b16 a[242:243], v114 offset:512
  ds_read_b64_tr_b16 a[244:245], v114 offset:8192
  ds_read_b64_tr_b16 a[246:247], v114 offset:8704
  ds_read_b64_tr_b16 a[248:249], v115 offset:0
  ds_read_b64_tr_b16 a[250:251], v115 offset:512
  ds_read_b64_tr_b16 a[252:253], v115 offset:8192
  ds_read_b64_tr_b16 a[254:255], v115 offset:8704
  s_waitcnt lgkmcnt(0)
  s_waitcnt vmcnt(24)
  s_barrier
  s_add_u32 m0, s71, 49152
  s_add_u32 s24, s86, 3670016
  buffer_load_dwordx4 v116, s[8:11], s24 offen lds
  s_add_u32 m0, s71, 53248
  s_add_u32 s24, s86, 3801088
  buffer_load_dwordx4 v116, s[8:11], s24 offen lds
  s_add_u32 m0, s71, 57344
  s_add_u32 s24, s86, 3932160
  buffer_load_dwordx4 v116, s[8:11], s24 offen lds
  s_add_u32 m0, s71, 61440
  s_add_u32 s24, s86, 4063232
  buffer_load_dwordx4 v116, s[8:11], s24 offen lds
  v_add_u32 v114, 65536, v118
  v_add_u32 v115, 65536, v119
  ds_read_b64_tr_b16 v[128:129], v114 offset:0
  ds_read_b64_tr_b16 v[130:131], v114 offset:512
  ds_read_b64_tr_b16 v[132:133], v114 offset:8192
  ds_read_b64_tr_b16 v[134:135], v114 offset:8704
  ds_read_b64_tr_b16 v[136:137], v115 offset:0
  ds_read_b64_tr_b16 v[138:139], v115 offset:512
  ds_read_b64_tr_b16 v[140:141], v115 offset:8192
  ds_read_b64_tr_b16 v[142:143], v115 offset:8704
  s_waitcnt lgkmcnt(0)
  s_waitcnt vmcnt(24)
  s_barrier
  s_mov_b32 s8, s48
  s_mov_b32 s9, s49
  s_mov_b32 s10, 0x400000
  s_mov_b32 s11, 0x20000
  s_add_u32 m0, s71, 65536
  s_add_u32 s24, s86, 0
  buffer_load_dwordx4 v116, s[8:11], s24 offen lds
  s_add_u32 m0, s71, 69632
  s_add_u32 s24, s86, 131072
  buffer_load_dwordx4 v116, s[8:11], s24 offen lds
  s_add_u32 m0, s71, 73728
  s_add_u32 s24, s86, 262144
  buffer_load_dwordx4 v116, s[8:11], s24 offen lds
  s_add_u32 m0, s71, 77824
  s_add_u32 s24, s86, 393216
  buffer_load_dwordx4 v116, s[8:11], s24 offen lds
  v_add_u32 v114, 81920, v118
  v_add_u32 v115, 81920, v119
  ds_read_b64_tr_b16 v[144:145], v114 offset:0
  ds_read_b64_tr_b16 v[146:147], v114 offset:512
  ds_read_b64_tr_b16 v[148:149], v114 offset:8192
  ds_read_b64_tr_b16 v[150:151], v114 offset:8704
  ds_read_b64_tr_b16 v[152:153], v115 offset:0
  ds_read_b64_tr_b16 v[154:155], v115 offset:512
  ds_read_b64_tr_b16 v[156:157], v115 offset:8192
  ds_read_b64_tr_b16 v[158:159], v115 offset:8704
  s_waitcnt lgkmcnt(0)
  s_waitcnt vmcnt(24)
  s_barrier
  s_add_u32 m0, s71, 81920
  s_add_u32 s24, s86, 524288
  buffer_load_dwordx4 v116, s[8:11], s24 offen lds
  s_add_u32 m0, s71, 86016
  s_add_u32 s24, s86, 655360
  buffer_load_dwordx4 v116, s[8:11], s24 offen lds
  s_add_u32 m0, s71, 90112
  s_add_u32 s24, s86, 786432
  buffer_load_dwordx4 v116, s[8:11], s24 offen lds
  s_add_u32 m0, s71, 94208
  s_add_u32 s24, s86, 917504
  buffer_load_dwordx4 v116, s[8:11], s24 offen lds
  v_add_u32 v114, 98304, v118
  v_add_u32 v115, 98304, v119
  ds_read_b64_tr_b16 a[96:97], v114 offset:0
  ds_read_b64_tr_b16 a[98:99], v114 offset:512
  ds_read_b64_tr_b16 a[100:101], v114 offset:8192
  ds_read_b64_tr_b16 a[102:103], v114 offset:8704
  ds_read_b64_tr_b16 a[104:105], v115 offset:0
  ds_read_b64_tr_b16 a[106:107], v115 offset:512
  ds_read_b64_tr_b16 a[108:109], v115 offset:8192
  ds_read_b64_tr_b16 a[110:111], v115 offset:8704
  s_waitcnt lgkmcnt(0)
  s_waitcnt vmcnt(24)
  s_barrier
  s_add_u32 m0, s71, 98304
  s_add_u32 s24, s86, 1048576
  buffer_load_dwordx4 v116, s[8:11], s24 offen lds
  s_add_u32 m0, s71, 102400
  s_add_u32 s24, s86, 1179648
  buffer_load_dwordx4 v116, s[8:11], s24 offen lds
  s_add_u32 m0, s71, 106496
  s_add_u32 s24, s86, 1310720
  buffer_load_dwordx4 v116, s[8:11], s24 offen lds
  s_add_u32 m0, s71, 110592
  s_add_u32 s24, s86, 1441792
  buffer_load_dwordx4 v116, s[8:11], s24 offen lds
  v_add_u32 v114, 114688, v118
  v_add_u32 v115, 114688, v119
  ds_read_b64_tr_b16 a[112:113], v114 offset:0
  ds_read_b64_tr_b16 a[114:115], v114 offset:512
  ds_read_b64_tr_b16 a[116:117], v114 offset:8192
  ds_read_b64_tr_b16 a[118:119], v114 offset:8704
  ds_read_b64_tr_b16 a[120:121], v115 offset:0
  ds_read_b64_tr_b16 a[122:123], v115 offset:512
  ds_read_b64_tr_b16 a[124:125], v115 offset:8192
  ds_read_b64_tr_b16 a[126:127], v115 offset:8704
  s_waitcnt lgkmcnt(0)
  s_waitcnt vmcnt(24)
  s_barrier
  s_add_u32 m0, s71, 114688
  s_add_u32 s24, s86, 1572864
  buffer_load_dwordx4 v116, s[8:11], s24 offen lds
  s_add_u32 m0, s71, 118784
  s_add_u32 s24, s86, 1703936
  buffer_load_dwordx4 v116, s[8:11], s24 offen lds
  s_add_u32 m0, s71, 122880
  s_add_u32 s24, s86, 1835008
  buffer_load_dwordx4 v116, s[8:11], s24 offen lds
  s_add_u32 m0, s71, 126976
  s_add_u32 s24, s86, 1966080
  buffer_load_dwordx4 v116, s[8:11], s24 offen lds
  s_mov_b32 s70, 0
  s_lshl_b32 s72, s20, 21
  s_mov_b32 s79, 0x40000000
  s_lshl_b32 s82, s20, 10
  s_lshl_b32 s24, s21, 8
  s_add_u32 s82, s82, s24
  s_add_u32 s82, s82, 0x9100000
  buffer_load_dword v100, off, s[16:19], 0 sc1
  v_add_u32 v114, 131072, v118
  v_add_u32 v115, 131072, v119
  ds_read_b64_tr_b16 a[128:129], v114 offset:0
  ds_read_b64_tr_b16 a[130:131], v114 offset:512
  ds_read_b64_tr_b16 a[132:133], v114 offset:8192
  ds_read_b64_tr_b16 a[134:135], v114 offset:8704
  ds_read_b64_tr_b16 a[136:137], v115 offset:0
  ds_read_b64_tr_b16 a[138:139], v115 offset:512
  ds_read_b64_tr_b16 a[140:141], v115 offset:8192
  ds_read_b64_tr_b16 a[142:143], v115 offset:8704
  s_waitcnt lgkmcnt(0)
  s_waitcnt vmcnt(24)
  s_barrier
  s_add_u32 m0, s71, 131072
  s_add_u32 s24, s86, 2097152
  buffer_load_dwordx4 v116, s[8:11], s24 offen lds
  s_add_u32 m0, s71, 135168
  s_add_u32 s24, s86, 2228224
  buffer_load_dwordx4 v116, s[8:11], s24 offen lds
  s_add_u32 m0, s71, 139264
  s_add_u32 s24, s86, 2359296
  buffer_load_dwordx4 v116, s[8:11], s24 offen lds
  s_add_u32 m0, s71, 143360
  s_add_u32 s24, s86, 2490368
  buffer_load_dwordx4 v116, s[8:11], s24 offen lds
  v_add_u32 v114, 147456, v118
  v_add_u32 v115, 147456, v119
  ds_read_b64_tr_b16 a[144:145], v114 offset:0
  ds_read_b64_tr_b16 a[146:147], v114 offset:512
  ds_read_b64_tr_b16 a[148:149], v114 offset:8192
  ds_read_b64_tr_b16 a[150:151], v114 offset:8704
  ds_read_b64_tr_b16 a[152:153], v115 offset:0
  ds_read_b64_tr_b16 a[154:155], v115 offset:512
  ds_read_b64_tr_b16 a[156:157], v115 offset:8192
  ds_read_b64_tr_b16 a[158:159], v115 offset:8704
  s_waitcnt lgkmcnt(0)
  s_waitcnt vmcnt(24)
  s_barrier
  s_add_u32 m0, s71, 147456
  s_add_u32 s24, s86, 2621440
  buffer_load_dwordx4 v116, s[8:11], s24 offen lds
  s_add_u32 m0, s71, 151552
  s_add_u32 s24, s86, 2752512
  buffer_load_dwordx4 v116, s[8:11], s24 offen lds
  s_add_u32 m0, s71, 155648
  s_add_u32 s24, s86, 2883584
  buffer_load_dwordx4 v116, s[8:11], s24 offen lds
  s_add_u32 m0, s71, 159744
  s_add_u32 s24, s86, 3014656
  buffer_load_dwordx4 v116, s[8:11], s24 offen lds
  v_add_u32 v114, 32768, v118
  v_add_u32 v115, 32768, v119
  ds_read_b64_tr_b16 a[160:161], v114 offset:0
  ds_read_b64_tr_b16 a[162:163], v114 offset:512
  ds_read_b64_tr_b16 a[164:165], v114 offset:8192
  ds_read_b64_tr_b16 a[166:167], v114 offset:8704
  ds_read_b64_tr_b16 a[168:169], v115 offset:0
  ds_read_b64_tr_b16 a[170:171], v115 offset:512
  ds_read_b64_tr_b16 a[172:173], v115 offset:8192
  ds_read_b64_tr_b16 a[174:175], v115 offset:8704
  s_waitcnt lgkmcnt(0)
  s_waitcnt vmcnt(24)
  s_barrier
  s_mov_b32 s8, s44
  s_mov_b32 s9, s45
  s_mov_b32 s10, 0x400000
  s_mov_b32 s11, 0x20000
  s_add_u32 m0, s71, 32768
  s_add_u32 s24, s86, 0
  buffer_load_dwordx4 v116, s[8:11], s24 offen lds
  s_add_u32 m0, s71, 36864
  s_add_u32 s24, s86, 131072
  buffer_load_dwordx4 v116, s[8:11], s24 offen lds
  s_add_u32 m0, s71, 40960
  s_add_u32 s24, s86, 262144
  buffer_load_dwordx4 v116, s[8:11], s24 offen lds
  s_add_u32 m0, s71, 45056
  s_add_u32 s24, s86, 393216
  buffer_load_dwordx4 v116, s[8:11], s24 offen lds
  v_add_u32 v114, 49152, v118
  v_add_u32 v115, 49152, v119
  ds_read_b64_tr_b16 a[176:177], v114 offset:0
  ds_read_b64_tr_b16 a[178:179], v114 offset:512
  ds_read_b64_tr_b16 a[180:181], v114 offset:8192
  ds_read_b64_tr_b16 a[182:183], v114 offset:8704
  ds_read_b64_tr_b16 a[184:185], v115 offset:0
  ds_read_b64_tr_b16 a[186:187], v115 offset:512
  ds_read_b64_tr_b16 a[188:189], v115 offset:8192
  ds_read_b64_tr_b16 a[190:191], v115 offset:8704
  s_waitcnt lgkmcnt(0)
  s_waitcnt vmcnt(24)
  s_barrier
  s_add_u32 m0, s71, 49152
  s_add_u32 s24, s86, 524288
  buffer_load_dwordx4 v116, s[8:11], s24 offen lds
  s_add_u32 m0, s71, 53248
  s_add_u32 s24, s86, 655360
  buffer_load_dwordx4 v116, s[8:11], s24 offen lds
  s_add_u32 m0, s71, 57344
  s_add_u32 s24, s86, 786432
  buffer_load_dwordx4 v116, s[8:11], s24 offen lds
  s_add_u32 m0, s71, 61440
  s_add_u32 s24, s86, 917504
  buffer_load_dwordx4 v116, s[8:11], s24 offen lds
  v_add_u32 v114, 65536, v118
  v_add_u32 v115, 65536, v119
  ds_read_b64_tr_b16 v[160:161], v114 offset:0
  ds_read_b64_tr_b16 v[162:163], v114 offset:512
  ds_read_b64_tr_b16 v[164:165], v114 offset:8192
  ds_read_b64_tr_b16 v[166:167], v114 offset:8704
  ds_read_b64_tr_b16 v[168:169], v115 offset:0
  ds_read_b64_tr_b16 v[170:171], v115 offset:512
  ds_read_b64_tr_b16 v[172:173], v115 offset:8192
  ds_read_b64_tr_b16 v[174:175], v115 offset:8704
  s_waitcnt lgkmcnt(0)
  s_waitcnt vmcnt(24)
  s_barrier
  s_mov_b32 s8, s46
  s_mov_b32 s9, s47
  s_mov_b32 s10, 0x400000
  s_mov_b32 s11, 0x20000
  s_add_u32 m0, s71, 65536
  s_add_u32 s24, s86, 1048576
  buffer_load_dwordx4 v116, s[8:11], s24 offen lds
  s_add_u32 m0, s71, 69632
  s_add_u32 s24, s86, 1179648
  buffer_load_dwordx4 v116, s[8:11], s24 offen lds
  s_add_u32 m0, s71, 73728
  s_add_u32 s24, s86, 1310720
  buffer_load_dwordx4 v116, s[8:11], s24 offen lds
  s_add_u32 m0, s71, 77824
  s_add_u32 s24, s86, 1441792
  buffer_load_dwordx4 v116, s[8:11], s24 offen lds
  v_add_u32 v114, 81920, v118
  v_add_u32 v115, 81920, v119
  ds_read_b64_tr_b16 v[176:177], v114 offset:0
  ds_read_b64_tr_b16 v[178:179], v114 offset:512
  ds_read_b64_tr_b16 v[180:181], v114 offset:8192
  ds_read_b64_tr_b16 v[182:183], v114 offset:8704
  ds_read_b64_tr_b16 v[184:185], v115 offset:0
  ds_read_b64_tr_b16 v[186:187], v115 offset:512
  ds_read_b64_tr_b16 v[188:189], v115 offset:8192
  ds_read_b64_tr_b16 v[190:191], v115 offset:8704
  s_waitcnt lgkmcnt(0)
  s_waitcnt vmcnt(24)
  s_barrier
  s_add_u32 m0, s71, 81920
  s_add_u32 s24, s86, 1572864
  buffer_load_dwordx4 v116, s[8:11], s24 offen lds
  s_add_u32 m0, s71, 86016
  s_add_u32 s24, s86, 1703936
  buffer_load_dwordx4 v116, s[8:11], s24 offen lds
  s_add_u32 m0, s71, 90112
  s_add_u32 s24, s86, 1835008
  buffer_load_dwordx4 v116, s[8:11], s24 offen lds
  s_add_u32 m0, s71, 94208
  s_add_u32 s24, s86, 1966080
  buffer_load_dwordx4 v116, s[8:11], s24 offen lds
  v_add_u32 v114, 98304, v118
  v_add_u32 v115, 98304, v119
  ds_read_b64_tr_b16 v[192:193], v114 offset:0
  ds_read_b64_tr_b16 v[194:195], v114 offset:512
  ds_read_b64_tr_b16 v[196:197], v114 offset:8192
  ds_read_b64_tr_b16 v[198:199], v114 offset:8704
  ds_read_b64_tr_b16 v[200:201], v115 offset:0
  ds_read_b64_tr_b16 v[202:203], v115 offset:512
  ds_read_b64_tr_b16 v[204:205], v115 offset:8192
  ds_read_b64_tr_b16 v[206:207], v115 offset:8704
  s_waitcnt lgkmcnt(0)
  s_waitcnt vmcnt(24)
  s_barrier
  s_mov_b32 s8, s48
  s_mov_b32 s9, s49
  s_mov_b32 s10, 0x400000
  s_mov_b32 s11, 0x20000
  s_add_u32 m0, s71, 98304
  s_add_u32 s24, s86, 3145728
  buffer_load_dwordx4 v116, s[8:11], s24 offen lds
  s_add_u32 m0, s71, 102400
  s_add_u32 s24, s86, 3276800
  buffer_load_dwordx4 v116, s[8:11], s24 offen lds
  s_add_u32 m0, s71, 106496
  s_add_u32 s24, s86, 3407872
  buffer_load_dwordx4 v116, s[8:11], s24 offen lds
  s_add_u32 m0, s71, 110592
  s_add_u32 s24, s86, 3538944
  buffer_load_dwordx4 v116, s[8:11], s24 offen lds
  v_add_u32 v114, 114688, v118
  v_add_u32 v115, 114688, v119
  ds_read_b64_tr_b16 v[208:209], v114 offset:0
  ds_read_b64_tr_b16 v[210:211], v114 offset:512
  ds_read_b64_tr_b16 v[212:213], v114 offset:8192
  ds_read_b64_tr_b16 v[214:215], v114 offset:8704
  ds_read_b64_tr_b16 v[216:217], v115 offset:0
  ds_read_b64_tr_b16 v[218:219], v115 offset:512
  ds_read_b64_tr_b16 v[220:221], v115 offset:8192
  ds_read_b64_tr_b16 v[222:223], v115 offset:8704
  s_waitcnt lgkmcnt(0)
  s_waitcnt vmcnt(24)
  s_barrier
  s_add_u32 m0, s71, 114688
  s_add_u32 s24, s86, 3670016
  buffer_load_dwordx4 v116, s[8:11], s24 offen lds
  s_add_u32 m0, s71, 118784
  s_add_u32 s24, s86, 3801088
  buffer_load_dwordx4 v116, s[8:11], s24 offen lds
  s_add_u32 m0, s71, 122880
  s_add_u32 s24, s86, 3932160
  buffer_load_dwordx4 v116, s[8:11], s24 offen lds
  s_add_u32 m0, s71, 126976
  s_add_u32 s24, s86, 4063232
  buffer_load_dwordx4 v116, s[8:11], s24 offen lds
  v_readfirstlane_b32 s24, v100
  s_nop 0
  s_cmp_ge_u32 s24, 256
  s_cbranch_scc1 L_rarr
  s_mov_b32 s16, s66
  s_mov_b32 s17, s67
  s_mov_b32 s18, 0x100
  s_mov_b32 s19, 0x20000
L_arr_2:
  buffer_load_dword v100, off, s[16:19], 0 sc1
  s_waitcnt vmcnt(0)
  v_readfirstlane_b32 s24, v100
  s_nop 0
  s_cmp_ge_u32 s24, 256
  s_cbranch_scc1 L_arr_2_ok
  s_sleep 2
  s_add_u32 s23, s23, 1
  s_cmp_lt_u32 s23, 0x40000
  s_cbranch_scc1 L_arr_2
  s_branch L_exit
L_arr_2_ok:
L_rarr:
  buffer_load_dword v100, off, s[16:19], 0 offset:128 sc1
  v_lshrrev_b32_e64 v101, 2, v0
  buffer_load_dword v11, v101, s[4:7], s82 offen sc1
  v_add_u32 v114, 131072, v118
  v_add_u32 v115, 131072, v119
  ds_read_b64_tr_b16 v[224:225], v114 offset:0
  ds_read_b64_tr_b16 v[226:227], v114 offset:512
  ds_read_b64_tr_b16 v[228:229], v114 offset:8192
  ds_read_b64_tr_b16 v[230:231], v114 offset:8704
  ds_read_b64_tr_b16 v[232:233], v115 offset:0
  ds_read_b64_tr_b16 v[234:235], v115 offset:512
  ds_read_b64_tr_b16 v[236:237], v115 offset:8192
  ds_read_b64_tr_b16 v[238:239], v115 offset:8704
  s_waitcnt lgkmcnt(0)
  s_waitcnt vmcnt(24)
  s_barrier
  s_mov_b32 s8, s50
  s_mov_b32 s9, s51
  s_mov_b32 s10, 0x400000
  s_mov_b32 s11, 0x20000
  s_add_u32 m0, s71, 131072
  s_add_u32 s24, s87, 768
  buffer_load_dwordx4 v117, s[8:11], s24 offen lds
  s_add_u32 m0, s71, 135168
  s_add_u32 s24, s87, 17152
  buffer_load_dwordx4 v117, s[8:11], s24 offen lds
  s_add_u32 m0, s71, 139264
  s_add_u32 s24, s87, 33536
  buffer_load_dwordx4 v117, s[8:11], s24 offen lds
  s_add_u32 m0, s71, 143360
  s_add_u32 s24, s87, 49920
  buffer_load_dwordx4 v117, s[8:11], s24 offen lds
  v_add_u32 v114, 147456, v118
  v_add_u32 v115, 147456, v119
  ds_read_b64_tr_b16 v[240:241], v114 offset:0
  ds_read_b64_tr_b16 v[242:243], v114 offset:512
  ds_read_b64_tr_b16 v[244:245], v114 offset:8192
  ds_read_b64_tr_b16 v[246:247], v114 offset:8704
  ds_read_b64_tr_b16 v[248:249], v115 offset:0
  ds_read_b64_tr_b16 v[250:251], v115 offset:512
  ds_read_b64_tr_b16 v[252:253], v115 offset:8192
  ds_read_b64_tr_b16 v[254:255], v115 offset:8704
  s_waitcnt lgkmcnt(0)
  s_waitcnt vmcnt(24)
  s_barrier
  s_add_u32 m0, s71, 147456
  s_add_u32 s24, s87, 66304
  buffer_load_dwordx4 v117, s[8:11], s24 offen lds
  s_add_u32 m0, s71, 151552
  s_add_u32 s24, s87, 82688
  buffer_load_dwordx4 v117, s[8:11], s24 offen lds
  s_add_u32 m0, s71, 155648
  s_add_u32 s24, s87, 99072
  buffer_load_dwordx4 v117, s[8:11], s24 offen lds
  s_add_u32 m0, s71, 159744
  s_add_u32 s24, s87, 115456
  buffer_load_dwordx4 v117, s[8:11], s24 offen lds
  s_mov_b32 s16, s66
  s_mov_b32 s17, s67
  s_mov_b32 s18, 0x100
  s_mov_b32 s19, 0x20000
  s_cmp_lg_u32 s21, 0
  s_cbranch_scc1 L_noarr_3
  v_mov_b32_e64 v125, 1
  s_mov_b64 exec, 1
  buffer_atomic_add v125, off, s[16:19], 0 offset:64
  s_mov_b64 exec, -1
L_noarr_3:
  v_add_u32 v114, 32768, v118
  v_add_u32 v115, 32768, v119
  ds_read_b64_tr_b16 v[64:65], v114 offset:0
  ds_read_b64_tr_b16 v[66:67], v114 offset:512
  ds_read_b64_tr_b16 v[68:69], v114 offset:8192
  ds_read_b64_tr_b16 v[70:71], v114 offset:8704
  ds_read_b64_tr_b16 v[72:73], v115 offset:0
  ds_read_b64_tr_b16 v[74:75], v115 offset:512
  ds_read_b64_tr_b16 v[76:77], v115 offset:8192
  ds_read_b64_tr_b16 v[78:79], v115 offset:8704
  s_waitcnt lgkmcnt(0)
  s_waitcnt vmcnt(24)
  s_barrier
  ds_write_b128 v1, v[64:67] offset:0
  ds_write_b128 v1, v[68:71] offset:1024
  ds_write_b128 v1, v[72:75] offset:2048
  ds_write_b128 v1, v[76:79] offset:3072
  v_add_u32 v114, 49152, v118
  v_add_u32 v115, 49152, v119
  ds_read_b64_tr_b16 v[80:81], v114 offset:0
  ds_read_b64_tr_b16 v[82:83], v114 offset:512
  ds_read_b64_tr_b16 v[84:85], v114 offset:8192
  ds_read_b64_tr_b16 v[86:87], v114 offset:8704
  ds_read_b64_tr_b16 v[88:89], v115 offset:0
  ds_read_b64_tr_b16 v[90:91], v115 offset:512
  ds_read_b64_tr_b16 v[92:93], v115 offset:8192
  ds_read_b64_tr_b16 v[94:95], v115 offset:8704
  s_waitcnt lgkmcnt(0)
  s_waitcnt vmcnt(20)
  s_barrier
  ds_write_b128 v1, v[80:83] offset:16384
  ds_write_b128 v1, v[84:87] offset:17408
  ds_write_b128 v1, v[88:91] offset:18432
  ds_write_b128 v1, v[92:95] offset:19456
  v_add_u32 v114, 65536, v118
  v_add_u32 v115, 65536, v119
  ds_read_b64_tr_b16 v[64:65], v114 offset:0
  ds_read_b64_tr_b16 v[66:67], v114 offset:512
  ds_read_b64_tr_b16 v[68:69], v114 offset:8192
  ds_read_b64_tr_b16 v[70:71], v114 offset:8704
  ds_read_b64_tr_b16 v[72:73], v115 offset:0
  ds_read_b64_tr_b16 v[74:75], v115 offset:512
  ds_read_b64_tr_b16 v[76:77], v115 offset:8192
  ds_read_b64_tr_b16 v[78:79], v115 offset:8704
  s_waitcnt lgkmcnt(0)
  s_waitcnt vmcnt(16)
  s_barrier
  ds_write_b128 v1, v[64:67] offset:32768
  ds_write_b128 v1, v[68:71] offset:33792
  ds_write_b128 v1, v[72:75] offset:34816
  ds_write_b128 v1, v[76:79] offset:35840
  v_add_u32 v114, 81920, v118
  v_add_u32 v115, 81920, v119
  ds_read_b64_tr_b16 v[80:81], v114 offset:0
  ds_read_b64_tr_b16 v[82:83], v114 offset:512
  ds_read_b64_tr_b16 v[84:85], v114 offset:8192
  ds_read_b64_tr_b16 v[86:87], v114 offset:8704
  ds_read_b64_tr_b16 v[88:89], v115 offset:0
  ds_read_b64_tr_b16 v[90:91], v115 offset:512
  ds_read_b64_tr_b16 v[92:93], v115 offset:8192
  ds_read_b64_tr_b16 v[94:95], v115 offset:8704
  s_waitcnt lgkmcnt(0)
  s_waitcnt vmcnt(12)
  s_barrier
  ds_write_b128 v1, v[80:83] offset:49152
  ds_write_b128 v1, v[84:87] offset:50176
  ds_write_b128 v1, v[88:91] offset:51200
  ds_write_b128 v1, v[92:95] offset:52224
  v_add_u32 v114, 98304, v118
  v_add_u32 v115, 98304, v119
  ds_read_b64_tr_b16 v[64:65], v114 offset:0
  ds_read_b64_tr_b16 v[66:67], v114 offset:512
  ds_read_b64_tr_b16 v[68:69], v114 offset:8192
  ds_read_b64_tr_b16 v[70:71], v114 offset:8704
  ds_read_b64_tr_b16 v[72:73], v115 offset:0
  ds_read_b64_tr_b16 v[74:75], v115 offset:512
  ds_read_b64_tr_b16 v[76:77], v115 offset:8192
  ds_read_b64_tr_b16 v[78:79], v115 offset:8704
  s_waitcnt lgkmcnt(0)
  s_waitcnt vmcnt(8)
  s_barrier
  ds_write_b128 v2, v[64:67] offset:0
  ds_write_b128 v2, v[68:71] offset:1024
  ds_write_b128 v2, v[72:75] offset:2048
  ds_write_b128 v2, v[76:79] offset:3072
  v_add_u32 v114, 114688, v118
  v_add_u32 v115, 114688, v119
  ds_read_b64_tr_b16 v[80:81], v114 offset:0
  ds_read_b64_tr_b16 v[82:83], v114 offset:512
  ds_read_b64_tr_b16 v[84:85], v114 offset:8192
  ds_read_b64_tr_b16 v[86:87], v114 offset:8704
  ds_read_b64_tr_b16 v[88:89], v115 offset:0
  ds_read_b64_tr_b16 v[90:91], v115 offset:512
  ds_read_b64_tr_b16 v[92:93], v115 offset:8192
  ds_read_b64_tr_b16 v[94:95], v115 offset:8704
  s_waitcnt lgkmcnt(0)
  s_waitcnt vmcnt(4)
  s_barrier
  ds_write_b128 v2, v[80:83] offset:16384
  ds_write_b128 v2, v[84:87] offset:17408
  ds_write_b128 v2, v[88:91] offset:18432
  ds_write_b128 v2, v[92:95] offset:19456
  v_add_u32 v114, 131072, v118
  v_add_u32 v115, 131072, v119
  ds_read_b64_tr_b16 v[64:65], v114 offset:0
  ds_read_b64_tr_b16 v[66:67], v114 offset:512
  ds_read_b64_tr_b16 v[68:69], v114 offset:8192
  ds_read_b64_tr_b16 v[70:71], v114 offset:8704
  ds_read_b64_tr_b16 v[72:73], v115 offset:0
  ds_read_b64_tr_b16 v[74:75], v115 offset:512
  ds_read_b64_tr_b16 v[76:77], v115 offset:8192
  ds_read_b64_tr_b16 v[78:79], v115 offset:8704
  s_waitcnt lgkmcnt(0)
  s_waitcnt vmcnt(0)
  s_barrier
  v_cmp_eq_u32 s[84:85], 1, v11
  s_nop 0
  s_bitcmp1_b64 s[84:85], s70
  s_cbranch_scc1 L_kv0_ok
  v_lshrrev_b32_e64 v101, 2, v0
L_kv0_p:
  buffer_load_dword v11, v101, s[4:7], s82 offen sc1
  s_waitcnt vmcnt(0)
  v_cmp_eq_u32 s[84:85], 1, v11
  s_nop 0
  s_bitcmp1_b64 s[84:85], s70
  s_cbranch_scc1 L_kv0_ok
  s_add_u32 s23, s23, 1
  s_cmp_lt_u32 s23, 0x40000
  s_cbranch_scc1 L_kv0_p
  s_branch L_exit
L_kv0_ok:
  s_mov_b32 s27, 1
  s_bitcmp1_b64 s[84:85], s27
  s_cbranch_scc1 L_kv1_ok
  v_lshrrev_b32 v101, 2, v0
L_kv1_p:
  buffer_load_dword v11, v101, s[4:7], s82 offen sc1
  s_waitcnt vmcnt(0)
  v_cmp_eq_u32 s[84:85], 1, v11
  s_nop 0
  s_bitcmp1_b64 s[84:85], s27
  s_cbranch_scc1 L_kv1_ok
  s_add_u32 s23, s23, 1
  s_cmp_lt_u32 s23, 0x40000
  s_cbranch_scc1 L_kv1_p
  s_branch L_exit
L_kv1_ok:
  buffer_load_dwordx4 v[40:43], v12, s[4:7], s72 offen offset:0 sc1
  buffer_load_dwordx4 v[44:47], v12, s[4:7], s72 offen offset:256 sc1
  ds_write_b128 v2, v[64:67] offset:32768
  ds_write_b128 v2, v[68:71] offset:33792
  ds_write_b128 v2, v[72:75] offset:34816
  ds_write_b128 v2, v[76:79] offset:35840
  v_add_u32 v114, 147456, v118
  v_add_u32 v115, 147456, v119
  ds_read_b64_tr_b16 v[80:81], v114 offset:0
  ds_read_b64_tr_b16 v[82:83], v114 offset:512
  ds_read_b64_tr_b16 v[84:85], v114 offset:8192
  ds_read_b64_tr_b16 v[86:87], v114 offset:8704
  ds_read_b64_tr_b16 v[88:89], v115 offset:0
  ds_read_b64_tr_b16 v[90:91], v115 offset:512
  ds_read_b64_tr_b16 v[92:93], v115 offset:8192
  ds_read_b64_tr_b16 v[94:95], v115 offset:8704
  s_waitcnt lgkmcnt(0)
  s_barrier
  ds_write_b128 v2, v[80:83] offset:49152
  ds_write_b128 v2, v[84:87] offset:50176
  ds_write_b128 v2, v[88:91] offset:51200
  ds_write_b128 v2, v[92:95] offset:52224
  ds_write_b128 v15, v[16:19] offset:0
  ds_write_b128 v15, v[20:23] offset:4096
  v_readfirstlane_b32 s86, v100
  s_mov_b32 s16, 0x3f803f80
  s_mov_b32 s17, 0x3f803f80
  s_mov_b32 s18, 0x3e0293ee
  s_mov_b32 s19, 0x3e0293ee
  s_mul_i32 s14, s21, 2048
  s_add_u32 s14, s14, 0x9084000
  s_and_b32 s84, s84, 0x7f
  s_mov_b32 s85, 0
  s_waitcnt lgkmcnt(0)
  ds_read_b128 v[64:67], v1 offset:0
  ds_read_b128 v[68:71], v1 offset:1024
  ds_read_b128 v[72:75], v1 offset:2048
  ds_read_b128 v[76:79], v1 offset:3072
  ds_read_b128 v[80:83], v1 offset:16384
  ds_read_b128 v[84:87], v1 offset:17408
  ds_read_b128 v[88:91], v1 offset:18432
  ds_read_b128 v[92:95], v1 offset:19456
  v_mov_b64 v[16:17], 0
  v_mov_b64 v[18:19], 0
  v_mov_b64 v[20:21], 0
  v_mov_b64 v[22:23], 0
  v_mov_b64 v[24:25], 0
  v_mov_b64 v[26:27], 0
  v_mov_b64 v[28:29], 0
  v_mov_b64 v[30:31], 0
  v_mov_b64 v[32:33], 0
  v_mov_b64 v[34:35], 0
  v_mov_b64 v[36:37], 0
  v_mov_b64 v[38:39], 0
  v_mov_b64 v[56:57], -1
  v_mov_b64 v[58:59], -1
  s_xor_b32 s25, s78, 0x80000
  s_add_u32 s26, s72, 0x8000
  s_waitcnt vmcnt(0) lgkmcnt(0)
  s_bcnt1_i32_b32 s86, s86
  s_cmp_eq_u32 s86, 1
  s_cbranch_scc0 L_rslow
L_rfast:
  s_waitcnt lgkmcnt(0)
  s_barrier
  ds_read_b128 v[96:99], v0 offset:0
  ds_read_b128 v[100:103], v0 offset:1024
  buffer_load_dwordx4 v[48:51], v12, s[4:7], s72 offen offset:2048 sc1
  s_waitcnt lgkmcnt(1)
  v_smfmac_f32_16x16x64_bf16 v[16:19], v[96:99], v[64:71], v14
  ds_read_b128 v[104:107], v0 offset:2048
  v_smfmac_f32_16x16x64_bf16 v[20:23], v[96:99], v[72:79], v14
  ds_read_b128 v[108:111], v0 offset:3072
  s_waitcnt lgkmcnt(2)
  v_smfmac_f32_16x16x64_bf16 v[16:19], v[100:103], v[80:87], v14
  buffer_load_dwordx4 v[52:55], v12, s[4:7], s72 offen offset:2304 sc1
  v_smfmac_f32_16x16x64_bf16 v[20:23], v[100:103], v[88:95], v14
  ds_read_b128 v[112:115], v0 offset:4096
  s_waitcnt lgkmcnt(2)
  v_smfmac_f32_16x16x64_bf16 v[16:19], v[104:107], a[192:199], v14
  ds_read_b128 v[116:119], v0 offset:5120
  v_smfmac_f32_16x16x64_bf16 v[20:23], v[104:107], a[200:207], v14
  s_waitcnt vmcnt(2)
  ds_read_b128 v[120:123], v0 offset:6144
  s_waitcnt lgkmcnt(3)
  v_smfmac_f32_16x16x64_bf16 v[16:19], v[108:111], a[208:215], v14
  ds_read_b128 v[124:127], v0 offset:7168
  v_smfmac_f32_16x16x64_bf16 v[20:23], v[108:111], a[216:223], v14
  ds_read_b128 v[64:67], v1 offset:32768
  s_waitcnt lgkmcnt(4)
  v_smfmac_f32_16x16x64_bf16 v[16:19], v[112:115], a[224:231], v14
  ds_read_b128 v[68:71], v1 offset:33792
  s_waitcnt lgkmcnt(4)
  v_smfmac_f32_16x16x64_bf16 v[16:19], v[116:119], a[240:247], v14
  buffer_store_dwordx4 v[28:31], v15, s[4:7], s79 offen offset:2048 sc1
  s_waitcnt lgkmcnt(3)
  v_smfmac_f32_16x16x64_bf16 v[16:19], v[120:123], v[128:135], v14
  ds_read_b128 v[80:83], v1 offset:49152
  s_waitcnt lgkmcnt(3)
  v_smfmac_f32_16x16x64_bf16 v[16:19], v[124:127], v[144:151], v14
  ds_read_b128 v[84:87], v1 offset:50176
  v_smfmac_f32_16x16x64_bf16 v[20:23], v[112:115], a[232:239], v14
  buffer_store_dword v56, v10, s[4:7], s76 offen
  v_smfmac_f32_16x16x64_bf16 v[20:23], v[116:119], a[248:255], v14
  v_smfmac_f32_16x16x64_bf16 v[20:23], v[120:123], v[136:143], v14
  v_smfmac_f32_16x16x64_bf16 v[20:23], v[124:127], v[152:159], v14
  buffer_store_dwordx4 v[56:59], v0, s[4:7], s25 offen offset:0
  v_smfmac_f32_16x16x64_bf16 v[24:27], v[96:99], a[96:103], v14
  s_nop 1
  v_add_f32 v16, v16, v18
  v_smfmac_f32_16x16x64_bf16 v[24:27], v[100:103], a[112:119], v14
  s_nop 1
  v_add_f32 v17, v17, v19
  v_smfmac_f32_16x16x64_bf16 v[24:27], v[112:115], a[128:135], v14
  v_mul_f32 v16, s18, v16
  v_add_f32 v20, v20, v22
  v_smfmac_f32_16x16x64_bf16 v[24:27], v[116:119], a[144:151], v14
  ds_read_b128 v[72:75], v1 offset:34816
  v_mov_b64 v[28:29], 0
  v_mul_f32 v17, s18, v17
  v_smfmac_f32_16x16x64_bf16 v[24:27], v[120:123], a[160:167], v14
  ds_read_b128 v[76:79], v1 offset:35840
  v_mov_b64_e64 v[30:31], 0
  v_cvt_pk_bf16_f32 v56, v16, v17
  v_add_f32 v21, v21, v23
  v_mul_f32 v20, s18, v20
  v_smfmac_f32_16x16x64_bf16 v[24:27], v[124:127], a[176:183], v14
  ds_read_b128 v[88:91], v1 offset:51200
  s_waitcnt lgkmcnt(5)
  v_mul_f32_e64 v21, s18, v21
  v_smfmac_f32_16x16x64_bf16 v[24:27], v[104:107], v[64:71], v14
  ds_read_b128 v[92:95], v1 offset:52224
  s_waitcnt lgkmcnt(4)
  v_cvt_pk_bf16_f32 v57, v20, v21
  v_smfmac_f32_16x16x64_bf16 v[24:27], v[108:111], v[80:87], v14
  ds_write2_b32 v6, v56, v57 offset0:0 offset1:32
  v_smfmac_f32_16x16x64_bf16 v[28:31], v[96:99], a[104:111], v14
  ds_write2_b32 v6, v56, v57 offset0:65 offset1:97
  v_smfmac_f32_16x16x64_bf16 v[28:31], v[100:103], a[120:127], v14
  ds_read_b64_tr_b16 v[16:17], v7 offset:0
  v_smfmac_f32_16x16x64_bf16 v[28:31], v[112:115], a[136:143], v14
  ds_read_b64_tr_b16 v[18:19], v7 offset:64
  v_smfmac_f32_16x16x64_bf16 v[28:31], v[116:119], a[152:159], v14
  ds_read_b64_tr_b16 v[20:21], v7 offset:256
  v_add_f32_e64 v24, v24, v26
  v_smfmac_f32_16x16x64_bf16 v[28:31], v[120:123], a[168:175], v14
  ds_read_b64_tr_b16 v[22:23], v7 offset:320
  v_add_f32_e64 v25, v25, v27
  v_smfmac_f32_16x16x64_bf16 v[28:31], v[124:127], a[184:191], v14
  ds_write2st64_b32 v4, v56, v57 offset0:32 offset1:33
  s_waitcnt lgkmcnt(9)
  v_smfmac_f32_16x16x64_bf16 v[28:31], v[104:107], v[72:79], v14
  ds_read_b128 v[64:67], v2 offset:0
  s_waitcnt lgkmcnt(8)
  v_cvt_pk_bf16_f32 v26, v24, v25
  v_smfmac_f32_16x16x64_bf16 v[28:31], v[108:111], v[88:95], v14
  ds_read_b128 v[68:71], v2 offset:1024
  s_waitcnt lgkmcnt(5)
  v_mfma_f32_16x16x32_bf16 v[56:59], v[40:43], v[16:19], 0
  s_nop 0
  ds_read_b128 v[80:83], v2 offset:16384
  s_waitcnt lgkmcnt(4)
  v_mfma_f32_16x16x32_bf16 v[56:59], v[44:47], v[20:23], v[56:59]
  ds_read_b128 v[72:75], v2 offset:2048
  v_add_f32 v28, v28, v30
  v_smfmac_f32_16x16x64_bf16 v[32:35], v[96:99], v[160:167], v14
  ds_read_b128 v[76:79], v2 offset:3072
  v_add_f32_e64 v29, v29, v31
  v_smfmac_f32_16x16x64_bf16 v[36:39], v[96:99], v[168:175], v14
  ds_read_b128 v[84:87], v2 offset:17408
  v_cvt_pk_bf16_f32 v27, v28, v29
  v_smfmac_f32_16x16x64_bf16 v[32:35], v[100:103], v[176:183], v14
  buffer_load_dwordx4 v[40:43], v12, s[4:7], s26 offen offset:0 sc1
  ds_write_b128 v15, v[56:59] offset:22016
  v_smfmac_f32_16x16x64_bf16 v[36:39], v[100:103], v[184:191], v14
  ds_write2st64_b32 v4, v26, v27 offset0:41 offset1:42
  buffer_store_dwordx4 v[60:63], v13, s[4:7], s79 offen sc1
  s_add_u32 s79, s72, 0x4000
  v_smfmac_f32_16x16x64_bf16 v[32:35], v[104:107], v[192:199], v14
  ds_read_b128 v[88:91], v2 offset:18432
  v_smfmac_f32_16x16x64_bf16 v[36:39], v[104:107], v[200:207], v14
  ds_read_b128 v[92:95], v2 offset:19456
  v_smfmac_f32_16x16x64_bf16 v[32:35], v[108:111], v[208:215], v14
  s_waitcnt lgkmcnt(2)
  s_barrier
  ds_read_b128 v[96:99], v0 offset:22016
  v_smfmac_f32_16x16x64_bf16 v[36:39], v[108:111], v[216:223], v14
  buffer_load_dwordx4 v[44:47], v12, s[4:7], s26 offen offset:256 sc1
  ds_read_b128 v[100:103], v0 offset:23040
  v_smfmac_f32_16x16x64_bf16 v[32:35], v[120:123], v[64:71], v14
  ds_read_b128 v[104:107], v0 offset:24064
  v_smfmac_f32_16x16x64_bf16 v[32:35], v[124:127], v[80:87], v14
  ds_read_b128 v[108:111], v0 offset:25088
  v_smfmac_f32_16x16x64_bf16 v[32:35], v[112:115], v[224:231], v14
  ds_read_b64_tr_b16 v[24:25], v5 offset:10496
  v_mov_b64_e64 v[64:65], s[16:17]
  v_smfmac_f32_16x16x64_bf16 v[32:35], v[116:119], v[240:247], v14
  ds_read_b64_tr_b16 v[16:17], v5 offset:8192
  v_mov_b64_e64 v[66:67], s[16:17]
  v_smfmac_f32_16x16x64_bf16 v[36:39], v[120:123], v[72:79], v14
  ds_read_b64_tr_b16 v[26:27], v5 offset:10560
  s_waitcnt lgkmcnt(7)
  v_mov_b64 v[76:77], 0
  v_smfmac_f32_16x16x64_bf16 v[36:39], v[124:127], v[88:95], v14
  ds_read_b64_tr_b16 v[18:19], v5 offset:8256
  v_mov_b32_e64 v79, 0
  v_smfmac_f32_16x16x64_bf16 v[36:39], v[112:115], v[232:239], v14
  ds_read_b64_tr_b16 v[28:29], v5 offset:10624
  v_mov_b64 v[80:81], 0
  v_mov_b64 v[82:83], 0
  v_smfmac_f32_16x16x64_bf16 v[36:39], v[116:119], v[248:255], v14
  ds_read_b64_tr_b16 v[20:21], v5 offset:8320
  ds_read_b64_tr_b16 v[30:31], v5 offset:10688
  ds_read_b64_tr_b16 v[22:23], v5 offset:8384
  s_waitcnt lgkmcnt(8)
  v_pk_add_f32 v[96:97], v[96:97], v[100:101]
  v_pk_add_f32 v[98:99], v[98:99], v[102:103]
  v_pk_add_f32 v[104:105], v[104:105], v[108:109]
  v_pk_add_f32 v[106:107], v[106:107], v[110:111]
  v_pk_add_f32 v[56:57], v[96:97], v[104:105]
  v_pk_add_f32 v[58:59], v[98:99], v[106:107]
  s_waitcnt lgkmcnt(4)
  v_mfma_f32_16x16x32_bf16 v[60:63], v[24:27], v[16:19], 0
  v_exp_f32 v72, v56
  s_waitcnt lgkmcnt(0)
  v_mfma_f32_16x16x32_bf16 v[60:63], v[28:31], v[20:23], v[60:63]
  v_exp_f32 v73, v57
  v_exp_f32 v74, v58
  v_exp_f32_e64 v75, v59
  v_cvt_pk_bf16_f32 v16, v72, v73
  v_add_f32_e64 v32, v32, v34
  v_cvt_pk_bf16_f32 v17, v74, v75
  v_add_f32_e64 v33, v33, v35
  v_cvt_pk_bf16_f32 v28, v32, v33
  v_pk_add_f32 v[36:37], v[36:37], v[38:39]
  v_cvt_pk_bf16_f32 v30, v36, v37
  v_mov_b32_dpp v18, v16 quad_perm:[2,3,0,1] row_mask:0xf bank_mask:0xf
  v_mov_b32_dpp v19, v17 quad_perm:[2,3,0,1] row_mask:0xf bank_mask:0xf
  v_add_f32_dpp v60, v62, v60 quad_perm:[2,3,0,1] row_mask:0xf bank_mask:0xf
  v_add_f32_dpp v61, v63, v61 quad_perm:[2,3,0,1] row_mask:0xf bank_mask:0xf
  s_waitcnt vmcnt(4)
  v_mfma_f32_16x16x32_bf16 v[68:71], v[64:67], v[16:19], 0
  v_exp_f32 v72, v60
  v_mfma_f32_16x16x32_bf16 v[32:35], v[48:51], v[16:19], 0
  v_exp_f32_e64 v73, v61
  v_mfma_f32_16x16x32_bf16 v[36:39], v[52:55], v[16:19], 0
  v_cvt_pk_bf16_f32 v78, v72, v73
  v_max3_f32 v62, |v56|, |v57|, |v58|
  v_max3_f32 v63, |v59|, |v60|, |v61|
  v_mfma_f32_16x16x32_bf16 v[68:71], v[64:67], v[78:81], v[68:71]
  v_max_f32_e64 v62, v62, v63
  v_cmp_ngt_f32 vcc, 0x42000000, v62
  v_mfma_f32_16x16x32_bf16 v[32:35], v[28:31], v[78:81], v[32:35]
  v_mfma_f32_16x16x32_bf16 v[36:39], v[28:31], v[76:79], v[36:39]
  s_cbranch_vccnz L_rfast_max
L_rfast_pv:
  s_nop 2
  v_rcp_f32 v56, v68
  s_nop 1
  v_pk_mul_f32 v[32:33], v[32:33], v[56:57] op_sel_hi:[1,0]
  v_pk_mul_f32 v[34:35], v[34:35], v[56:57] op_sel_hi:[1,0]
  v_cvt_pk_bf16_f32 v16, v32, v33
  v_cvt_pk_bf16_f32 v17, v34, v35
  ds_write_b64 v8, v[16:17] offset:0
  v_pk_mul_f32 v[36:37], v[36:37], v[56:57] op_sel_hi:[1,0]
  v_pk_mul_f32 v[38:39], v[38:39], v[56:57] op_sel_hi:[1,0]
  v_cvt_pk_bf16_f32 v18, v36, v37
  v_cvt_pk_bf16_f32 v19, v38, v39
  ds_write_b64 v8, v[18:19] offset:256
  v_mfma_f32_32x32x16_bf16 v[96:111], v[80:83], v[80:83], 0
  v_mfma_f32_32x32x16_bf16 v[112:127], v[80:83], v[80:83], 0
  v_mov_b64 v[32:33], -1
  v_mov_b64 v[34:35], -1
  s_add_u32 s24, s73, 4096
  s_waitcnt lgkmcnt(0)
  s_barrier
  ds_read_b128 v[16:19], v0 offset:26112
  ds_read_b128 v[20:23], v0 offset:27136
  buffer_store_dwordx4 v[32:35], v0, s[4:7], s25 offen offset:1024
  ds_read_b128 v[64:67], v2 offset:32768
  s_waitcnt lgkmcnt(2)
  v_smfmac_f32_16x16x64_bf16 v[96:99], v[16:19], a[0:7], v14
  ds_read_b128 v[68:71], v2 offset:33792
  s_waitcnt lgkmcnt(2)
  v_smfmac_f32_16x16x64_bf16 v[96:99], v[20:23], a[16:23], v14
  ds_read_b128 v[80:83], v2 offset:49152
  v_smfmac_f32_16x16x64_bf16 v[100:103], v[16:19], a[8:15], v14
  s_nop 0
  s_nop 0
  ds_read_b128 v[84:87], v2 offset:50176
  v_smfmac_f32_16x16x64_bf16 v[100:103], v[20:23], a[24:31], v14
  ds_read_b128 v[72:75], v2 offset:34816
  v_smfmac_f32_16x16x64_bf16 v[104:107], v[16:19], a[32:39], v14
  ds_read_b128 v[76:79], v2 offset:35840
  v_smfmac_f32_16x16x64_bf16 v[104:107], v[20:23], a[48:55], v14
  ds_read_b128 v[88:91], v2 offset:51200
  v_add_f32_e64 v96, v96, v98
  v_smfmac_f32_16x16x64_bf16 v[108:111], v[16:19], a[40:47], v14
  ds_read_b128 v[92:95], v2 offset:52224
  v_add_f32_e64 v97, v97, v99
  v_cvt_pk_bf16_f32 v56, v96, v97
  v_smfmac_f32_16x16x64_bf16 v[108:111], v[20:23], a[56:63], v14
  v_add_f32_e64 v100, v100, v102
  v_smfmac_f32_16x16x64_bf16 v[112:115], v[16:19], a[64:71], v14
  v_add_f32_e64 v101, v101, v103
  v_cvt_pk_bf16_f32 v57, v100, v101
  v_smfmac_f32_16x16x64_bf16 v[112:115], v[20:23], a[80:87], v14
  buffer_store_dwordx2 v[56:57], v9, s[4:7], s73 offen offset:0
  v_add_f32_e64 v104, v104, v106
  v_smfmac_f32_16x16x64_bf16 v[116:119], v[16:19], a[72:79], v14
  v_add_f32_e64 v105, v105, v107
  v_cvt_pk_bf16_f32 v58, v104, v105
  v_smfmac_f32_16x16x64_bf16 v[116:119], v[20:23], a[88:95], v14
  s_waitcnt lgkmcnt(6)
  v_add_f32 v108, v108, v110
  v_smfmac_f32_16x16x64_bf16 v[120:123], v[16:19], v[64:71], v14
  s_waitcnt lgkmcnt(4)
  v_add_f32 v109, v109, v111
  v_cvt_pk_bf16_f32 v59, v108, v109
  v_smfmac_f32_16x16x64_bf16 v[120:123], v[20:23], v[80:87], v14
  buffer_store_dwordx2 v[58:59], v9, s[4:7], s73 offen offset:2048
  s_waitcnt lgkmcnt(2)
  v_add_f32 v112, v112, v114
  v_smfmac_f32_16x16x64_bf16 v[124:127], v[16:19], v[72:79], v14
  s_waitcnt lgkmcnt(0)
  v_add_f32 v113, v113, v115
  v_cvt_pk_bf16_f32 v24, v112, v113
  v_smfmac_f32_16x16x64_bf16 v[124:127], v[20:23], v[88:95], v14
  v_add_f32 v116, v116, v118
  v_add_f32 v117, v117, v119
  v_cvt_pk_bf16_f32 v25, v116, v117
  buffer_store_dwordx2 v[24:25], v9, s[4:7], s24 offen offset:0
  v_add_f32 v120, v120, v122
  v_add_f32 v121, v121, v123
  v_cvt_pk_bf16_f32 v26, v120, v121
  s_nop 0
  v_add_f32 v124, v124, v126
  v_add_f32_e64 v125, v125, v127
  v_cvt_pk_bf16_f32 v27, v124, v125
  buffer_store_dwordx2 v[26:27], v9, s[4:7], s24 offen offset:2048
  s_cmp_eq_u32 s21, 3
  s_cbranch_scc1 L_rfast_w3
  s_cmp_eq_u32 s21, 2
  s_cbranch_scc1 L_rfast_w2
  s_cmp_eq_u32 s21, 1
  s_cbranch_scc1 L_rfast_w1
L_rfast_w0:
  s_nop 0
  s_nop 13
  buffer_load_dwordx4 v[96:99], v0, s[4:7], s78 offen offset:0 sc1
  buffer_load_dwordx4 v[100:103], v0, s[4:7], s78 offen offset:1024 sc1
  ds_read_b128 v[104:107], v0 offset:30208
  v_add_u32_e64 v60, s83, v5
  ds_read_b64_tr_b16 v[62:63], v60 offset:10560
  ds_read_b64_tr_b16 v[60:61], v60 offset:10496
  ds_read_b128 v[64:67], v1 offset:0
  v_mov_b64_e64 v[16:17], 0
  ds_read_b128 v[68:71], v1 offset:1024
  v_mov_b64_e64 v[18:19], 0
  ds_read_b128 v[72:75], v1 offset:2048
  v_mov_b64_e64 v[20:21], 0
  ds_read_b128 v[76:79], v1 offset:3072
  v_mov_b64_e64 v[22:23], 0
  ds_read_b128 v[80:83], v1 offset:16384
  v_mov_b64_e64 v[32:33], 0
  ds_read_b128 v[84:87], v1 offset:17408
  v_mov_b64_e64 v[34:35], 0
  ds_read_b128 v[88:91], v1 offset:18432
  buffer_load_dwordx4 v[112:115], v0, s[4:7], s78 offen offset:0 sc1
  buffer_load_dwordx4 v[116:119], v0, s[4:7], s78 offen offset:1024 sc1
  v_mov_b64_e64 v[36:37], 0
  ds_read_b128 v[92:95], v1 offset:19456
  v_mov_b64 v[38:39], 0
  v_mov_b64 v[24:25], 0
  v_mov_b64 v[26:27], 0
  v_mov_b64 v[56:57], -1
  v_mov_b64 v[58:59], -1
  s_waitcnt lgkmcnt(10)
  s_waitcnt vmcnt(3)
  v_mfma_f32_16x16x32_bf16 v[108:111], v[104:107], v[96:99], 0
  s_waitcnt vmcnt(2)
  v_mfma_f32_16x16x32_bf16 v[108:111], v[104:107], v[100:103], v[108:111]
  s_nop 0
  s_nop 6
  v_add_f32_dpp v108, v108, v108 row_ror:4 row_mask:0xf bank_mask:0xf
  v_add_f32_dpp v109, v109, v109 row_ror:4 row_mask:0xf bank_mask:0xf
  v_cmp_u_f32_e64 vcc, v110, v110
  v_add_f32_dpp v108, v108, v108 row_ror:8 row_mask:0xf bank_mask:0xf
  v_add_f32_dpp v109, v109, v109 row_ror:8 row_mask:0xf bank_mask:0xf
  v_cvt_pk_bf16_f32 v108, v108, v109
  s_cbranch_vccnz L_rfast_w0_h1_miss
L_rfast_w0_h1_got:
  buffer_store_dword v108, v10, s[4:7], s76 offen
  s_nop 15
  s_nop 15
  s_nop 15
  s_nop 0
  s_nop 0
  buffer_load_dwordx4 v[120:123], v0, s[4:7], s14 offen offset:0 sc1
  buffer_load_dwordx4 v[124:127], v0, s[4:7], s14 offen offset:1024 sc1
  s_xor_b32 s73, s73, 0x80000
  s_xor_b32 s76, s76, 0x4000
  s_add_u32 s72, s72, 0x8000
  s_add_u32 s70, s70, 1
  s_mov_b32 s25, s78
  s_xor_b32 s78, s78, 0x80000
  s_add_u32 s27, s70, 1
  s_add_u32 s26, s72, 0x8000
  s_min_u32 s27, s27, 63
  s_bitcmp1_b64 s[84:85], s27
  s_cbranch_scc0 L_rfast_w0_kv
L_rfast_w0_kv_ok:
  s_nop 0
  s_nop 13
  buffer_load_dwordx4 v[48:51], v0, s[4:7], s14 offen offset:0 sc1
  buffer_load_dwordx4 v[52:55], v0, s[4:7], s14 offen offset:1024 sc1
  s_waitcnt vmcnt(3)
  ds_write_b128 v3, v[120:123] offset:0
  s_waitcnt vmcnt(2)
  ds_write_b128 v3, v[124:127] offset:1024
  v_max3_u32 v109, v120, v121, v122
  v_max3_u32 v110, v123, v124, v125
  v_max3_u32 v109, v109, v126, v127
  v_max_u32_e64 v109, v109, v110
  v_cmp_eq_u32 vcc, -1, v109
  s_cbranch_vccnz L_rfast_w0_h2_miss
L_rfast_w0_h2_got:
  s_xor_b32 s14, s14, 0x4000
  s_cmp_lt_u32 s70, 63
  s_cbranch_scc1 L_rfast
  s_branch L_rfast_last
L_rfast_w1:
  s_nop 15
  s_nop 0
  s_nop 7
  buffer_load_dwordx4 v[96:99], v0, s[4:7], s78 offen offset:0 sc1
  buffer_load_dwordx4 v[100:103], v0, s[4:7], s78 offen offset:1024 sc1
  ds_read_b128 v[104:107], v0 offset:30208
  v_add_u32_e64 v60, s83, v5
  ds_read_b64_tr_b16 v[62:63], v60 offset:10560
  ds_read_b64_tr_b16 v[60:61], v60 offset:10496
  ds_read_b128 v[64:67], v1 offset:0
  v_mov_b64_e64 v[16:17], 0
  ds_read_b128 v[68:71], v1 offset:1024
  v_mov_b64_e64 v[18:19], 0
  ds_read_b128 v[72:75], v1 offset:2048
  v_mov_b64_e64 v[20:21], 0
  ds_read_b128 v[76:79], v1 offset:3072
  v_mov_b64_e64 v[22:23], 0
  ds_read_b128 v[80:83], v1 offset:16384
  v_mov_b64_e64 v[32:33], 0
  ds_read_b128 v[84:87], v1 offset:17408
  v_mov_b64_e64 v[34:35], 0
  ds_read_b128 v[88:91], v1 offset:18432
  buffer_load_dwordx4 v[112:115], v0, s[4:7], s78 offen offset:0 sc1
  buffer_load_dwordx4 v[116:119], v0, s[4:7], s78 offen offset:1024 sc1
  v_mov_b64_e64 v[36:37], 0
  ds_read_b128 v[92:95], v1 offset:19456
  v_mov_b64 v[38:39], 0
  v_mov_b64 v[24:25], 0
  v_mov_b64 v[26:27], 0
  v_mov_b64 v[56:57], -1
  v_mov_b64 v[58:59], -1
  s_waitcnt lgkmcnt(10)
  s_waitcnt vmcnt(3)
  v_mfma_f32_16x16x32_bf16 v[108:111], v[104:107], v[96:99], 0
  s_waitcnt vmcnt(2)
  v_mfma_f32_16x16x32_bf16 v[108:111], v[104:107], v[100:103], v[108:111]
  s_nop 0
  s_nop 6
  v_add_f32_dpp v108, v108, v108 row_ror:4 row_mask:0xf bank_mask:0xf
  v_add_f32_dpp v109, v109, v109 row_ror:4 row_mask:0xf bank_mask:0xf
  v_cmp_u_f32_e64 vcc, v110, v110
  v_add_f32_dpp v108, v108, v108 row_ror:8 row_mask:0xf bank_mask:0xf
  v_add_f32_dpp v109, v109, v109 row_ror:8 row_mask:0xf bank_mask:0xf
  v_cvt_pk_bf16_f32 v108, v108, v109
  s_cbranch_vccnz L_rfast_w1_h1_miss
L_rfast_w1_h1_got:
  buffer_store_dword v108, v10, s[4:7], s76 offen
  s_nop 15
  s_nop 15
  s_nop 12
  buffer_load_dwordx4 v[120:123], v0, s[4:7], s14 offen offset:0 sc1
  buffer_load_dwordx4 v[124:127], v0, s[4:7], s14 offen offset:1024 sc1
  s_xor_b32 s73, s73, 0x80000
  s_xor_b32 s76, s76, 0x4000
  s_add_u32 s72, s72, 0x8000
  s_add_u32 s70, s70, 1
  s_mov_b32 s25, s78
  s_xor_b32 s78, s78, 0x80000
  s_add_u32 s27, s70, 1
  s_add_u32 s26, s72, 0x8000
  s_min_u32 s27, s27, 63
  s_bitcmp1_b64 s[84:85], s27
  s_cbranch_scc0 L_rfast_w1_kv
L_rfast_w1_kv_ok:
  s_nop 0
  s_nop 13
  buffer_load_dwordx4 v[48:51], v0, s[4:7], s14 offen offset:0 sc1
  buffer_load_dwordx4 v[52:55], v0, s[4:7], s14 offen offset:1024 sc1
  s_waitcnt vmcnt(3)
  ds_write_b128 v3, v[120:123] offset:0
  s_waitcnt vmcnt(2)
  ds_write_b128 v3, v[124:127] offset:1024
  v_max3_u32 v109, v120, v121, v122
  v_max3_u32 v110, v123, v124, v125
  v_max3_u32 v109, v109, v126, v127
  v_max_u32_e64 v109, v109, v110
  v_cmp_eq_u32 vcc, -1, v109
  s_cbranch_vccnz L_rfast_w1_h2_miss
L_rfast_w1_h2_got:
  s_xor_b32 s14, s14, 0x4000
  s_cmp_lt_u32 s70, 63
  s_cbranch_scc1 L_rfast
  s_branch L_rfast_last
L_rfast_w2:
  s_nop 15
  s_nop 15
  s_nop 7
  buffer_load_dwordx4 v[96:99], v0, s[4:7], s78 offen offset:0 sc1
  buffer_load_dwordx4 v[100:103], v0, s[4:7], s78 offen offset:1024 sc1
  ds_read_b128 v[104:107], v0 offset:30208
  v_add_u32_e64 v60, s83, v5
  ds_read_b64_tr_b16 v[62:63], v60 offset:10560
  ds_read_b64_tr_b16 v[60:61], v60 offset:10496
  ds_read_b128 v[64:67], v1 offset:0
  v_mov_b64_e64 v[16:17], 0
  ds_read_b128 v[68:71], v1 offset:1024
  v_mov_b64_e64 v[18:19], 0
  ds_read_b128 v[72:75], v1 offset:2048
  v_mov_b64_e64 v[20:21], 0
  ds_read_b128 v[76:79], v1 offset:3072
  v_mov_b64_e64 v[22:23], 0
  ds_read_b128 v[80:83], v1 offset:16384
  v_mov_b64_e64 v[32:33], 0
  ds_read_b128 v[84:87], v1 offset:17408
  v_mov_b64_e64 v[34:35], 0
  ds_read_b128 v[88:91], v1 offset:18432
  buffer_load_dwordx4 v[112:115], v0, s[4:7], s78 offen offset:0 sc1
  buffer_load_dwordx4 v[116:119], v0, s[4:7], s78 offen offset:1024 sc1
  v_mov_b64_e64 v[36:37], 0
  ds_read_b128 v[92:95], v1 offset:19456
  v_mov_b64 v[38:39], 0
  v_mov_b64 v[24:25], 0
  v_mov_b64 v[26:27], 0
  v_mov_b64 v[56:57], -1
  v_mov_b64 v[58:59], -1
  s_waitcnt lgkmcnt(10)
  s_waitcnt vmcnt(3)
  v_mfma_f32_16x16x32_bf16 v[108:111], v[104:107], v[96:99], 0
  s_waitcnt vmcnt(2)
  v_mfma_f32_16x16x32_bf16 v[108:111], v[104:107], v[100:103], v[108:111]
  s_nop 0
  s_nop 6
  v_add_f32_dpp v108, v108, v108 row_ror:4 row_mask:0xf bank_mask:0xf
  v_add_f32_dpp v109, v109, v109 row_ror:4 row_mask:0xf bank_mask:0xf
  v_cmp_u_f32_e64 vcc, v110, v110
  v_add_f32_dpp v108, v108, v108 row_ror:8 row_mask:0xf bank_mask:0xf
  v_add_f32_dpp v109, v109, v109 row_ror:8 row_mask:0xf bank_mask:0xf
  v_cvt_pk_bf16_f32 v108, v108, v109
  s_cbranch_vccnz L_rfast_w2_h1_miss
L_rfast_w2_h1_got:
  buffer_store_dword v108, v10, s[4:7], s76 offen
  s_nop 15
  s_nop 15
  s_nop 15
  s_nop 0
  s_nop 0
  buffer_load_dwordx4 v[120:123], v0, s[4:7], s14 offen offset:0 sc1
  buffer_load_dwordx4 v[124:127], v0, s[4:7], s14 offen offset:1024 sc1
  s_xor_b32 s73, s73, 0x80000
  s_xor_b32 s76, s76, 0x4000
  s_add_u32 s72, s72, 0x8000
  s_add_u32 s70, s70, 1
  s_mov_b32 s25, s78
  s_xor_b32 s78, s78, 0x80000
  s_add_u32 s27, s70, 1
  s_add_u32 s26, s72, 0x8000
  s_min_u32 s27, s27, 63
  s_bitcmp1_b64 s[84:85], s27
  s_cbranch_scc0 L_rfast_w2_kv
L_rfast_w2_kv_ok:
  s_nop 0
  s_nop 13
  buffer_load_dwordx4 v[48:51], v0, s[4:7], s14 offen offset:0 sc1
  buffer_load_dwordx4 v[52:55], v0, s[4:7], s14 offen offset:1024 sc1
  s_waitcnt vmcnt(3)
  ds_write_b128 v3, v[120:123] offset:0
  s_waitcnt vmcnt(2)
  ds_write_b128 v3, v[124:127] offset:1024
  v_max3_u32 v109, v120, v121, v122
  v_max3_u32 v110, v123, v124, v125
  v_max3_u32 v109, v109, v126, v127
  v_max_u32_e64 v109, v109, v110
  v_cmp_eq_u32 vcc, -1, v109
  s_cbranch_vccnz L_rfast_w2_h2_miss
L_rfast_w2_h2_got:
  s_xor_b32 s14, s14, 0x4000
  s_cmp_lt_u32 s70, 63
  s_cbranch_scc1 L_rfast
  s_branch L_rfast_last
L_rfast_w3:
  s_nop 15
  s_nop 15
  s_nop 15
  s_nop 0
  s_nop 5
  buffer_load_dwordx4 v[96:99], v0, s[4:7], s78 offen offset:0 sc1
  buffer_load_dwordx4 v[100:103], v0, s[4:7], s78 offen offset:1024 sc1
  ds_read_b128 v[104:107], v0 offset:30208
  v_add_u32_e64 v60, s83, v5
  ds_read_b64_tr_b16 v[62:63], v60 offset:10560
  ds_read_b64_tr_b16 v[60:61], v60 offset:10496
  ds_read_b128 v[64:67], v1 offset:0
  v_mov_b64_e64 v[16:17], 0
  ds_read_b128 v[68:71], v1 offset:1024
  v_mov_b64_e64 v[18:19], 0
  ds_read_b128 v[72:75], v1 offset:2048
  v_mov_b64_e64 v[20:21], 0
  ds_read_b128 v[76:79], v1 offset:3072
  v_mov_b64_e64 v[22:23], 0
  ds_read_b128 v[80:83], v1 offset:16384
  v_mov_b64_e64 v[32:33], 0
  ds_read_b128 v[84:87], v1 offset:17408
  v_mov_b64_e64 v[34:35], 0
  ds_read_b128 v[88:91], v1 offset:18432
  buffer_load_dwordx4 v[112:115], v0, s[4:7], s78 offen offset:0 sc1
  buffer_load_dwordx4 v[116:119], v0, s[4:7], s78 offen offset:1024 sc1
  v_mov_b64_e64 v[36:37], 0
  ds_read_b128 v[92:95], v1 offset:19456
  v_mov_b64 v[38:39], 0
  v_mov_b64 v[24:25], 0
  v_mov_b64 v[26:27], 0
  v_mov_b64 v[56:57], -1
  v_mov_b64 v[58:59], -1
  s_waitcnt lgkmcnt(10)
  s_waitcnt vmcnt(3)
  v_mfma_f32_16x16x32_bf16 v[108:111], v[104:107], v[96:99], 0
  s_waitcnt vmcnt(2)
  v_mfma_f32_16x16x32_bf16 v[108:111], v[104:107], v[100:103], v[108:111]
  s_nop 0
  s_nop 6
  v_add_f32_dpp v108, v108, v108 row_ror:4 row_mask:0xf bank_mask:0xf
  v_add_f32_dpp v109, v109, v109 row_ror:4 row_mask:0xf bank_mask:0xf
  v_cmp_u_f32_e64 vcc, v110, v110
  v_add_f32_dpp v108, v108, v108 row_ror:8 row_mask:0xf bank_mask:0xf
  v_add_f32_dpp v109, v109, v109 row_ror:8 row_mask:0xf bank_mask:0xf
  v_cvt_pk_bf16_f32 v108, v108, v109
  s_cbranch_vccnz L_rfast_w3_h1_miss
L_rfast_w3_h1_got:
  buffer_store_dword v108, v10, s[4:7], s76 offen
  s_nop 15
  s_nop 15
  s_nop 12
  buffer_load_dwordx4 v[120:123], v0, s[4:7], s14 offen offset:0 sc1
  buffer_load_dwordx4 v[124:127], v0, s[4:7], s14 offen offset:1024 sc1
  s_xor_b32 s73, s73, 0x80000
  s_xor_b32 s76, s76, 0x4000
  s_add_u32 s72, s72, 0x8000
  s_add_u32 s70, s70, 1
  s_mov_b32 s25, s78
  s_xor_b32 s78, s78, 0x80000
  s_add_u32 s27, s70, 1
  s_add_u32 s26, s72, 0x8000
  s_min_u32 s27, s27, 63
  s_bitcmp1_b64 s[84:85], s27
  s_cbranch_scc0 L_rfast_w3_kv
L_rfast_w3_kv_ok:
  s_nop 0
  s_nop 13
  buffer_load_dwordx4 v[48:51], v0, s[4:7], s14 offen offset:0 sc1
  buffer_load_dwordx4 v[52:55], v0, s[4:7], s14 offen offset:1024 sc1
  s_waitcnt vmcnt(3)
  ds_write_b128 v3, v[120:123] offset:0
  s_waitcnt vmcnt(2)
  ds_write_b128 v3, v[124:127] offset:1024
  v_max3_u32 v109, v120, v121, v122
  v_max3_u32 v110, v123, v124, v125
  v_max3_u32 v109, v109, v126, v127
  v_max_u32 v109, v109, v110
  v_cmp_eq_u32 vcc, -1, v109
  s_cbranch_vccnz L_rfast_w3_h2_miss
L_rfast_w3_h2_got:
  s_xor_b32 s14, s14, 0x4000
  s_cmp_lt_u32 s70, 63
  s_cbranch_scc1 L_rfast
  s_branch L_rfast_last
L_rfast_max:
  v_mov_b32_dpp v60, v60 quad_perm:[0,1,0,1] row_mask:0xf bank_mask:0xf
  v_mov_b32_dpp v61, v61 quad_perm:[0,1,0,1] row_mask:0xf bank_mask:0xf
  v_max3_f32 v62, v56, v57, v58
  v_max3_f32 v63, v59, v60, v61
  v_max_f32 v62, v62, v63
  s_nop 1
  v_max_f32_dpp v62, v62, v62 quad_perm:[2,3,0,1] row_mask:0xf bank_mask:0xf
  v_mov_b32 v63, v62
  s_nop 1
  v_permlane16_swap_b32 v62, v63
  v_max_f32 v62, v62, v63
  v_mov_b32 v63, v62
  s_nop 1
  v_permlane32_swap_b32 v62, v63
  v_max_f32 v62, v62, v63
  v_sub_f32 v56, v56, v62
  v_exp_f32 v56, v56
  v_sub_f32 v57, v57, v62
  v_exp_f32 v57, v57
  v_sub_f32 v58, v58, v62
  v_exp_f32 v58, v58
  v_sub_f32 v59, v59, v62
  v_exp_f32 v59, v59
  v_sub_f32 v60, v60, v62
  v_exp_f32 v60, v60
  v_sub_f32 v61, v61, v62
  v_exp_f32 v61, v61
  v_cvt_pk_bf16_f32 v16, v56, v57
  v_cvt_pk_bf16_f32 v17, v58, v59
  v_cvt_pk_bf16_f32 v78, v60, v61
  v_mov_b32_dpp v18, v16 quad_perm:[2,3,0,1] row_mask:0xf bank_mask:0xf
  v_mov_b32_dpp v19, v17 quad_perm:[2,3,0,1] row_mask:0xf bank_mask:0xf
  s_nop 0
  s_nop 0
  v_mfma_f32_16x16x32_bf16 v[68:71], v[64:67], v[16:19], 0
  v_mfma_f32_16x16x32_bf16 v[32:35], v[48:51], v[16:19], 0
  v_mfma_f32_16x16x32_bf16 v[36:39], v[52:55], v[16:19], 0
  v_mfma_f32_16x16x32_bf16 v[68:71], v[64:67], v[78:81], v[68:71]
  v_mfma_f32_16x16x32_bf16 v[32:35], v[28:31], v[78:81], v[32:35]
  v_mfma_f32_16x16x32_bf16 v[36:39], v[28:31], v[76:79], v[36:39]
  s_nop 0
  s_nop 6
  s_branch L_rfast_pv
L_rfast_w0_h1_miss:
  s_mov_b64 exec, vcc
  buffer_load_dwordx4 v[96:99], v0, s[4:7], s78 offen offset:0 sc1
  buffer_load_dwordx4 v[100:103], v0, s[4:7], s78 offen offset:1024 sc1
  s_mov_b64 exec, -1
  s_waitcnt vmcnt(3)
  v_mfma_f32_16x16x32_bf16 v[108:111], v[104:107], v[112:115], 0
  s_waitcnt vmcnt(2)
  v_mfma_f32_16x16x32_bf16 v[108:111], v[104:107], v[116:119], v[108:111]
  s_nop 7
  v_add_f32_dpp v108, v108, v108 row_ror:4 row_mask:0xf bank_mask:0xf
  v_add_f32_dpp v109, v109, v109 row_ror:4 row_mask:0xf bank_mask:0xf
  v_cmp_u_f32 vcc, v110, v110
  v_add_f32_dpp v108, v108, v108 row_ror:8 row_mask:0xf bank_mask:0xf
  v_add_f32_dpp v109, v109, v109 row_ror:8 row_mask:0xf bank_mask:0xf
  v_cvt_pk_bf16_f32 v108, v108, v109
  s_cbranch_vccz L_rfast_w0_h1_got
  v_max3_u32 v120, v112, v113, v114
  v_max3_u32 v121, v115, v116, v117
  v_max3_u32 v120, v120, v118, v119
  v_max_u32 v120, v120, v121
  v_cmp_eq_u32 vcc, -1, v120
  s_cbranch_vccz L_rfast_w0_h1_got
  s_mov_b64 exec, vcc
  buffer_load_dwordx4 v[112:115], v0, s[4:7], s78 offen offset:0 sc1
  buffer_load_dwordx4 v[116:119], v0, s[4:7], s78 offen offset:1024 sc1
  s_mov_b64 exec, -1
  s_waitcnt vmcnt(3)
  v_mfma_f32_16x16x32_bf16 v[108:111], v[104:107], v[96:99], 0
  s_waitcnt vmcnt(2)
  v_mfma_f32_16x16x32_bf16 v[108:111], v[104:107], v[100:103], v[108:111]
  s_nop 7
  v_add_f32_dpp v108, v108, v108 row_ror:4 row_mask:0xf bank_mask:0xf
  v_add_f32_dpp v109, v109, v109 row_ror:4 row_mask:0xf bank_mask:0xf
  v_cmp_u_f32_e64 vcc, v110, v110
  v_add_f32_dpp v108, v108, v108 row_ror:8 row_mask:0xf bank_mask:0xf
  v_add_f32_dpp v109, v109, v109 row_ror:8 row_mask:0xf bank_mask:0xf
  v_cvt_pk_bf16_f32 v108, v108, v109
  s_cbranch_vccz L_rfast_w0_h1_got
  s_add_u32 s23, s23, 1
  s_cmp_lt_u32 s23, 0x40000
  s_cbranch_scc1 L_rfast_w0_h1_miss
  s_branch L_exit
L_rfast_w0_kv:
  v_lshrrev_b32 v109, 2, v0
L_rfast_w0_kv_p:
  buffer_load_dword v11, v109, s[4:7], s82 offen sc1
  s_waitcnt vmcnt(0)
  v_cmp_eq_u32 s[84:85], 1, v11
  s_nop 0
  s_bitcmp1_b64 s[84:85], s27
  s_cbranch_scc1 L_rfast_w0_kv_ok
  s_add_u32 s23, s23, 1
  s_cmp_lt_u32 s23, 0x40000
  s_cbranch_scc1 L_rfast_w0_kv_p
  s_branch L_exit
L_rfast_w0_h2_miss:
  s_mov_b64 exec, vcc
  buffer_load_dwordx4 v[120:123], v0, s[4:7], s14 offen offset:0 sc1
  buffer_load_dwordx4 v[124:127], v0, s[4:7], s14 offen offset:1024 sc1
  s_mov_b64 exec, -1
  s_waitcnt vmcnt(3)
  ds_write_b128 v3, v[48:51] offset:0
  s_waitcnt vmcnt(2)
  ds_write_b128 v3, v[52:55] offset:1024
  v_max3_u32 v109, v48, v49, v50
  v_max3_u32 v110, v51, v52, v53
  v_max3_u32 v109, v109, v54, v55
  v_max_u32_e64 v109, v109, v110
  v_cmp_eq_u32 vcc, -1, v109
  s_cbranch_vccz L_rfast_w0_h2_got
  s_mov_b64 exec, vcc
  buffer_load_dwordx4 v[48:51], v0, s[4:7], s14 offen offset:0 sc1
  buffer_load_dwordx4 v[52:55], v0, s[4:7], s14 offen offset:1024 sc1
  s_mov_b64 exec, -1
  s_waitcnt vmcnt(3)
  ds_write_b128 v3, v[120:123] offset:0
  s_waitcnt vmcnt(2)
  ds_write_b128 v3, v[124:127] offset:1024
  v_max3_u32 v109, v120, v121, v122
  v_max3_u32 v110, v123, v124, v125
  v_max3_u32 v109, v109, v126, v127
  v_max_u32_e64 v109, v109, v110
  v_cmp_eq_u32 vcc, -1, v109
  s_cbranch_vccz L_rfast_w0_h2_got
  s_add_u32 s23, s23, 1
  s_cmp_lt_u32 s23, 0x40000
  s_cbranch_scc1 L_rfast_w0_h2_miss
  s_branch L_exit
L_rfast_w1_h1_miss:
  s_mov_b64 exec, vcc
  buffer_load_dwordx4 v[96:99], v0, s[4:7], s78 offen offset:0 sc1
  buffer_load_dwordx4 v[100:103], v0, s[4:7], s78 offen offset:1024 sc1
  s_mov_b64 exec, -1
  s_waitcnt vmcnt(3)
  v_mfma_f32_16x16x32_bf16 v[108:111], v[104:107], v[112:115], 0
  s_waitcnt vmcnt(2)
  v_mfma_f32_16x16x32_bf16 v[108:111], v[104:107], v[116:119], v[108:111]
  s_nop 7
  v_add_f32_dpp v108, v108, v108 row_ror:4 row_mask:0xf bank_mask:0xf
  v_add_f32_dpp v109, v109, v109 row_ror:4 row_mask:0xf bank_mask:0xf
  v_cmp_u_f32 vcc, v110, v110
  v_add_f32_dpp v108, v108, v108 row_ror:8 row_mask:0xf bank_mask:0xf
  v_add_f32_dpp v109, v109, v109 row_ror:8 row_mask:0xf bank_mask:0xf
  v_cvt_pk_bf16_f32 v108, v108, v109
  s_cbranch_vccz L_rfast_w1_h1_got
  v_max3_u32 v120, v112, v113, v114
  v_max3_u32 v121, v115, v116, v117
  v_max3_u32 v120, v120, v118, v119
  v_max_u32 v120, v120, v121
  v_cmp_eq_u32 vcc, -1, v120
  s_cbranch_vccz L_rfast_w1_h1_got
  s_mov_b64 exec, vcc
  buffer_load_dwordx4 v[112:115], v0, s[4:7], s78 offen offset:0 sc1
  buffer_load_dwordx4 v[116:119], v0, s[4:7], s78 offen offset:1024 sc1
  s_mov_b64 exec, -1
  s_waitcnt vmcnt(3)
  v_mfma_f32_16x16x32_bf16 v[108:111], v[104:107], v[96:99], 0
  s_waitcnt vmcnt(2)
  v_mfma_f32_16x16x32_bf16 v[108:111], v[104:107], v[100:103], v[108:111]
  s_nop 7
  v_add_f32_dpp v108, v108, v108 row_ror:4 row_mask:0xf bank_mask:0xf
  v_add_f32_dpp v109, v109, v109 row_ror:4 row_mask:0xf bank_mask:0xf
  v_cmp_u_f32_e64 vcc, v110, v110
  v_add_f32_dpp v108, v108, v108 row_ror:8 row_mask:0xf bank_mask:0xf
  v_add_f32_dpp v109, v109, v109 row_ror:8 row_mask:0xf bank_mask:0xf
  v_cvt_pk_bf16_f32 v108, v108, v109
  s_cbranch_vccz L_rfast_w1_h1_got
  s_add_u32 s23, s23, 1
  s_cmp_lt_u32 s23, 0x40000
  s_cbranch_scc1 L_rfast_w1_h1_miss
  s_branch L_exit
L_rfast_w1_kv:
  v_lshrrev_b32 v109, 2, v0
L_rfast_w1_kv_p:
  buffer_load_dword v11, v109, s[4:7], s82 offen sc1
  s_waitcnt vmcnt(0)
  v_cmp_eq_u32 s[84:85], 1, v11
  s_nop 0
  s_bitcmp1_b64 s[84:85], s27
  s_cbranch_scc1 L_rfast_w1_kv_ok
  s_add_u32 s23, s23, 1
  s_cmp_lt_u32 s23, 0x40000
  s_cbranch_scc1 L_rfast_w1_kv_p
  s_branch L_exit
L_rfast_w1_h2_miss:
  s_mov_b64 exec, vcc
  buffer_load_dwordx4 v[120:123], v0, s[4:7], s14 offen offset:0 sc1
  buffer_load_dwordx4 v[124:127], v0, s[4:7], s14 offen offset:1024 sc1
  s_mov_b64 exec, -1
  s_waitcnt vmcnt(3)
  ds_write_b128 v3, v[48:51] offset:0
  s_waitcnt vmcnt(2)
  ds_write_b128 v3, v[52:55] offset:1024
  v_max3_u32 v109, v48, v49, v50
  v_max3_u32 v110, v51, v52, v53
  v_max3_u32 v109, v109, v54, v55
  v_max_u32_e64 v109, v109, v110
  v_cmp_eq_u32 vcc, -1, v109
  s_cbranch_vccz L_rfast_w1_h2_got
  s_mov_b64 exec, vcc
  buffer_load_dwordx4 v[48:51], v0, s[4:7], s14 offen offset:0 sc1
  buffer_load_dwordx4 v[52:55], v0, s[4:7], s14 offen offset:1024 sc1
  s_mov_b64 exec, -1
  s_waitcnt vmcnt(3)
  ds_write_b128 v3, v[120:123] offset:0
  s_waitcnt vmcnt(2)
  ds_write_b128 v3, v[124:127] offset:1024
  v_max3_u32 v109, v120, v121, v122
  v_max3_u32 v110, v123, v124, v125
  v_max3_u32 v109, v109, v126, v127
  v_max_u32_e64 v109, v109, v110
  v_cmp_eq_u32 vcc, -1, v109
  s_cbranch_vccz L_rfast_w1_h2_got
  s_add_u32 s23, s23, 1
  s_cmp_lt_u32 s23, 0x40000
  s_cbranch_scc1 L_rfast_w1_h2_miss
  s_branch L_exit
L_rfast_w2_h1_miss:
  s_mov_b64 exec, vcc
  buffer_load_dwordx4 v[96:99], v0, s[4:7], s78 offen offset:0 sc1
  buffer_load_dwordx4 v[100:103], v0, s[4:7], s78 offen offset:1024 sc1
  s_mov_b64 exec, -1
  s_waitcnt vmcnt(3)
  v_mfma_f32_16x16x32_bf16 v[108:111], v[104:107], v[112:115], 0
  s_waitcnt vmcnt(2)
  v_mfma_f32_16x16x32_bf16 v[108:111], v[104:107], v[116:119], v[108:111]
  s_nop 7
  v_add_f32_dpp v108, v108, v108 row_ror:4 row_mask:0xf bank_mask:0xf
  v_add_f32_dpp v109, v109, v109 row_ror:4 row_mask:0xf bank_mask:0xf
  v_cmp_u_f32 vcc, v110, v110
  v_add_f32_dpp v108, v108, v108 row_ror:8 row_mask:0xf bank_mask:0xf
  v_add_f32_dpp v109, v109, v109 row_ror:8 row_mask:0xf bank_mask:0xf
  v_cvt_pk_bf16_f32 v108, v108, v109
  s_cbranch_vccz L_rfast_w2_h1_got
  v_max3_u32 v120, v112, v113, v114
  v_max3_u32 v121, v115, v116, v117
  v_max3_u32 v120, v120, v118, v119
  v_max_u32 v120, v120, v121
  v_cmp_eq_u32 vcc, -1, v120
  s_cbranch_vccz L_rfast_w2_h1_got
  s_mov_b64 exec, vcc
  buffer_load_dwordx4 v[112:115], v0, s[4:7], s78 offen offset:0 sc1
  buffer_load_dwordx4 v[116:119], v0, s[4:7], s78 offen offset:1024 sc1
  s_mov_b64 exec, -1
  s_waitcnt vmcnt(3)
  v_mfma_f32_16x16x32_bf16 v[108:111], v[104:107], v[96:99], 0
  s_waitcnt vmcnt(2)
  v_mfma_f32_16x16x32_bf16 v[108:111], v[104:107], v[100:103], v[108:111]
  s_nop 7
  v_add_f32_dpp v108, v108, v108 row_ror:4 row_mask:0xf bank_mask:0xf
  v_add_f32_dpp v109, v109, v109 row_ror:4 row_mask:0xf bank_mask:0xf
  v_cmp_u_f32_e64 vcc, v110, v110
  v_add_f32_dpp v108, v108, v108 row_ror:8 row_mask:0xf bank_mask:0xf
  v_add_f32_dpp v109, v109, v109 row_ror:8 row_mask:0xf bank_mask:0xf
  v_cvt_pk_bf16_f32 v108, v108, v109
  s_cbranch_vccz L_rfast_w2_h1_got
  s_add_u32 s23, s23, 1
  s_cmp_lt_u32 s23, 0x40000
  s_cbranch_scc1 L_rfast_w2_h1_miss
  s_branch L_exit
L_rfast_w2_kv:
  v_lshrrev_b32 v109, 2, v0
L_rfast_w2_kv_p:
  buffer_load_dword v11, v109, s[4:7], s82 offen sc1
  s_waitcnt vmcnt(0)
  v_cmp_eq_u32 s[84:85], 1, v11
  s_nop 0
  s_bitcmp1_b64 s[84:85], s27
  s_cbranch_scc1 L_rfast_w2_kv_ok
  s_add_u32 s23, s23, 1
  s_cmp_lt_u32 s23, 0x40000
  s_cbranch_scc1 L_rfast_w2_kv_p
  s_branch L_exit
L_rfast_w2_h2_miss:
  s_mov_b64 exec, vcc
  buffer_load_dwordx4 v[120:123], v0, s[4:7], s14 offen offset:0 sc1
  buffer_load_dwordx4 v[124:127], v0, s[4:7], s14 offen offset:1024 sc1
  s_mov_b64 exec, -1
  s_waitcnt vmcnt(3)
  ds_write_b128 v3, v[48:51] offset:0
  s_waitcnt vmcnt(2)
  ds_write_b128 v3, v[52:55] offset:1024
  v_max3_u32 v109, v48, v49, v50
  v_max3_u32 v110, v51, v52, v53
  v_max3_u32 v109, v109, v54, v55
  v_max_u32_e64 v109, v109, v110
  v_cmp_eq_u32 vcc, -1, v109
  s_cbranch_vccz L_rfast_w2_h2_got
  s_mov_b64 exec, vcc
  buffer_load_dwordx4 v[48:51], v0, s[4:7], s14 offen offset:0 sc1
  buffer_load_dwordx4 v[52:55], v0, s[4:7], s14 offen offset:1024 sc1
  s_mov_b64 exec, -1
  s_waitcnt vmcnt(3)
  ds_write_b128 v3, v[120:123] offset:0
  s_waitcnt vmcnt(2)
  ds_write_b128 v3, v[124:127] offset:1024
  v_max3_u32 v109, v120, v121, v122
  v_max3_u32 v110, v123, v124, v125
  v_max3_u32 v109, v109, v126, v127
  v_max_u32_e64 v109, v109, v110
  v_cmp_eq_u32 vcc, -1, v109
  s_cbranch_vccz L_rfast_w2_h2_got
  s_add_u32 s23, s23, 1
  s_cmp_lt_u32 s23, 0x40000
  s_cbranch_scc1 L_rfast_w2_h2_miss
  s_branch L_exit
L_rfast_w3_h1_miss:
  s_mov_b64 exec, vcc
  buffer_load_dwordx4 v[96:99], v0, s[4:7], s78 offen offset:0 sc1
  buffer_load_dwordx4 v[100:103], v0, s[4:7], s78 offen offset:1024 sc1
  s_mov_b64 exec, -1
  s_waitcnt vmcnt(3)
  v_mfma_f32_16x16x32_bf16 v[108:111], v[104:107], v[112:115], 0
  s_waitcnt vmcnt(2)
  v_mfma_f32_16x16x32_bf16 v[108:111], v[104:107], v[116:119], v[108:111]
  s_nop 7
  v_add_f32_dpp v108, v108, v108 row_ror:4 row_mask:0xf bank_mask:0xf
  v_add_f32_dpp v109, v109, v109 row_ror:4 row_mask:0xf bank_mask:0xf
  v_cmp_u_f32 vcc, v110, v110
  v_add_f32_dpp v108, v108, v108 row_ror:8 row_mask:0xf bank_mask:0xf
  v_add_f32_dpp v109, v109, v109 row_ror:8 row_mask:0xf bank_mask:0xf
  v_cvt_pk_bf16_f32 v108, v108, v109
  s_cbranch_vccz L_rfast_w3_h1_got
  v_max3_u32 v120, v112, v113, v114
  v_max3_u32 v121, v115, v116, v117
  v_max3_u32 v120, v120, v118, v119
  v_max_u32 v120, v120, v121
  v_cmp_eq_u32 vcc, -1, v120
  s_cbranch_vccz L_rfast_w3_h1_got
  s_mov_b64 exec, vcc
  buffer_load_dwordx4 v[112:115], v0, s[4:7], s78 offen offset:0 sc1
  buffer_load_dwordx4 v[116:119], v0, s[4:7], s78 offen offset:1024 sc1
  s_mov_b64 exec, -1
  s_waitcnt vmcnt(3)
  v_mfma_f32_16x16x32_bf16 v[108:111], v[104:107], v[96:99], 0
  s_waitcnt vmcnt(2)
  v_mfma_f32_16x16x32_bf16 v[108:111], v[104:107], v[100:103], v[108:111]
  s_nop 7
  v_add_f32_dpp v108, v108, v108 row_ror:4 row_mask:0xf bank_mask:0xf
  v_add_f32_dpp v109, v109, v109 row_ror:4 row_mask:0xf bank_mask:0xf
  v_cmp_u_f32_e64 vcc, v110, v110
  v_add_f32_dpp v108, v108, v108 row_ror:8 row_mask:0xf bank_mask:0xf
  v_add_f32_dpp v109, v109, v109 row_ror:8 row_mask:0xf bank_mask:0xf
  v_cvt_pk_bf16_f32 v108, v108, v109
  s_cbranch_vccz L_rfast_w3_h1_got
  s_add_u32 s23, s23, 1
  s_cmp_lt_u32 s23, 0x40000
  s_cbranch_scc1 L_rfast_w3_h1_miss
  s_branch L_exit
L_rfast_w3_kv:
  v_lshrrev_b32 v109, 2, v0
L_rfast_w3_kv_p:
  buffer_load_dword v11, v109, s[4:7], s82 offen sc1
  s_waitcnt vmcnt(0)
  v_cmp_eq_u32 s[84:85], 1, v11
  s_nop 0
  s_bitcmp1_b64 s[84:85], s27
  s_cbranch_scc1 L_rfast_w3_kv_ok
  s_add_u32 s23, s23, 1
  s_cmp_lt_u32 s23, 0x40000
  s_cbranch_scc1 L_rfast_w3_kv_p
  s_branch L_exit
L_rfast_w3_h2_miss:
  s_mov_b64 exec, vcc
  buffer_load_dwordx4 v[120:123], v0, s[4:7], s14 offen offset:0 sc1
  buffer_load_dwordx4 v[124:127], v0, s[4:7], s14 offen offset:1024 sc1
  s_mov_b64 exec, -1
  s_waitcnt vmcnt(3)
  ds_write_b128 v3, v[48:51] offset:0
  s_waitcnt vmcnt(2)
  ds_write_b128 v3, v[52:55] offset:1024
  v_max3_u32 v109, v48, v49, v50
  v_max3_u32 v110, v51, v52, v53
  v_max3_u32 v109, v109, v54, v55
  v_max_u32_e64 v109, v109, v110
  v_cmp_eq_u32 vcc, -1, v109
  s_cbranch_vccz L_rfast_w3_h2_got
  s_mov_b64 exec, vcc
  buffer_load_dwordx4 v[48:51], v0, s[4:7], s14 offen offset:0 sc1
  buffer_load_dwordx4 v[52:55], v0, s[4:7], s14 offen offset:1024 sc1
  s_mov_b64 exec, -1
  s_waitcnt vmcnt(3)
  ds_write_b128 v3, v[120:123] offset:0
  s_waitcnt vmcnt(2)
  ds_write_b128 v3, v[124:127] offset:1024
  v_max3_u32 v109, v120, v121, v122
  v_max3_u32 v110, v123, v124, v125
  v_max3_u32 v109, v109, v126, v127
  v_max_u32_e64 v109, v109, v110
  v_cmp_eq_u32 vcc, -1, v109
  s_cbranch_vccz L_rfast_w3_h2_got
  s_add_u32 s23, s23, 1
  s_cmp_lt_u32 s23, 0x40000
  s_cbranch_scc1 L_rfast_w3_h2_miss
  s_branch L_exit
L_rfast_last:
  s_waitcnt lgkmcnt(0)
  s_barrier
  s_waitcnt vmcnt(0)
  ds_read_b128 v[96:99], v0 offset:0
  ds_read_b128 v[100:103], v0 offset:1024
  ds_read_b128 v[104:107], v0 offset:2048
  ds_read_b128 v[108:111], v0 offset:3072
  ds_read_b128 v[112:115], v0 offset:4096
  ds_read_b128 v[116:119], v0 offset:5120
  ds_read_b128 v[120:123], v0 offset:6144
  ds_read_b128 v[124:127], v0 offset:7168
  buffer_store_dwordx4 v[28:31], v15, s[4:7], s79 offen offset:2048 sc1
  buffer_store_dwordx4 v[60:63], v13, s[4:7], s79 offen sc1
  s_add_u32 s79, s72, 0x4000
  v_mov_b64 v[28:29], 0
  v_mov_b64 v[30:31], 0
  ds_read_b128 v[64:67], v1 offset:32768
  ds_read_b128 v[68:71], v1 offset:33792
  ds_read_b128 v[72:75], v1 offset:34816
  ds_read_b128 v[76:79], v1 offset:35840
  ds_read_b128 v[80:83], v1 offset:49152
  ds_read_b128 v[84:87], v1 offset:50176
  ds_read_b128 v[88:91], v1 offset:51200
  ds_read_b128 v[92:95], v1 offset:52224
  s_waitcnt lgkmcnt(15)
  v_smfmac_f32_16x16x64_bf16 v[24:27], v[96:99], a[96:103], v14
  v_smfmac_f32_16x16x64_bf16 v[28:31], v[96:99], a[104:111], v14
  s_waitcnt lgkmcnt(14)
  v_smfmac_f32_16x16x64_bf16 v[24:27], v[100:103], a[112:119], v14
  v_smfmac_f32_16x16x64_bf16 v[28:31], v[100:103], a[120:127], v14
  s_waitcnt lgkmcnt(11)
  v_smfmac_f32_16x16x64_bf16 v[24:27], v[112:115], a[128:135], v14
  v_smfmac_f32_16x16x64_bf16 v[28:31], v[112:115], a[136:143], v14
  s_waitcnt lgkmcnt(10)
  v_smfmac_f32_16x16x64_bf16 v[24:27], v[116:119], a[144:151], v14
  v_smfmac_f32_16x16x64_bf16 v[28:31], v[116:119], a[152:159], v14
  s_waitcnt lgkmcnt(9)
  v_smfmac_f32_16x16x64_bf16 v[24:27], v[120:123], a[160:167], v14
  v_smfmac_f32_16x16x64_bf16 v[28:31], v[120:123], a[168:175], v14
  s_waitcnt lgkmcnt(8)
  v_smfmac_f32_16x16x64_bf16 v[24:27], v[124:127], a[176:183], v14
  v_smfmac_f32_16x16x64_bf16 v[28:31], v[124:127], a[184:191], v14
  s_waitcnt lgkmcnt(4)
  v_smfmac_f32_16x16x64_bf16 v[24:27], v[104:107], v[64:71], v14
  v_smfmac_f32_16x16x64_bf16 v[28:31], v[104:107], v[72:79], v14
  s_waitcnt lgkmcnt(0)
  v_smfmac_f32_16x16x64_bf16 v[24:27], v[108:111], v[80:87], v14
  v_smfmac_f32_16x16x64_bf16 v[28:31], v[108:111], v[88:95], v14
  v_smfmac_f32_16x16x64_bf16 v[32:35], v[96:99], v[160:167], v14
  ds_read_b128 v[64:67], v2 offset:0
  ds_read_b128 v[68:71], v2 offset:1024
  v_smfmac_f32_16x16x64_bf16 v[36:39], v[96:99], v[168:175], v14
  ds_read_b128 v[72:75], v2 offset:2048
  ds_read_b128 v[76:79], v2 offset:3072
  v_smfmac_f32_16x16x64_bf16 v[32:35], v[100:103], v[176:183], v14
  ds_read_b128 v[80:83], v2 offset:16384
  ds_read_b128 v[84:87], v2 offset:17408
  v_smfmac_f32_16x16x64_bf16 v[36:39], v[100:103], v[184:191], v14
  ds_read_b128 v[88:91], v2 offset:18432
  ds_read_b128 v[92:95], v2 offset:19456
  v_add_f32_e64 v24, v24, v26
  v_smfmac_f32_16x16x64_bf16 v[32:35], v[104:107], v[192:199], v14
  v_add_f32_e64 v25, v25, v27
  v_cvt_pk_bf16_f32 v26, v24, v25
  v_smfmac_f32_16x16x64_bf16 v[36:39], v[104:107], v[200:207], v14
  v_add_f32 v28, v28, v30
  v_add_f32 v29, v29, v31
  v_smfmac_f32_16x16x64_bf16 v[32:35], v[108:111], v[208:215], v14
  v_cvt_pk_bf16_f32 v27, v28, v29
  v_smfmac_f32_16x16x64_bf16 v[36:39], v[108:111], v[216:223], v14
  ds_write2st64_b32 v4, v26, v27 offset0:41 offset1:42
  v_add_u32_e64 v60, s83, v5
  v_smfmac_f32_16x16x64_bf16 v[32:35], v[112:115], v[224:231], v14
  ds_read_b64_tr_b16 v[62:63], v60 offset:10560
  ds_read_b64_tr_b16 v[60:61], v60 offset:10496
  v_smfmac_f32_16x16x64_bf16 v[36:39], v[112:115], v[232:239], v14
  v_smfmac_f32_16x16x64_bf16 v[32:35], v[116:119], v[240:247], v14
  v_smfmac_f32_16x16x64_bf16 v[36:39], v[116:119], v[248:255], v14
  s_waitcnt lgkmcnt(3)
  v_smfmac_f32_16x16x64_bf16 v[32:35], v[120:123], v[64:71], v14
  v_smfmac_f32_16x16x64_bf16 v[36:39], v[120:123], v[72:79], v14
  v_smfmac_f32_16x16x64_bf16 v[32:35], v[124:127], v[80:87], v14
  v_smfmac_f32_16x16x64_bf16 v[36:39], v[124:127], v[88:95], v14
  s_waitcnt lgkmcnt(0)
  buffer_store_dwordx4 v[60:63], v13, s[4:7], s79 offen sc1
  s_nop 4
  v_add_f32 v32, v32, v34
  v_add_f32_e64 v33, v33, v35
  v_cvt_pk_bf16_f32 v28, v32, v33
  v_pk_add_f32 v[36:37], v[36:37], v[38:39]
  v_cvt_pk_bf16_f32 v30, v36, v37
  buffer_store_dwordx4 v[28:31], v15, s[4:7], s79 offen offset:2048 sc1
  s_branch L_exit
L_rslow:
  s_waitcnt lgkmcnt(0)
  s_barrier
  ds_read_b128 v[96:99], v0 offset:0
  ds_read_b128 v[100:103], v0 offset:1024
  buffer_load_dwordx4 v[48:51], v12, s[4:7], s72 offen offset:2048 sc1
  s_waitcnt lgkmcnt(1)
  v_smfmac_f32_16x16x64_bf16 v[16:19], v[96:99], v[64:71], v14
  ds_read_b128 v[104:107], v0 offset:2048
  v_smfmac_f32_16x16x64_bf16 v[20:23], v[96:99], v[72:79], v14
  ds_read_b128 v[108:111], v0 offset:3072
  s_waitcnt lgkmcnt(2)
  v_smfmac_f32_16x16x64_bf16 v[16:19], v[100:103], v[80:87], v14
  buffer_load_dwordx4 v[52:55], v12, s[4:7], s72 offen offset:2304 sc1
  v_smfmac_f32_16x16x64_bf16 v[20:23], v[100:103], v[88:95], v14
  ds_read_b128 v[112:115], v0 offset:4096
  s_waitcnt lgkmcnt(2)
  v_smfmac_f32_16x16x64_bf16 v[16:19], v[104:107], a[192:199], v14
  ds_read_b128 v[116:119], v0 offset:5120
  v_smfmac_f32_16x16x64_bf16 v[20:23], v[104:107], a[200:207], v14
  s_waitcnt vmcnt(2)
  ds_read_b128 v[120:123], v0 offset:6144
  s_waitcnt lgkmcnt(3)
  v_smfmac_f32_16x16x64_bf16 v[16:19], v[108:111], a[208:215], v14
  ds_read_b128 v[124:127], v0 offset:7168
  v_smfmac_f32_16x16x64_bf16 v[20:23], v[108:111], a[216:223], v14
  ds_read_b128 v[64:67], v1 offset:32768
  s_waitcnt lgkmcnt(4)
  v_smfmac_f32_16x16x64_bf16 v[16:19], v[112:115], a[224:231], v14
  ds_read_b128 v[68:71], v1 offset:33792
  s_waitcnt lgkmcnt(4)
  v_smfmac_f32_16x16x64_bf16 v[16:19], v[116:119], a[240:247], v14
  buffer_store_dwordx4 v[28:31], v15, s[4:7], s79 offen offset:2048 sc1
  s_waitcnt lgkmcnt(3)
  v_smfmac_f32_16x16x64_bf16 v[16:19], v[120:123], v[128:135], v14
  ds_read_b128 v[80:83], v1 offset:49152
  s_waitcnt lgkmcnt(3)
  v_smfmac_f32_16x16x64_bf16 v[16:19], v[124:127], v[144:151], v14
  ds_read_b128 v[84:87], v1 offset:50176
  v_smfmac_f32_16x16x64_bf16 v[20:23], v[112:115], a[232:239], v14
  buffer_store_dword v56, v10, s[4:7], s76 offen sc1
  v_smfmac_f32_16x16x64_bf16 v[20:23], v[116:119], a[248:255], v14
  v_smfmac_f32_16x16x64_bf16 v[20:23], v[120:123], v[136:143], v14
  v_smfmac_f32_16x16x64_bf16 v[20:23], v[124:127], v[152:159], v14
  buffer_store_dwordx4 v[56:59], v0, s[4:7], s25 offen offset:0 sc1
  v_smfmac_f32_16x16x64_bf16 v[24:27], v[96:99], a[96:103], v14
  s_nop 1
  v_add_f32 v16, v16, v18
  v_smfmac_f32_16x16x64_bf16 v[24:27], v[100:103], a[112:119], v14
  s_nop 1
  v_add_f32 v17, v17, v19
  v_smfmac_f32_16x16x64_bf16 v[24:27], v[112:115], a[128:135], v14
  v_mul_f32 v16, s18, v16
  v_add_f32 v20, v20, v22
  v_smfmac_f32_16x16x64_bf16 v[24:27], v[116:119], a[144:151], v14
  ds_read_b128 v[72:75], v1 offset:34816
  v_mov_b64 v[28:29], 0
  v_mul_f32 v17, s18, v17
  v_smfmac_f32_16x16x64_bf16 v[24:27], v[120:123], a[160:167], v14
  ds_read_b128 v[76:79], v1 offset:35840
  v_mov_b64_e64 v[30:31], 0
  v_cvt_pk_bf16_f32 v56, v16, v17
  v_add_f32 v21, v21, v23
  v_mul_f32 v20, s18, v20
  v_smfmac_f32_16x16x64_bf16 v[24:27], v[124:127], a[176:183], v14
  ds_read_b128 v[88:91], v1 offset:51200
  s_waitcnt lgkmcnt(5)
  v_mul_f32_e64 v21, s18, v21
  v_smfmac_f32_16x16x64_bf16 v[24:27], v[104:107], v[64:71], v14
  ds_read_b128 v[92:95], v1 offset:52224
  s_waitcnt lgkmcnt(4)
  v_cvt_pk_bf16_f32 v57, v20, v21
  v_smfmac_f32_16x16x64_bf16 v[24:27], v[108:111], v[80:87], v14
  ds_write2_b32 v6, v56, v57 offset0:0 offset1:32
  v_smfmac_f32_16x16x64_bf16 v[28:31], v[96:99], a[104:111], v14
  ds_write2_b32 v6, v56, v57 offset0:65 offset1:97
  v_smfmac_f32_16x16x64_bf16 v[28:31], v[100:103], a[120:127], v14
  ds_read_b64_tr_b16 v[16:17], v7 offset:0
  v_smfmac_f32_16x16x64_bf16 v[28:31], v[112:115], a[136:143], v14
  ds_read_b64_tr_b16 v[18:19], v7 offset:64
  v_smfmac_f32_16x16x64_bf16 v[28:31], v[116:119], a[152:159], v14
  ds_read_b64_tr_b16 v[20:21], v7 offset:256
  v_add_f32_e64 v24, v24, v26
  v_smfmac_f32_16x16x64_bf16 v[28:31], v[120:123], a[168:175], v14
  ds_read_b64_tr_b16 v[22:23], v7 offset:320
  v_add_f32_e64 v25, v25, v27
  v_smfmac_f32_16x16x64_bf16 v[28:31], v[124:127], a[184:191], v14
  ds_write2st64_b32 v4, v56, v57 offset0:32 offset1:33
  s_waitcnt lgkmcnt(9)
  v_smfmac_f32_16x16x64_bf16 v[28:31], v[104:107], v[72:79], v14
  ds_read_b128 v[64:67], v2 offset:0
  s_waitcnt lgkmcnt(8)
  v_cvt_pk_bf16_f32 v26, v24, v25
  v_smfmac_f32_16x16x64_bf16 v[28:31], v[108:111], v[88:95], v14
  ds_read_b128 v[68:71], v2 offset:1024
  s_waitcnt lgkmcnt(5)
  v_mfma_f32_16x16x32_bf16 v[56:59], v[40:43], v[16:19], 0
  s_nop 0
  ds_read_b128 v[80:83], v2 offset:16384
  s_waitcnt lgkmcnt(4)
  v_mfma_f32_16x16x32_bf16 v[56:59], v[44:47], v[20:23], v[56:59]
  ds_read_b128 v[72:75], v2 offset:2048
  v_add_f32 v28, v28, v30
  v_smfmac_f32_16x16x64_bf16 v[32:35], v[96:99], v[160:167], v14
  ds_read_b128 v[76:79], v2 offset:3072
  v_add_f32_e64 v29, v29, v31
  v_smfmac_f32_16x16x64_bf16 v[36:39], v[96:99], v[168:175], v14
  ds_read_b128 v[84:87], v2 offset:17408
  v_cvt_pk_bf16_f32 v27, v28, v29
  v_smfmac_f32_16x16x64_bf16 v[32:35], v[100:103], v[176:183], v14
  buffer_load_dwordx4 v[40:43], v12, s[4:7], s26 offen offset:0 sc1
  ds_write_b128 v15, v[56:59] offset:22016
  v_smfmac_f32_16x16x64_bf16 v[36:39], v[100:103], v[184:191], v14
  ds_write2st64_b32 v4, v26, v27 offset0:41 offset1:42
  buffer_store_dwordx4 v[60:63], v13, s[4:7], s79 offen sc1
  s_add_u32 s79, s72, 0x4000
  v_smfmac_f32_16x16x64_bf16 v[32:35], v[104:107], v[192:199], v14
  ds_read_b128 v[88:91], v2 offset:18432
  v_smfmac_f32_16x16x64_bf16 v[36:39], v[104:107], v[200:207], v14
  ds_read_b128 v[92:95], v2 offset:19456
  v_smfmac_f32_16x16x64_bf16 v[32:35], v[108:111], v[208:215], v14
  s_waitcnt lgkmcnt(2)
  s_barrier
  ds_read_b128 v[96:99], v0 offset:22016
  v_smfmac_f32_16x16x64_bf16 v[36:39], v[108:111], v[216:223], v14
  buffer_load_dwordx4 v[44:47], v12, s[4:7], s26 offen offset:256 sc1
  ds_read_b128 v[100:103], v0 offset:23040
  v_smfmac_f32_16x16x64_bf16 v[32:35], v[120:123], v[64:71], v14
  ds_read_b128 v[104:107], v0 offset:24064
  v_smfmac_f32_16x16x64_bf16 v[32:35], v[124:127], v[80:87], v14
  ds_read_b128 v[108:111], v0 offset:25088
  v_smfmac_f32_16x16x64_bf16 v[32:35], v[112:115], v[224:231], v14
  ds_read_b64_tr_b16 v[24:25], v5 offset:10496
  v_mov_b64_e64 v[64:65], s[16:17]
  v_smfmac_f32_16x16x64_bf16 v[32:35], v[116:119], v[240:247], v14
  ds_read_b64_tr_b16 v[16:17], v5 offset:8192
  v_mov_b64_e64 v[66:67], s[16:17]
  v_smfmac_f32_16x16x64_bf16 v[36:39], v[120:123], v[72:79], v14
  ds_read_b64_tr_b16 v[26:27], v5 offset:10560
  s_waitcnt lgkmcnt(7)
  v_mov_b64 v[76:77], 0
  v_smfmac_f32_16x16x64_bf16 v[36:39], v[124:127], v[88:95], v14
  ds_read_b64_tr_b16 v[18:19], v5 offset:8256
  v_mov_b32_e64 v79, 0
  v_smfmac_f32_16x16x64_bf16 v[36:39], v[112:115], v[232:239], v14
  ds_read_b64_tr_b16 v[28:29], v5 offset:10624
  v_mov_b64 v[80:81], 0
  v_mov_b64 v[82:83], 0
  v_smfmac_f32_16x16x64_bf16 v[36:39], v[116:119], v[248:255], v14
  ds_read_b64_tr_b16 v[20:21], v5 offset:8320
  ds_read_b64_tr_b16 v[30:31], v5 offset:10688
  ds_read_b64_tr_b16 v[22:23], v5 offset:8384
  s_waitcnt lgkmcnt(8)
  v_pk_add_f32 v[96:97], v[96:97], v[100:101]
  v_pk_add_f32 v[98:99], v[98:99], v[102:103]
  v_pk_add_f32 v[104:105], v[104:105], v[108:109]
  v_pk_add_f32 v[106:107], v[106:107], v[110:111]
  v_pk_add_f32 v[56:57], v[96:97], v[104:105]
  v_pk_add_f32 v[58:59], v[98:99], v[106:107]
  s_waitcnt lgkmcnt(4)
  v_mfma_f32_16x16x32_bf16 v[60:63], v[24:27], v[16:19], 0
  v_exp_f32 v72, v56
  s_waitcnt lgkmcnt(0)
  v_mfma_f32_16x16x32_bf16 v[60:63], v[28:31], v[20:23], v[60:63]
  v_exp_f32 v73, v57
  v_exp_f32 v74, v58
  v_exp_f32_e64 v75, v59
  v_cvt_pk_bf16_f32 v16, v72, v73
  v_add_f32_e64 v32, v32, v34
  v_cvt_pk_bf16_f32 v17, v74, v75
  v_add_f32_e64 v33, v33, v35
  v_cvt_pk_bf16_f32 v28, v32, v33
  v_pk_add_f32 v[36:37], v[36:37], v[38:39]
  v_cvt_pk_bf16_f32 v30, v36, v37
  v_mov_b32_dpp v18, v16 quad_perm:[2,3,0,1] row_mask:0xf bank_mask:0xf
  v_mov_b32_dpp v19, v17 quad_perm:[2,3,0,1] row_mask:0xf bank_mask:0xf
  v_add_f32_dpp v60, v62, v60 quad_perm:[2,3,0,1] row_mask:0xf bank_mask:0xf
  v_add_f32_dpp v61, v63, v61 quad_perm:[2,3,0,1] row_mask:0xf bank_mask:0xf
  s_waitcnt vmcnt(4)
  v_mfma_f32_16x16x32_bf16 v[68:71], v[64:67], v[16:19], 0
  v_exp_f32 v72, v60
  v_mfma_f32_16x16x32_bf16 v[32:35], v[48:51], v[16:19], 0
  v_exp_f32_e64 v73, v61
  v_mfma_f32_16x16x32_bf16 v[36:39], v[52:55], v[16:19], 0
  v_cvt_pk_bf16_f32 v78, v72, v73
  v_max3_f32 v62, |v56|, |v57|, |v58|
  v_max3_f32 v63, |v59|, |v60|, |v61|
  v_mfma_f32_16x16x32_bf16 v[68:71], v[64:67], v[78:81], v[68:71]
  v_max_f32_e64 v62, v62, v63
  v_cmp_ngt_f32 vcc, 0x42000000, v62
  v_mfma_f32_16x16x32_bf16 v[32:35], v[28:31], v[78:81], v[32:35]
  v_mfma_f32_16x16x32_bf16 v[36:39], v[28:31], v[76:79], v[36:39]
  s_cbranch_vccnz L_rslow_max
L_rslow_pv:
  s_nop 2
  v_rcp_f32 v56, v68
  s_nop 1
  v_pk_mul_f32 v[32:33], v[32:33], v[56:57] op_sel_hi:[1,0]
  v_pk_mul_f32 v[34:35], v[34:35], v[56:57] op_sel_hi:[1,0]
  v_cvt_pk_bf16_f32 v16, v32, v33
  v_cvt_pk_bf16_f32 v17, v34, v35
  ds_write_b64 v8, v[16:17] offset:0
  v_pk_mul_f32 v[36:37], v[36:37], v[56:57] op_sel_hi:[1,0]
  v_pk_mul_f32 v[38:39], v[38:39], v[56:57] op_sel_hi:[1,0]
  v_cvt_pk_bf16_f32 v18, v36, v37
  v_cvt_pk_bf16_f32 v19, v38, v39
  ds_write_b64 v8, v[18:19] offset:256
  v_mfma_f32_32x32x16_bf16 v[96:111], v[80:83], v[80:83], 0
  v_mfma_f32_32x32x16_bf16 v[112:127], v[80:83], v[80:83], 0
  v_mov_b64 v[32:33], -1
  v_mov_b64 v[34:35], -1
  s_add_u32 s24, s73, 4096
  s_waitcnt lgkmcnt(0)
  s_barrier
  ds_read_b128 v[16:19], v0 offset:26112
  ds_read_b128 v[20:23], v0 offset:27136
  buffer_store_dwordx4 v[32:35], v0, s[4:7], s25 offen offset:1024 sc1
  ds_read_b128 v[64:67], v2 offset:32768
  s_waitcnt lgkmcnt(2)
  v_smfmac_f32_16x16x64_bf16 v[96:99], v[16:19], a[0:7], v14
  ds_read_b128 v[68:71], v2 offset:33792
  s_waitcnt lgkmcnt(2)
  v_smfmac_f32_16x16x64_bf16 v[96:99], v[20:23], a[16:23], v14
  ds_read_b128 v[80:83], v2 offset:49152
  v_smfmac_f32_16x16x64_bf16 v[100:103], v[16:19], a[8:15], v14
  s_nop 0
  s_nop 0
  ds_read_b128 v[84:87], v2 offset:50176
  v_smfmac_f32_16x16x64_bf16 v[100:103], v[20:23], a[24:31], v14
  ds_read_b128 v[72:75], v2 offset:34816
  v_smfmac_f32_16x16x64_bf16 v[104:107], v[16:19], a[32:39], v14
  ds_read_b128 v[76:79], v2 offset:35840
  v_smfmac_f32_16x16x64_bf16 v[104:107], v[20:23], a[48:55], v14
  ds_read_b128 v[88:91], v2 offset:51200
  v_add_f32_e64 v96, v96, v98
  v_smfmac_f32_16x16x64_bf16 v[108:111], v[16:19], a[40:47], v14
  ds_read_b128 v[92:95], v2 offset:52224
  v_add_f32_e64 v97, v97, v99
  v_cvt_pk_bf16_f32 v56, v96, v97
  v_smfmac_f32_16x16x64_bf16 v[108:111], v[20:23], a[56:63], v14
  v_add_f32_e64 v100, v100, v102
  v_smfmac_f32_16x16x64_bf16 v[112:115], v[16:19], a[64:71], v14
  v_add_f32_e64 v101, v101, v103
  v_cvt_pk_bf16_f32 v57, v100, v101
  v_smfmac_f32_16x16x64_bf16 v[112:115], v[20:23], a[80:87], v14
  buffer_store_dwordx2 v[56:57], v9, s[4:7], s73 offen offset:0 sc1
  v_add_f32_e64 v104, v104, v106
  v_smfmac_f32_16x16x64_bf16 v[116:119], v[16:19], a[72:79], v14
  v_add_f32_e64 v105, v105, v107
  v_cvt_pk_bf16_f32 v58, v104, v105
  v_smfmac_f32_16x16x64_bf16 v[116:119], v[20:23], a[88:95], v14
  s_waitcnt lgkmcnt(6)
  v_add_f32 v108, v108, v110
  v_smfmac_f32_16x16x64_bf16 v[120:123], v[16:19], v[64:71], v14
  s_waitcnt lgkmcnt(4)
  v_add_f32 v109, v109, v111
  v_cvt_pk_bf16_f32 v59, v108, v109
  v_smfmac_f32_16x16x64_bf16 v[120:123], v[20:23], v[80:87], v14
  buffer_store_dwordx2 v[58:59], v9, s[4:7], s73 offen offset:2048 sc1
  s_waitcnt lgkmcnt(2)
  v_add_f32 v112, v112, v114
  v_smfmac_f32_16x16x64_bf16 v[124:127], v[16:19], v[72:79], v14
  s_waitcnt lgkmcnt(0)
  v_add_f32 v113, v113, v115
  v_cvt_pk_bf16_f32 v24, v112, v113
  v_smfmac_f32_16x16x64_bf16 v[124:127], v[20:23], v[88:95], v14
  v_add_f32 v116, v116, v118
  v_add_f32 v117, v117, v119
  v_cvt_pk_bf16_f32 v25, v116, v117
  buffer_store_dwordx2 v[24:25], v9, s[4:7], s24 offen offset:0 sc1
  v_add_f32 v120, v120, v122
  v_add_f32 v121, v121, v123
  v_cvt_pk_bf16_f32 v26, v120, v121
  s_nop 0
  v_add_f32 v124, v124, v126
  v_add_f32_e64 v125, v125, v127
  v_cvt_pk_bf16_f32 v27, v124, v125
  buffer_store_dwordx2 v[26:27], v9, s[4:7], s24 offen offset:2048 sc1
  s_cmp_eq_u32 s21, 3
  s_cbranch_scc1 L_rslow_w3
  s_cmp_eq_u32 s21, 2
  s_cbranch_scc1 L_rslow_w2
  s_cmp_eq_u32 s21, 1
  s_cbranch_scc1 L_rslow_w1
L_rslow_w0:
  s_nop 15
  s_nop 15
  s_nop 15
  s_nop 15
  s_nop 15
  s_nop 15
  s_nop 15
  s_nop 15
  s_nop 15
  s_nop 15
  s_nop 0
  s_nop 13
  buffer_load_dwordx4 v[96:99], v0, s[4:7], s78 offen offset:0 sc1
  buffer_load_dwordx4 v[100:103], v0, s[4:7], s78 offen offset:1024 sc1
  ds_read_b128 v[104:107], v0 offset:30208
  v_add_u32_e64 v60, s83, v5
  ds_read_b64_tr_b16 v[62:63], v60 offset:10560
  ds_read_b64_tr_b16 v[60:61], v60 offset:10496
  ds_read_b128 v[64:67], v1 offset:0
  v_mov_b64_e64 v[16:17], 0
  ds_read_b128 v[68:71], v1 offset:1024
  v_mov_b64_e64 v[18:19], 0
  ds_read_b128 v[72:75], v1 offset:2048
  v_mov_b64_e64 v[20:21], 0
  ds_read_b128 v[76:79], v1 offset:3072
  v_mov_b64_e64 v[22:23], 0
  ds_read_b128 v[80:83], v1 offset:16384
  v_mov_b64_e64 v[32:33], 0
  ds_read_b128 v[84:87], v1 offset:17408
  v_mov_b64_e64 v[34:35], 0
  ds_read_b128 v[88:91], v1 offset:18432
  v_mov_b64_e64 v[36:37], 0
  ds_read_b128 v[92:95], v1 offset:19456
  v_mov_b64 v[38:39], 0
  v_mov_b64 v[24:25], 0
  v_mov_b64 v[26:27], 0
  v_mov_b64 v[56:57], -1
  v_mov_b64 v[58:59], -1
  s_nop 15
  s_nop 15
  s_nop 15
  s_nop 0
  s_nop 6
  buffer_load_dwordx4 v[112:115], v0, s[4:7], s78 offen offset:0 sc1
  buffer_load_dwordx4 v[116:119], v0, s[4:7], s78 offen offset:1024 sc1
  s_waitcnt lgkmcnt(10)
  s_waitcnt vmcnt(3)
  v_mfma_f32_16x16x32_bf16 v[108:111], v[104:107], v[96:99], 0
  s_waitcnt vmcnt(2)
  v_mfma_f32_16x16x32_bf16 v[108:111], v[104:107], v[100:103], v[108:111]
  s_nop 7
  v_add_f32_dpp v108, v108, v108 row_ror:4 row_mask:0xf bank_mask:0xf
  v_add_f32_dpp v109, v109, v109 row_ror:4 row_mask:0xf bank_mask:0xf
  v_cmp_u_f32_e64 vcc, v110, v110
  v_add_f32_dpp v108, v108, v108 row_ror:8 row_mask:0xf bank_mask:0xf
  v_add_f32_dpp v109, v109, v109 row_ror:8 row_mask:0xf bank_mask:0xf
  v_cvt_pk_bf16_f32 v108, v108, v109
  s_cbranch_vccnz L_rslow_w0_h1_miss
L_rslow_w0_h1_got:
  buffer_store_dword v108, v10, s[4:7], s76 offen sc1
  s_nop 15
  s_nop 15
  s_nop 15
  s_nop 15
  s_nop 15
  s_nop 15
  s_nop 15
  s_nop 15
  s_nop 15
  s_nop 15
  s_nop 15
  s_nop 15
  s_nop 15
  s_nop 15
  s_nop 0
  buffer_load_dwordx4 v[120:123], v0, s[4:7], s14 offen offset:0 sc1
  buffer_load_dwordx4 v[124:127], v0, s[4:7], s14 offen offset:1024 sc1
  s_xor_b32 s73, s73, 0x80000
  s_xor_b32 s76, s76, 0x4000
  s_add_u32 s72, s72, 0x8000
  s_add_u32 s70, s70, 1
  s_mov_b32 s25, s78
  s_xor_b32 s78, s78, 0x80000
  s_add_u32 s27, s70, 1
  s_add_u32 s26, s72, 0x8000
  s_min_u32 s27, s27, 63
  s_bitcmp1_b64 s[84:85], s27
  s_cbranch_scc0 L_rslow_w0_kv
L_rslow_w0_kv_ok:
  s_nop 15
  s_nop 15
  s_nop 15
  s_nop 15
  s_nop 15
  s_nop 3
  buffer_load_dwordx4 v[48:51], v0, s[4:7], s14 offen offset:0 sc1
  buffer_load_dwordx4 v[52:55], v0, s[4:7], s14 offen offset:1024 sc1
  s_waitcnt vmcnt(3)
  ds_write_b128 v3, v[120:123] offset:0
  s_waitcnt vmcnt(2)
  ds_write_b128 v3, v[124:127] offset:1024
  v_max3_u32 v109, v120, v121, v122
  v_max3_u32 v110, v123, v124, v125
  v_max3_u32 v109, v109, v126, v127
  v_max_u32_e64 v109, v109, v110
  v_cmp_eq_u32 vcc, -1, v109
  s_cbranch_vccnz L_rslow_w0_h2_miss
L_rslow_w0_h2_got:
  s_xor_b32 s14, s14, 0x4000
  s_cmp_lt_u32 s70, 63
  s_cbranch_scc1 L_rslow
  s_branch L_rslow_last
L_rslow_w1:
  s_nop 15
  s_nop 15
  s_nop 15
  s_nop 15
  s_nop 15
  s_nop 15
  s_nop 15
  s_nop 15
  s_nop 15
  s_nop 15
  s_nop 15
  s_nop 0
  s_nop 12
  buffer_load_dwordx4 v[96:99], v0, s[4:7], s78 offen offset:0 sc1
  buffer_load_dwordx4 v[100:103], v0, s[4:7], s78 offen offset:1024 sc1
  ds_read_b128 v[104:107], v0 offset:30208
  v_add_u32_e64 v60, s83, v5
  ds_read_b64_tr_b16 v[62:63], v60 offset:10560
  ds_read_b64_tr_b16 v[60:61], v60 offset:10496
  ds_read_b128 v[64:67], v1 offset:0
  v_mov_b64_e64 v[16:17], 0
  ds_read_b128 v[68:71], v1 offset:1024
  v_mov_b64_e64 v[18:19], 0
  ds_read_b128 v[72:75], v1 offset:2048
  v_mov_b64_e64 v[20:21], 0
  ds_read_b128 v[76:79], v1 offset:3072
  v_mov_b64_e64 v[22:23], 0
  ds_read_b128 v[80:83], v1 offset:16384
  v_mov_b64_e64 v[32:33], 0
  ds_read_b128 v[84:87], v1 offset:17408
  v_mov_b64_e64 v[34:35], 0
  ds_read_b128 v[88:91], v1 offset:18432
  v_mov_b64_e64 v[36:37], 0
  ds_read_b128 v[92:95], v1 offset:19456
  v_mov_b64 v[38:39], 0
  v_mov_b64 v[24:25], 0
  v_mov_b64 v[26:27], 0
  v_mov_b64 v[56:57], -1
  v_mov_b64 v[58:59], -1
  s_nop 15
  s_nop 15
  s_nop 15
  s_nop 0
  s_nop 6
  buffer_load_dwordx4 v[112:115], v0, s[4:7], s78 offen offset:0 sc1
  buffer_load_dwordx4 v[116:119], v0, s[4:7], s78 offen offset:1024 sc1
  s_waitcnt lgkmcnt(10)
  s_waitcnt vmcnt(3)
  v_mfma_f32_16x16x32_bf16 v[108:111], v[104:107], v[96:99], 0
  s_waitcnt vmcnt(2)
  v_mfma_f32_16x16x32_bf16 v[108:111], v[104:107], v[100:103], v[108:111]
  s_nop 7
  v_add_f32_dpp v108, v108, v108 row_ror:4 row_mask:0xf bank_mask:0xf
  v_add_f32_dpp v109, v109, v109 row_ror:4 row_mask:0xf bank_mask:0xf
  v_cmp_u_f32_e64 vcc, v110, v110
  v_add_f32_dpp v108, v108, v108 row_ror:8 row_mask:0xf bank_mask:0xf
  v_add_f32_dpp v109, v109, v109 row_ror:8 row_mask:0xf bank_mask:0xf
  v_cvt_pk_bf16_f32 v108, v108, v109
  s_cbranch_vccnz L_rslow_w1_h1_miss
L_rslow_w1_h1_got:
  buffer_store_dword v108, v10, s[4:7], s76 offen sc1
  s_nop 15
  s_nop 15
  s_nop 15
  s_nop 15
  s_nop 15
  s_nop 15
  s_nop 15
  s_nop 15
  s_nop 15
  s_nop 15
  s_nop 15
  s_nop 15
  s_nop 15
  s_nop 15
  s_nop 0
  buffer_load_dwordx4 v[120:123], v0, s[4:7], s14 offen offset:0 sc1
  buffer_load_dwordx4 v[124:127], v0, s[4:7], s14 offen offset:1024 sc1
  s_xor_b32 s73, s73, 0x80000
  s_xor_b32 s76, s76, 0x4000
  s_add_u32 s72, s72, 0x8000
  s_add_u32 s70, s70, 1
  s_mov_b32 s25, s78
  s_xor_b32 s78, s78, 0x80000
  s_add_u32 s27, s70, 1
  s_add_u32 s26, s72, 0x8000
  s_min_u32 s27, s27, 63
  s_bitcmp1_b64 s[84:85], s27
  s_cbranch_scc0 L_rslow_w1_kv
L_rslow_w1_kv_ok:
  s_nop 15
  s_nop 15
  s_nop 15
  s_nop 15
  s_nop 15
  s_nop 3
  buffer_load_dwordx4 v[48:51], v0, s[4:7], s14 offen offset:0 sc1
  buffer_load_dwordx4 v[52:55], v0, s[4:7], s14 offen offset:1024 sc1
  s_waitcnt vmcnt(3)
  ds_write_b128 v3, v[120:123] offset:0
  s_waitcnt vmcnt(2)
  ds_write_b128 v3, v[124:127] offset:1024
  v_max3_u32 v109, v120, v121, v122
  v_max3_u32 v110, v123, v124, v125
  v_max3_u32 v109, v109, v126, v127
  v_max_u32_e64 v109, v109, v110
  v_cmp_eq_u32 vcc, -1, v109
  s_cbranch_vccnz L_rslow_w1_h2_miss
L_rslow_w1_h2_got:
  s_xor_b32 s14, s14, 0x4000
  s_cmp_lt_u32 s70, 63
  s_cbranch_scc1 L_rslow
  s_branch L_rslow_last
L_rslow_w2:
  s_nop 15
  s_nop 15
  s_nop 15
  s_nop 15
  s_nop 15
  s_nop 15
  s_nop 15
  s_nop 15
  s_nop 15
  s_nop 15
  s_nop 15
  s_nop 15
  s_nop 14
  buffer_load_dwordx4 v[96:99], v0, s[4:7], s78 offen offset:0 sc1
  buffer_load_dwordx4 v[100:103], v0, s[4:7], s78 offen offset:1024 sc1
  ds_read_b128 v[104:107], v0 offset:30208
  v_add_u32_e64 v60, s83, v5
  ds_read_b64_tr_b16 v[62:63], v60 offset:10560
  ds_read_b64_tr_b16 v[60:61], v60 offset:10496
  ds_read_b128 v[64:67], v1 offset:0
  v_mov_b64_e64 v[16:17], 0
  ds_read_b128 v[68:71], v1 offset:1024
  v_mov_b64_e64 v[18:19], 0
  ds_read_b128 v[72:75], v1 offset:2048
  v_mov_b64_e64 v[20:21], 0
  ds_read_b128 v[76:79], v1 offset:3072
  v_mov_b64_e64 v[22:23], 0
  ds_read_b128 v[80:83], v1 offset:16384
  v_mov_b64_e64 v[32:33], 0
  ds_read_b128 v[84:87], v1 offset:17408
  v_mov_b64_e64 v[34:35], 0
  ds_read_b128 v[88:91], v1 offset:18432
  v_mov_b64_e64 v[36:37], 0
  ds_read_b128 v[92:95], v1 offset:19456
  v_mov_b64 v[38:39], 0
  v_mov_b64 v[24:25], 0
  v_mov_b64 v[26:27], 0
  v_mov_b64 v[56:57], -1
  v_mov_b64 v[58:59], -1
  s_nop 15
  s_nop 15
  s_nop 15
  s_nop 0
  s_nop 6
  buffer_load_dwordx4 v[112:115], v0, s[4:7], s78 offen offset:0 sc1
  buffer_load_dwordx4 v[116:119], v0, s[4:7], s78 offen offset:1024 sc1
  s_waitcnt lgkmcnt(10)
  s_waitcnt vmcnt(3)
  v_mfma_f32_16x16x32_bf16 v[108:111], v[104:107], v[96:99], 0
  s_waitcnt vmcnt(2)
  v_mfma_f32_16x16x32_bf16 v[108:111], v[104:107], v[100:103], v[108:111]
  s_nop 7
  v_add_f32_dpp v108, v108, v108 row_ror:4 row_mask:0xf bank_mask:0xf
  v_add_f32_dpp v109, v109, v109 row_ror:4 row_mask:0xf bank_mask:0xf
  v_cmp_u_f32_e64 vcc, v110, v110
  v_add_f32_dpp v108, v108, v108 row_ror:8 row_mask:0xf bank_mask:0xf
  v_add_f32_dpp v109, v109, v109 row_ror:8 row_mask:0xf bank_mask:0xf
  v_cvt_pk_bf16_f32 v108, v108, v109
  s_cbranch_vccnz L_rslow_w2_h1_miss
L_rslow_w2_h1_got:
  buffer_store_dword v108, v10, s[4:7], s76 offen sc1
  s_nop 15
  s_nop 15
  s_nop 15
  s_nop 15
  s_nop 15
  s_nop 15
  s_nop 15
  s_nop 15
  s_nop 15
  s_nop 15
  s_nop 15
  s_nop 15
  s_nop 15
  s_nop 15
  s_nop 0
  buffer_load_dwordx4 v[120:123], v0, s[4:7], s14 offen offset:0 sc1
  buffer_load_dwordx4 v[124:127], v0, s[4:7], s14 offen offset:1024 sc1
  s_xor_b32 s73, s73, 0x80000
  s_xor_b32 s76, s76, 0x4000
  s_add_u32 s72, s72, 0x8000
  s_add_u32 s70, s70, 1
  s_mov_b32 s25, s78
  s_xor_b32 s78, s78, 0x80000
  s_add_u32 s27, s70, 1
  s_add_u32 s26, s72, 0x8000
  s_min_u32 s27, s27, 63
  s_bitcmp1_b64 s[84:85], s27
  s_cbranch_scc0 L_rslow_w2_kv
L_rslow_w2_kv_ok:
  s_nop 15
  s_nop 15
  s_nop 15
  s_nop 15
  s_nop 15
  s_nop 3
  buffer_load_dwordx4 v[48:51], v0, s[4:7], s14 offen offset:0 sc1
  buffer_load_dwordx4 v[52:55], v0, s[4:7], s14 offen offset:1024 sc1
  s_waitcnt vmcnt(3)
  ds_write_b128 v3, v[120:123] offset:0
  s_waitcnt vmcnt(2)
  ds_write_b128 v3, v[124:127] offset:1024
  v_max3_u32 v109, v120, v121, v122
  v_max3_u32 v110, v123, v124, v125
  v_max3_u32 v109, v109, v126, v127
  v_max_u32_e64 v109, v109, v110
  v_cmp_eq_u32 vcc, -1, v109
  s_cbranch_vccnz L_rslow_w2_h2_miss
L_rslow_w2_h2_got:
  s_xor_b32 s14, s14, 0x4000
  s_cmp_lt_u32 s70, 63
  s_cbranch_scc1 L_rslow
  s_branch L_rslow_last
L_rslow_w3:
  s_nop 15
  s_nop 15
  s_nop 15
  s_nop 15
  s_nop 15
  s_nop 15
  s_nop 15
  s_nop 15
  s_nop 15
  s_nop 15
  s_nop 15
  s_nop 15
  s_nop 15
  s_nop 15
  s_nop 0
  buffer_load_dwordx4 v[96:99], v0, s[4:7], s78 offen offset:0 sc1
  buffer_load_dwordx4 v[100:103], v0, s[4:7], s78 offen offset:1024 sc1
  ds_read_b128 v[104:107], v0 offset:30208
  v_add_u32_e64 v60, s83, v5
  ds_read_b64_tr_b16 v[62:63], v60 offset:10560
  ds_read_b64_tr_b16 v[60:61], v60 offset:10496
  ds_read_b128 v[64:67], v1 offset:0
  v_mov_b64_e64 v[16:17], 0
  ds_read_b128 v[68:71], v1 offset:1024
  v_mov_b64_e64 v[18:19], 0
  ds_read_b128 v[72:75], v1 offset:2048
  v_mov_b64_e64 v[20:21], 0
  ds_read_b128 v[76:79], v1 offset:3072
  v_mov_b64_e64 v[22:23], 0
  ds_read_b128 v[80:83], v1 offset:16384
  v_mov_b64_e64 v[32:33], 0
  ds_read_b128 v[84:87], v1 offset:17408
  v_mov_b64_e64 v[34:35], 0
  ds_read_b128 v[88:91], v1 offset:18432
  v_mov_b64_e64 v[36:37], 0
  ds_read_b128 v[92:95], v1 offset:19456
  v_mov_b64 v[38:39], 0
  v_mov_b64 v[24:25], 0
  v_mov_b64 v[26:27], 0
  v_mov_b64 v[56:57], -1
  v_mov_b64 v[58:59], -1
  s_nop 15
  s_nop 15
  s_nop 15
  s_nop 0
  s_nop 6
  buffer_load_dwordx4 v[112:115], v0, s[4:7], s78 offen offset:0 sc1
  buffer_load_dwordx4 v[116:119], v0, s[4:7], s78 offen offset:1024 sc1
  s_waitcnt lgkmcnt(10)
  s_waitcnt vmcnt(3)
  v_mfma_f32_16x16x32_bf16 v[108:111], v[104:107], v[96:99], 0
  s_waitcnt vmcnt(2)
  v_mfma_f32_16x16x32_bf16 v[108:111], v[104:107], v[100:103], v[108:111]
  s_nop 7
  v_add_f32_dpp v108, v108, v108 row_ror:4 row_mask:0xf bank_mask:0xf
  v_add_f32_dpp v109, v109, v109 row_ror:4 row_mask:0xf bank_mask:0xf
  v_cmp_u_f32_e64 vcc, v110, v110
  v_add_f32_dpp v108, v108, v108 row_ror:8 row_mask:0xf bank_mask:0xf
  v_add_f32_dpp v109, v109, v109 row_ror:8 row_mask:0xf bank_mask:0xf
  v_cvt_pk_bf16_f32 v108, v108, v109
  s_cbranch_vccnz L_rslow_w3_h1_miss
L_rslow_w3_h1_got:
  buffer_store_dword v108, v10, s[4:7], s76 offen sc1
  s_nop 15
  s_nop 15
  s_nop 15
  s_nop 15
  s_nop 15
  s_nop 15
  s_nop 15
  s_nop 15
  s_nop 15
  s_nop 15
  s_nop 15
  s_nop 15
  s_nop 15
  s_nop 15
  s_nop 0
  buffer_load_dwordx4 v[120:123], v0, s[4:7], s14 offen offset:0 sc1
  buffer_load_dwordx4 v[124:127], v0, s[4:7], s14 offen offset:1024 sc1
  s_xor_b32 s73, s73, 0x80000
  s_xor_b32 s76, s76, 0x4000
  s_add_u32 s72, s72, 0x8000
  s_add_u32 s70, s70, 1
  s_mov_b32 s25, s78
  s_xor_b32 s78, s78, 0x80000
  s_add_u32 s27, s70, 1
  s_add_u32 s26, s72, 0x8000
  s_min_u32 s27, s27, 63
  s_bitcmp1_b64 s[84:85], s27
  s_cbranch_scc0 L_rslow_w3_kv
L_rslow_w3_kv_ok:
  s_nop 15
  s_nop 15
  s_nop 15
  s_nop 15
  s_nop 15
  s_nop 3
  buffer_load_dwordx4 v[48:51], v0, s[4:7], s14 offen offset:0 sc1
  buffer_load_dwordx4 v[52:55], v0, s[4:7], s14 offen offset:1024 sc1
  s_waitcnt vmcnt(3)
  ds_write_b128 v3, v[120:123] offset:0
  s_waitcnt vmcnt(2)
  ds_write_b128 v3, v[124:127] offset:1024
  v_max3_u32 v109, v120, v121, v122
  v_max3_u32 v110, v123, v124, v125
  v_max3_u32 v109, v109, v126, v127
  v_max_u32 v109, v109, v110
  v_cmp_eq_u32 vcc, -1, v109
  s_cbranch_vccnz L_rslow_w3_h2_miss
L_rslow_w3_h2_got:
  s_xor_b32 s14, s14, 0x4000
  s_cmp_lt_u32 s70, 63
  s_cbranch_scc1 L_rslow
  s_branch L_rslow_last
L_rslow_max:
  v_mov_b32_dpp v60, v60 quad_perm:[0,1,0,1] row_mask:0xf bank_mask:0xf
  v_mov_b32_dpp v61, v61 quad_perm:[0,1,0,1] row_mask:0xf bank_mask:0xf
  v_max3_f32 v62, v56, v57, v58
  v_max3_f32 v63, v59, v60, v61
  v_max_f32 v62, v62, v63
  s_nop 1
  v_max_f32_dpp v62, v62, v62 quad_perm:[2,3,0,1] row_mask:0xf bank_mask:0xf
  v_mov_b32 v63, v62
  s_nop 1
  v_permlane16_swap_b32 v62, v63
  v_max_f32 v62, v62, v63
  v_mov_b32 v63, v62
  s_nop 1
  v_permlane32_swap_b32 v62, v63
  v_max_f32 v62, v62, v63
  v_sub_f32 v56, v56, v62
  v_exp_f32 v56, v56
  v_sub_f32 v57, v57, v62
  v_exp_f32 v57, v57
  v_sub_f32 v58, v58, v62
  v_exp_f32 v58, v58
  v_sub_f32 v59, v59, v62
  v_exp_f32 v59, v59
  v_sub_f32 v60, v60, v62
  v_exp_f32 v60, v60
  v_sub_f32 v61, v61, v62
  v_exp_f32 v61, v61
  v_cvt_pk_bf16_f32 v16, v56, v57
  v_cvt_pk_bf16_f32 v17, v58, v59
  v_cvt_pk_bf16_f32 v78, v60, v61
  v_mov_b32_dpp v18, v16 quad_perm:[2,3,0,1] row_mask:0xf bank_mask:0xf
  v_mov_b32_dpp v19, v17 quad_perm:[2,3,0,1] row_mask:0xf bank_mask:0xf
  s_nop 0
  s_nop 0
  v_mfma_f32_16x16x32_bf16 v[68:71], v[64:67], v[16:19], 0
  v_mfma_f32_16x16x32_bf16 v[32:35], v[48:51], v[16:19], 0
  v_mfma_f32_16x16x32_bf16 v[36:39], v[52:55], v[16:19], 0
  v_mfma_f32_16x16x32_bf16 v[68:71], v[64:67], v[78:81], v[68:71]
  v_mfma_f32_16x16x32_bf16 v[32:35], v[28:31], v[78:81], v[32:35]
  v_mfma_f32_16x16x32_bf16 v[36:39], v[28:31], v[76:79], v[36:39]
  s_nop 0
  s_nop 6
  s_branch L_rslow_pv
L_rslow_w0_h1_miss:
  s_mov_b64 exec, vcc
  buffer_load_dwordx4 v[96:99], v0, s[4:7], s78 offen offset:0 sc1
  buffer_load_dwordx4 v[100:103], v0, s[4:7], s78 offen offset:1024 sc1
  s_mov_b64 exec, -1
  s_waitcnt vmcnt(3)
  v_mfma_f32_16x16x32_bf16 v[108:111], v[104:107], v[112:115], 0
  s_waitcnt vmcnt(2)
  v_mfma_f32_16x16x32_bf16 v[108:111], v[104:107], v[116:119], v[108:111]
  s_nop 7
  v_add_f32_dpp v108, v108, v108 row_ror:4 row_mask:0xf bank_mask:0xf
  v_add_f32_dpp v109, v109, v109 row_ror:4 row_mask:0xf bank_mask:0xf
  v_cmp_u_f32 vcc, v110, v110
  v_add_f32_dpp v108, v108, v108 row_ror:8 row_mask:0xf bank_mask:0xf
  v_add_f32_dpp v109, v109, v109 row_ror:8 row_mask:0xf bank_mask:0xf
  v_cvt_pk_bf16_f32 v108, v108, v109
  s_cbranch_vccz L_rslow_w0_h1_got
  v_max3_u32 v120, v112, v113, v114
  v_max3_u32 v121, v115, v116, v117
  v_max3_u32 v120, v120, v118, v119
  v_max_u32 v120, v120, v121
  v_cmp_eq_u32 vcc, -1, v120
  s_cbranch_vccz L_rslow_w0_h1_got
  s_mov_b64 exec, vcc
  buffer_load_dwordx4 v[112:115], v0, s[4:7], s78 offen offset:0 sc1
  buffer_load_dwordx4 v[116:119], v0, s[4:7], s78 offen offset:1024 sc1
  s_mov_b64 exec, -1
  s_waitcnt vmcnt(3)
  v_mfma_f32_16x16x32_bf16 v[108:111], v[104:107], v[96:99], 0
  s_waitcnt vmcnt(2)
  v_mfma_f32_16x16x32_bf16 v[108:111], v[104:107], v[100:103], v[108:111]
  s_nop 7
  v_add_f32_dpp v108, v108, v108 row_ror:4 row_mask:0xf bank_mask:0xf
  v_add_f32_dpp v109, v109, v109 row_ror:4 row_mask:0xf bank_mask:0xf
  v_cmp_u_f32_e64 vcc, v110, v110
  v_add_f32_dpp v108, v108, v108 row_ror:8 row_mask:0xf bank_mask:0xf
  v_add_f32_dpp v109, v109, v109 row_ror:8 row_mask:0xf bank_mask:0xf
  v_cvt_pk_bf16_f32 v108, v108, v109
  s_cbranch_vccz L_rslow_w0_h1_got
  s_add_u32 s23, s23, 1
  s_cmp_lt_u32 s23, 0x40000
  s_cbranch_scc1 L_rslow_w0_h1_miss
  s_branch L_exit
L_rslow_w0_kv:
  v_lshrrev_b32 v109, 2, v0
L_rslow_w0_kv_p:
  buffer_load_dword v11, v109, s[4:7], s82 offen sc1
  s_waitcnt vmcnt(0)
  v_cmp_eq_u32 s[84:85], 1, v11
  s_nop 0
  s_bitcmp1_b64 s[84:85], s27
  s_cbranch_scc1 L_rslow_w0_kv_ok
  s_add_u32 s23, s23, 1
  s_cmp_lt_u32 s23, 0x40000
  s_cbranch_scc1 L_rslow_w0_kv_p
  s_branch L_exit
L_rslow_w0_h2_miss:
  s_mov_b64 exec, vcc
  buffer_load_dwordx4 v[120:123], v0, s[4:7], s14 offen offset:0 sc1
  buffer_load_dwordx4 v[124:127], v0, s[4:7], s14 offen offset:1024 sc1
  s_mov_b64 exec, -1
  s_waitcnt vmcnt(3)
  ds_write_b128 v3, v[48:51] offset:0
  s_waitcnt vmcnt(2)
  ds_write_b128 v3, v[52:55] offset:1024
  v_max3_u32 v109, v48, v49, v50
  v_max3_u32 v110, v51, v52, v53
  v_max3_u32 v109, v109, v54, v55
  v_max_u32_e64 v109, v109, v110
  v_cmp_eq_u32 vcc, -1, v109
  s_cbranch_vccz L_rslow_w0_h2_got
  s_mov_b64 exec, vcc
  buffer_load_dwordx4 v[48:51], v0, s[4:7], s14 offen offset:0 sc1
  buffer_load_dwordx4 v[52:55], v0, s[4:7], s14 offen offset:1024 sc1
  s_mov_b64 exec, -1
  s_waitcnt vmcnt(3)
  ds_write_b128 v3, v[120:123] offset:0
  s_waitcnt vmcnt(2)
  ds_write_b128 v3, v[124:127] offset:1024
  v_max3_u32 v109, v120, v121, v122
  v_max3_u32 v110, v123, v124, v125
  v_max3_u32 v109, v109, v126, v127
  v_max_u32_e64 v109, v109, v110
  v_cmp_eq_u32 vcc, -1, v109
  s_cbranch_vccz L_rslow_w0_h2_got
  s_add_u32 s23, s23, 1
  s_cmp_lt_u32 s23, 0x40000
  s_cbranch_scc1 L_rslow_w0_h2_miss
  s_branch L_exit
L_rslow_w1_h1_miss:
  s_mov_b64 exec, vcc
  buffer_load_dwordx4 v[96:99], v0, s[4:7], s78 offen offset:0 sc1
  buffer_load_dwordx4 v[100:103], v0, s[4:7], s78 offen offset:1024 sc1
  s_mov_b64 exec, -1
  s_waitcnt vmcnt(3)
  v_mfma_f32_16x16x32_bf16 v[108:111], v[104:107], v[112:115], 0
  s_waitcnt vmcnt(2)
  v_mfma_f32_16x16x32_bf16 v[108:111], v[104:107], v[116:119], v[108:111]
  s_nop 7
  v_add_f32_dpp v108, v108, v108 row_ror:4 row_mask:0xf bank_mask:0xf
  v_add_f32_dpp v109, v109, v109 row_ror:4 row_mask:0xf bank_mask:0xf
  v_cmp_u_f32 vcc, v110, v110
  v_add_f32_dpp v108, v108, v108 row_ror:8 row_mask:0xf bank_mask:0xf
  v_add_f32_dpp v109, v109, v109 row_ror:8 row_mask:0xf bank_mask:0xf
  v_cvt_pk_bf16_f32 v108, v108, v109
  s_cbranch_vccz L_rslow_w1_h1_got
  v_max3_u32 v120, v112, v113, v114
  v_max3_u32 v121, v115, v116, v117
  v_max3_u32 v120, v120, v118, v119
  v_max_u32 v120, v120, v121
  v_cmp_eq_u32 vcc, -1, v120
  s_cbranch_vccz L_rslow_w1_h1_got
  s_mov_b64 exec, vcc
  buffer_load_dwordx4 v[112:115], v0, s[4:7], s78 offen offset:0 sc1
  buffer_load_dwordx4 v[116:119], v0, s[4:7], s78 offen offset:1024 sc1
  s_mov_b64 exec, -1
  s_waitcnt vmcnt(3)
  v_mfma_f32_16x16x32_bf16 v[108:111], v[104:107], v[96:99], 0
  s_waitcnt vmcnt(2)
  v_mfma_f32_16x16x32_bf16 v[108:111], v[104:107], v[100:103], v[108:111]
  s_nop 7
  v_add_f32_dpp v108, v108, v108 row_ror:4 row_mask:0xf bank_mask:0xf
  v_add_f32_dpp v109, v109, v109 row_ror:4 row_mask:0xf bank_mask:0xf
  v_cmp_u_f32_e64 vcc, v110, v110
  v_add_f32_dpp v108, v108, v108 row_ror:8 row_mask:0xf bank_mask:0xf
  v_add_f32_dpp v109, v109, v109 row_ror:8 row_mask:0xf bank_mask:0xf
  v_cvt_pk_bf16_f32 v108, v108, v109
  s_cbranch_vccz L_rslow_w1_h1_got
  s_add_u32 s23, s23, 1
  s_cmp_lt_u32 s23, 0x40000
  s_cbranch_scc1 L_rslow_w1_h1_miss
  s_branch L_exit
L_rslow_w1_kv:
  v_lshrrev_b32 v109, 2, v0
L_rslow_w1_kv_p:
  buffer_load_dword v11, v109, s[4:7], s82 offen sc1
  s_waitcnt vmcnt(0)
  v_cmp_eq_u32 s[84:85], 1, v11
  s_nop 0
  s_bitcmp1_b64 s[84:85], s27
  s_cbranch_scc1 L_rslow_w1_kv_ok
  s_add_u32 s23, s23, 1
  s_cmp_lt_u32 s23, 0x40000
  s_cbranch_scc1 L_rslow_w1_kv_p
  s_branch L_exit
L_rslow_w1_h2_miss:
  s_mov_b64 exec, vcc
  buffer_load_dwordx4 v[120:123], v0, s[4:7], s14 offen offset:0 sc1
  buffer_load_dwordx4 v[124:127], v0, s[4:7], s14 offen offset:1024 sc1
  s_mov_b64 exec, -1
  s_waitcnt vmcnt(3)
  ds_write_b128 v3, v[48:51] offset:0
  s_waitcnt vmcnt(2)
  ds_write_b128 v3, v[52:55] offset:1024
  v_max3_u32 v109, v48, v49, v50
  v_max3_u32 v110, v51, v52, v53
  v_max3_u32 v109, v109, v54, v55
  v_max_u32_e64 v109, v109, v110
  v_cmp_eq_u32 vcc, -1, v109
  s_cbranch_vccz L_rslow_w1_h2_got
  s_mov_b64 exec, vcc
  buffer_load_dwordx4 v[48:51], v0, s[4:7], s14 offen offset:0 sc1
  buffer_load_dwordx4 v[52:55], v0, s[4:7], s14 offen offset:1024 sc1
  s_mov_b64 exec, -1
  s_waitcnt vmcnt(3)
  ds_write_b128 v3, v[120:123] offset:0
  s_waitcnt vmcnt(2)
  ds_write_b128 v3, v[124:127] offset:1024
  v_max3_u32 v109, v120, v121, v122
  v_max3_u32 v110, v123, v124, v125
  v_max3_u32 v109, v109, v126, v127
  v_max_u32_e64 v109, v109, v110
  v_cmp_eq_u32 vcc, -1, v109
  s_cbranch_vccz L_rslow_w1_h2_got
  s_add_u32 s23, s23, 1
  s_cmp_lt_u32 s23, 0x40000
  s_cbranch_scc1 L_rslow_w1_h2_miss
  s_branch L_exit
L_rslow_w2_h1_miss:
  s_mov_b64 exec, vcc
  buffer_load_dwordx4 v[96:99], v0, s[4:7], s78 offen offset:0 sc1
  buffer_load_dwordx4 v[100:103], v0, s[4:7], s78 offen offset:1024 sc1
  s_mov_b64 exec, -1
  s_waitcnt vmcnt(3)
  v_mfma_f32_16x16x32_bf16 v[108:111], v[104:107], v[112:115], 0
  s_waitcnt vmcnt(2)
  v_mfma_f32_16x16x32_bf16 v[108:111], v[104:107], v[116:119], v[108:111]
  s_nop 7
  v_add_f32_dpp v108, v108, v108 row_ror:4 row_mask:0xf bank_mask:0xf
  v_add_f32_dpp v109, v109, v109 row_ror:4 row_mask:0xf bank_mask:0xf
  v_cmp_u_f32 vcc, v110, v110
  v_add_f32_dpp v108, v108, v108 row_ror:8 row_mask:0xf bank_mask:0xf
  v_add_f32_dpp v109, v109, v109 row_ror:8 row_mask:0xf bank_mask:0xf
  v_cvt_pk_bf16_f32 v108, v108, v109
  s_cbranch_vccz L_rslow_w2_h1_got
  v_max3_u32 v120, v112, v113, v114
  v_max3_u32 v121, v115, v116, v117
  v_max3_u32 v120, v120, v118, v119
  v_max_u32 v120, v120, v121
  v_cmp_eq_u32 vcc, -1, v120
  s_cbranch_vccz L_rslow_w2_h1_got
  s_mov_b64 exec, vcc
  buffer_load_dwordx4 v[112:115], v0, s[4:7], s78 offen offset:0 sc1
  buffer_load_dwordx4 v[116:119], v0, s[4:7], s78 offen offset:1024 sc1
  s_mov_b64 exec, -1
  s_waitcnt vmcnt(3)
  v_mfma_f32_16x16x32_bf16 v[108:111], v[104:107], v[96:99], 0
  s_waitcnt vmcnt(2)
  v_mfma_f32_16x16x32_bf16 v[108:111], v[104:107], v[100:103], v[108:111]
  s_nop 7
  v_add_f32_dpp v108, v108, v108 row_ror:4 row_mask:0xf bank_mask:0xf
  v_add_f32_dpp v109, v109, v109 row_ror:4 row_mask:0xf bank_mask:0xf
  v_cmp_u_f32_e64 vcc, v110, v110
  v_add_f32_dpp v108, v108, v108 row_ror:8 row_mask:0xf bank_mask:0xf
  v_add_f32_dpp v109, v109, v109 row_ror:8 row_mask:0xf bank_mask:0xf
  v_cvt_pk_bf16_f32 v108, v108, v109
  s_cbranch_vccz L_rslow_w2_h1_got
  s_add_u32 s23, s23, 1
  s_cmp_lt_u32 s23, 0x40000
  s_cbranch_scc1 L_rslow_w2_h1_miss
  s_branch L_exit
L_rslow_w2_kv:
  v_lshrrev_b32 v109, 2, v0
L_rslow_w2_kv_p:
  buffer_load_dword v11, v109, s[4:7], s82 offen sc1
  s_waitcnt vmcnt(0)
  v_cmp_eq_u32 s[84:85], 1, v11
  s_nop 0
  s_bitcmp1_b64 s[84:85], s27
  s_cbranch_scc1 L_rslow_w2_kv_ok
  s_add_u32 s23, s23, 1
  s_cmp_lt_u32 s23, 0x40000
  s_cbranch_scc1 L_rslow_w2_kv_p
  s_branch L_exit
L_rslow_w2_h2_miss:
  s_mov_b64 exec, vcc
  buffer_load_dwordx4 v[120:123], v0, s[4:7], s14 offen offset:0 sc1
  buffer_load_dwordx4 v[124:127], v0, s[4:7], s14 offen offset:1024 sc1
  s_mov_b64 exec, -1
  s_waitcnt vmcnt(3)
  ds_write_b128 v3, v[48:51] offset:0
  s_waitcnt vmcnt(2)
  ds_write_b128 v3, v[52:55] offset:1024
  v_max3_u32 v109, v48, v49, v50
  v_max3_u32 v110, v51, v52, v53
  v_max3_u32 v109, v109, v54, v55
  v_max_u32_e64 v109, v109, v110
  v_cmp_eq_u32 vcc, -1, v109
  s_cbranch_vccz L_rslow_w2_h2_got
  s_mov_b64 exec, vcc
  buffer_load_dwordx4 v[48:51], v0, s[4:7], s14 offen offset:0 sc1
  buffer_load_dwordx4 v[52:55], v0, s[4:7], s14 offen offset:1024 sc1
  s_mov_b64 exec, -1
  s_waitcnt vmcnt(3)
  ds_write_b128 v3, v[120:123] offset:0
  s_waitcnt vmcnt(2)
  ds_write_b128 v3, v[124:127] offset:1024
  v_max3_u32 v109, v120, v121, v122
  v_max3_u32 v110, v123, v124, v125
  v_max3_u32 v109, v109, v126, v127
  v_max_u32_e64 v109, v109, v110
  v_cmp_eq_u32 vcc, -1, v109
  s_cbranch_vccz L_rslow_w2_h2_got
  s_add_u32 s23, s23, 1
  s_cmp_lt_u32 s23, 0x40000
  s_cbranch_scc1 L_rslow_w2_h2_miss
  s_branch L_exit
L_rslow_w3_h1_miss:
  s_mov_b64 exec, vcc
  buffer_load_dwordx4 v[96:99], v0, s[4:7], s78 offen offset:0 sc1
  buffer_load_dwordx4 v[100:103], v0, s[4:7], s78 offen offset:1024 sc1
  s_mov_b64 exec, -1
  s_waitcnt vmcnt(3)
  v_mfma_f32_16x16x32_bf16 v[108:111], v[104:107], v[112:115], 0
  s_waitcnt vmcnt(2)
  v_mfma_f32_16x16x32_bf16 v[108:111], v[104:107], v[116:119], v[108:111]
  s_nop 7
  v_add_f32_dpp v108, v108, v108 row_ror:4 row_mask:0xf bank_mask:0xf
  v_add_f32_dpp v109, v109, v109 row_ror:4 row_mask:0xf bank_mask:0xf
  v_cmp_u_f32 vcc, v110, v110
  v_add_f32_dpp v108, v108, v108 row_ror:8 row_mask:0xf bank_mask:0xf
  v_add_f32_dpp v109, v109, v109 row_ror:8 row_mask:0xf bank_mask:0xf
  v_cvt_pk_bf16_f32 v108, v108, v109
  s_cbranch_vccz L_rslow_w3_h1_got
  v_max3_u32 v120, v112, v113, v114
  v_max3_u32 v121, v115, v116, v117
  v_max3_u32 v120, v120, v118, v119
  v_max_u32 v120, v120, v121
  v_cmp_eq_u32 vcc, -1, v120
  s_cbranch_vccz L_rslow_w3_h1_got
  s_mov_b64 exec, vcc
  buffer_load_dwordx4 v[112:115], v0, s[4:7], s78 offen offset:0 sc1
  buffer_load_dwordx4 v[116:119], v0, s[4:7], s78 offen offset:1024 sc1
  s_mov_b64 exec, -1
  s_waitcnt vmcnt(3)
  v_mfma_f32_16x16x32_bf16 v[108:111], v[104:107], v[96:99], 0
  s_waitcnt vmcnt(2)
  v_mfma_f32_16x16x32_bf16 v[108:111], v[104:107], v[100:103], v[108:111]
  s_nop 7
  v_add_f32_dpp v108, v108, v108 row_ror:4 row_mask:0xf bank_mask:0xf
  v_add_f32_dpp v109, v109, v109 row_ror:4 row_mask:0xf bank_mask:0xf
  v_cmp_u_f32_e64 vcc, v110, v110
  v_add_f32_dpp v108, v108, v108 row_ror:8 row_mask:0xf bank_mask:0xf
  v_add_f32_dpp v109, v109, v109 row_ror:8 row_mask:0xf bank_mask:0xf
  v_cvt_pk_bf16_f32 v108, v108, v109
  s_cbranch_vccz L_rslow_w3_h1_got
  s_add_u32 s23, s23, 1
  s_cmp_lt_u32 s23, 0x40000
  s_cbranch_scc1 L_rslow_w3_h1_miss
  s_branch L_exit
L_rslow_w3_kv:
  v_lshrrev_b32 v109, 2, v0
L_rslow_w3_kv_p:
  buffer_load_dword v11, v109, s[4:7], s82 offen sc1
  s_waitcnt vmcnt(0)
  v_cmp_eq_u32 s[84:85], 1, v11
  s_nop 0
  s_bitcmp1_b64 s[84:85], s27
  s_cbranch_scc1 L_rslow_w3_kv_ok
  s_add_u32 s23, s23, 1
  s_cmp_lt_u32 s23, 0x40000
  s_cbranch_scc1 L_rslow_w3_kv_p
  s_branch L_exit
L_rslow_w3_h2_miss:
  s_mov_b64 exec, vcc
  buffer_load_dwordx4 v[120:123], v0, s[4:7], s14 offen offset:0 sc1
  buffer_load_dwordx4 v[124:127], v0, s[4:7], s14 offen offset:1024 sc1
  s_mov_b64 exec, -1
  s_waitcnt vmcnt(3)
  ds_write_b128 v3, v[48:51] offset:0
  s_waitcnt vmcnt(2)
  ds_write_b128 v3, v[52:55] offset:1024
  v_max3_u32 v109, v48, v49, v50
  v_max3_u32 v110, v51, v52, v53
  v_max3_u32 v109, v109, v54, v55
  v_max_u32_e64 v109, v109, v110
  v_cmp_eq_u32 vcc, -1, v109
  s_cbranch_vccz L_rslow_w3_h2_got
  s_mov_b64 exec, vcc
  buffer_load_dwordx4 v[48:51], v0, s[4:7], s14 offen offset:0 sc1
  buffer_load_dwordx4 v[52:55], v0, s[4:7], s14 offen offset:1024 sc1
  s_mov_b64 exec, -1
  s_waitcnt vmcnt(3)
  ds_write_b128 v3, v[120:123] offset:0
  s_waitcnt vmcnt(2)
  ds_write_b128 v3, v[124:127] offset:1024
  v_max3_u32 v109, v120, v121, v122
  v_max3_u32 v110, v123, v124, v125
  v_max3_u32 v109, v109, v126, v127
  v_max_u32_e64 v109, v109, v110
  v_cmp_eq_u32 vcc, -1, v109
  s_cbranch_vccz L_rslow_w3_h2_got
  s_add_u32 s23, s23, 1
  s_cmp_lt_u32 s23, 0x40000
  s_cbranch_scc1 L_rslow_w3_h2_miss
  s_branch L_exit
L_rslow_last:
  s_waitcnt lgkmcnt(0)
  s_barrier
  s_waitcnt vmcnt(0)
  ds_read_b128 v[96:99], v0 offset:0
  ds_read_b128 v[100:103], v0 offset:1024
  ds_read_b128 v[104:107], v0 offset:2048
  ds_read_b128 v[108:111], v0 offset:3072
  ds_read_b128 v[112:115], v0 offset:4096
  ds_read_b128 v[116:119], v0 offset:5120
  ds_read_b128 v[120:123], v0 offset:6144
  ds_read_b128 v[124:127], v0 offset:7168
  buffer_store_dwordx4 v[28:31], v15, s[4:7], s79 offen offset:2048 sc1
  buffer_store_dwordx4 v[60:63], v13, s[4:7], s79 offen sc1
  s_add_u32 s79, s72, 0x4000
  v_mov_b64 v[28:29], 0
  v_mov_b64 v[30:31], 0
  ds_read_b128 v[64:67], v1 offset:32768
  ds_read_b128 v[68:71], v1 offset:33792
  ds_read_b128 v[72:75], v1 offset:34816
  ds_read_b128 v[76:79], v1 offset:35840
  ds_read_b128 v[80:83], v1 offset:49152
  ds_read_b128 v[84:87], v1 offset:50176
  ds_read_b128 v[88:91], v1 offset:51200
  ds_read_b128 v[92:95], v1 offset:52224
  s_waitcnt lgkmcnt(15)
  v_smfmac_f32_16x16x64_bf16 v[24:27], v[96:99], a[96:103], v14
  v_smfmac_f32_16x16x64_bf16 v[28:31], v[96:99], a[104:111], v14
  s_waitcnt lgkmcnt(14)
  v_smfmac_f32_16x16x64_bf16 v[24:27], v[100:103], a[112:119], v14
  v_smfmac_f32_16x16x64_bf16 v[28:31], v[100:103], a[120:127], v14
  s_waitcnt lgkmcnt(11)
  v_smfmac_f32_16x16x64_bf16 v[24:27], v[112:115], a[128:135], v14
  v_smfmac_f32_16x16x64_bf16 v[28:31], v[112:115], a[136:143], v14
  s_waitcnt lgkmcnt(10)
  v_smfmac_f32_16x16x64_bf16 v[24:27], v[116:119], a[144:151], v14
  v_smfmac_f32_16x16x64_bf16 v[28:31], v[116:119], a[152:159], v14
  s_waitcnt lgkmcnt(9)
  v_smfmac_f32_16x16x64_bf16 v[24:27], v[120:123], a[160:167], v14
  v_smfmac_f32_16x16x64_bf16 v[28:31], v[120:123], a[168:175], v14
  s_waitcnt lgkmcnt(8)
  v_smfmac_f32_16x16x64_bf16 v[24:27], v[124:127], a[176:183], v14
  v_smfmac_f32_16x16x64_bf16 v[28:31], v[124:127], a[184:191], v14
  s_waitcnt lgkmcnt(4)
  v_smfmac_f32_16x16x64_bf16 v[24:27], v[104:107], v[64:71], v14
  v_smfmac_f32_16x16x64_bf16 v[28:31], v[104:107], v[72:79], v14
  s_waitcnt lgkmcnt(0)
  v_smfmac_f32_16x16x64_bf16 v[24:27], v[108:111], v[80:87], v14
  v_smfmac_f32_16x16x64_bf16 v[28:31], v[108:111], v[88:95], v14
  v_smfmac_f32_16x16x64_bf16 v[32:35], v[96:99], v[160:167], v14
  ds_read_b128 v[64:67], v2 offset:0
  ds_read_b128 v[68:71], v2 offset:1024
  v_smfmac_f32_16x16x64_bf16 v[36:39], v[96:99], v[168:175], v14
  ds_read_b128 v[72:75], v2 offset:2048
  ds_read_b128 v[76:79], v2 offset:3072
  v_smfmac_f32_16x16x64_bf16 v[32:35], v[100:103], v[176:183], v14
  ds_read_b128 v[80:83], v2 offset:16384
  ds_read_b128 v[84:87], v2 offset:17408
  v_smfmac_f32_16x16x64_bf16 v[36:39], v[100:103], v[184:191], v14
  ds_read_b128 v[88:91], v2 offset:18432
  ds_read_b128 v[92:95], v2 offset:19456
  v_add_f32_e64 v24, v24, v26
  v_smfmac_f32_16x16x64_bf16 v[32:35], v[104:107], v[192:199], v14
  v_add_f32_e64 v25, v25, v27
  v_cvt_pk_bf16_f32 v26, v24, v25
  v_smfmac_f32_16x16x64_bf16 v[36:39], v[104:107], v[200:207], v14
  v_add_f32 v28, v28, v30
  v_add_f32 v29, v29, v31
  v_smfmac_f32_16x16x64_bf16 v[32:35], v[108:111], v[208:215], v14
  v_cvt_pk_bf16_f32 v27, v28, v29
  v_smfmac_f32_16x16x64_bf16 v[36:39], v[108:111], v[216:223], v14
  ds_write2st64_b32 v4, v26, v27 offset0:41 offset1:42
  v_add_u32_e64 v60, s83, v5
  v_smfmac_f32_16x16x64_bf16 v[32:35], v[112:115], v[224:231], v14
  ds_read_b64_tr_b16 v[62:63], v60 offset:10560
  ds_read_b64_tr_b16 v[60:61], v60 offset:10496
  v_smfmac_f32_16x16x64_bf16 v[36:39], v[112:115], v[232:239], v14
  v_smfmac_f32_16x16x64_bf16 v[32:35], v[116:119], v[240:247], v14
  v_smfmac_f32_16x16x64_bf16 v[36:39], v[116:119], v[248:255], v14
  s_waitcnt lgkmcnt(3)
  v_smfmac_f32_16x16x64_bf16 v[32:35], v[120:123], v[64:71], v14
  v_smfmac_f32_16x16x64_bf16 v[36:39], v[120:123], v[72:79], v14
  v_smfmac_f32_16x16x64_bf16 v[32:35], v[124:127], v[80:87], v14
  v_smfmac_f32_16x16x64_bf16 v[36:39], v[124:127], v[88:95], v14
  s_waitcnt lgkmcnt(0)
  buffer_store_dwordx4 v[60:63], v13, s[4:7], s79 offen sc1
  s_nop 4
  v_add_f32 v32, v32, v34
  v_add_f32_e64 v33, v33, v35
  v_cvt_pk_bf16_f32 v28, v32, v33
  v_pk_add_f32 v[36:37], v[36:37], v[38:39]
  v_cvt_pk_bf16_f32 v30, v36, v37
  buffer_store_dwordx4 v[28:31], v15, s[4:7], s79 offen offset:2048 sc1
  s_branch L_exit
L_follower:
  s_and_b32 s24, s2, 7
  s_sub_u32 s24, s24, 1
  s_lshl_b32 s24, s24, 5
  s_lshr_b32 s25, s2, 3
  s_add_u32 s24, s24, s25
  s_mul_i32 s20, s24, 9363
  s_lshr_b32 s20, s20, 16
  s_mul_i32 s25, s20, 7
  s_sub_u32 s22, s24, s25
  s_cmp_eq_u32 s22, 0
  s_cselect_b32 s29, 10, 9
  s_cmp_lt_u32 s20, 28
  s_cselect_b32 s34, 1, 0
  v_and_b32 v1, 63, v0
  v_lshlrev_b32 v2, 4, v1
  s_lshl_b32 s32, s21, 10
  v_add_u32 v3, s32, v2
  v_lshrrev_b32 v11, 4, v1
  v_and_b32 v12, 15, v1
  v_lshlrev_b32 v13, 2, v11
  v_xor_b32 v12, v12, v13
  v_lshlrev_b32 v12, 4, v12
  s_lshl_b32 s24, s21, 2
  v_add_u32 v11, s24, v11
  v_lshl_add_u32 v4, v11, 13, v12
  v_bfe_u32 v11, v1, 2, 2
  v_bfe_u32 v12, v1, 4, 1
  v_bfe_u32 v13, v1, 1, 1
  v_lshl_add_u32 v14, v12, 1, v13
  v_add_u32 v14, s24, v14
  v_lshlrev_b32 v5, 2, v11
  v_xor_b32 v14, v14, v5
  v_lshlrev_b32 v14, 4, v14
  v_lshrrev_b32_e64 v5, 5, v1
  v_lshl_add_u32 v5, v5, 3, v11
  v_lshl_add_u32 v5, v5, 8, v14
  v_and_b32_e64 v14, 1, v1
  v_lshl_add_u32 v5, v14, 3, v5
  s_lshl_b32 s25, s21, 1
  v_add_u32 v13, s25, v13
  v_lshrrev_b32_e64 v10, 1, v11
  v_lshl_add_u32 v10, v12, 1, v10
  v_lshlrev_b32 v10, 1, v10
  v_xor_b32 v13, v13, v10
  v_lshlrev_b32_e64 v13, 4, v13
  v_lshl_add_u32 v13, v14, 3, v13
  v_lshl_add_u32 v13, v12, 13, v13
  v_lshrrev_b32_e64 v10, 5, v1
  v_lshl_add_u32 v10, v10, 3, v11
  v_lshl_add_u32 v10, v10, 7, v13
  v_lshrrev_b32 v11, 3, v1
  s_lshl_b32 s25, s21, 3
  v_add_u32_e64 v11, s25, v11
  v_mul_u32_u24 v11, 3584, v11
  v_and_b32 v13, 7, v1
  v_lshlrev_b32 v12, 1, v12
  v_xor_b32_e64 v13, v13, v12
  v_lshl_add_u32 v8, v13, 4, v11
  v_xor_b32_e64 v13, 4, v13
  v_lshl_add_u32 v9, v13, 4, v11
  v_and_b32_e64 v11, 31, v1
  v_mul_u32_u24 v11, 1040, v11
  v_lshrrev_b32_e64 v12, 5, v1
  v_lshl_add_u32 v6, v12, 4, v11
  v_bfe_u32 v11, v1, 3, 1
  v_bfe_u32 v12, v1, 4, 1
  v_and_b32_e64 v13, 0x27, v1
  v_lshl_add_u32 v13, v11, 4, v13
  v_lshl_add_u32 v13, v12, 3, v13
  v_lshlrev_b32 v23, 4, v13
  v_lshrrev_b32 v11, 3, v0
  v_mul_u32_u24 v11, 1040, v11
  v_and_b32_e64 v12, 7, v0
  v_lshl_add_u32 v17, v12, 4, v11
  v_cmp_eq_u32 vcc, 0, v1
  v_mov_b32 v11, 0x40000000
  s_nop 0
  v_cndmask_b32 v15, v11, v1, vcc
  s_mov_b32 s16, s40
  s_mov_b32 s17, s41
  s_mov_b32 s18, 0x200000
  s_mov_b32 s19, 0x20000
  s_mov_b32 s8, s46
  s_mov_b32 s9, s47
  s_mov_b32 s10, 0x400000
  s_mov_b32 s11, 0x20000
  s_mov_b32 s12, s48
  s_mov_b32 s13, s49
  s_mov_b32 s14, 0x400000
  s_mov_b32 s15, 0x20000
  s_lshl_b32 s33, s20, 8
  s_add_u32 m0, s32, 33280
  s_add_u32 s24, s33, 0
  buffer_load_dwordx4 v4, s[8:11], s24 offen lds
  s_add_u32 m0, s32, 37376
  s_add_u32 s24, s33, 131072
  buffer_load_dwordx4 v4, s[8:11], s24 offen lds
  s_add_u32 m0, s32, 41472
  s_add_u32 s24, s33, 262144
  buffer_load_dwordx4 v4, s[8:11], s24 offen lds
  s_add_u32 m0, s32, 45568
  s_add_u32 s24, s33, 393216
  buffer_load_dwordx4 v4, s[8:11], s24 offen lds
  s_add_u32 m0, s32, 49664
  s_add_u32 s24, s33, 524288
  buffer_load_dwordx4 v4, s[8:11], s24 offen lds
  s_add_u32 m0, s32, 53760
  s_add_u32 s24, s33, 655360
  buffer_load_dwordx4 v4, s[8:11], s24 offen lds
  s_add_u32 m0, s32, 57856
  s_add_u32 s24, s33, 786432
  buffer_load_dwordx4 v4, s[8:11], s24 offen lds
  s_add_u32 m0, s32, 61952
  s_add_u32 s24, s33, 917504
  buffer_load_dwordx4 v4, s[8:11], s24 offen lds
  s_add_u32 m0, s32, 66048
  s_add_u32 s24, s33, 1048576
  buffer_load_dwordx4 v4, s[8:11], s24 offen lds
  s_add_u32 m0, s32, 70144
  s_add_u32 s24, s33, 1179648
  buffer_load_dwordx4 v4, s[8:11], s24 offen lds
  s_add_u32 m0, s32, 74240
  s_add_u32 s24, s33, 1310720
  buffer_load_dwordx4 v4, s[8:11], s24 offen lds
  s_add_u32 m0, s32, 78336
  s_add_u32 s24, s33, 1441792
  buffer_load_dwordx4 v4, s[8:11], s24 offen lds
  s_add_u32 m0, s32, 82432
  s_add_u32 s24, s33, 1572864
  buffer_load_dwordx4 v4, s[8:11], s24 offen lds
  s_add_u32 m0, s32, 86528
  s_add_u32 s24, s33, 1703936
  buffer_load_dwordx4 v4, s[8:11], s24 offen lds
  s_add_u32 m0, s32, 90624
  s_add_u32 s24, s33, 1835008
  buffer_load_dwordx4 v4, s[8:11], s24 offen lds
  s_add_u32 m0, s32, 94720
  s_add_u32 s24, s33, 1966080
  buffer_load_dwordx4 v4, s[8:11], s24 offen lds
  s_add_u32 m0, s32, 98816
  s_add_u32 s24, s33, 2097152
  buffer_load_dwordx4 v4, s[8:11], s24 offen lds
  s_add_u32 m0, s32, 102912
  s_add_u32 s24, s33, 2228224
  buffer_load_dwordx4 v4, s[8:11], s24 offen lds
  s_add_u32 m0, s32, 107008
  s_add_u32 s24, s33, 2359296
  buffer_load_dwordx4 v4, s[8:11], s24 offen lds
  s_add_u32 m0, s32, 111104
  s_add_u32 s24, s33, 2490368
  buffer_load_dwordx4 v4, s[8:11], s24 offen lds
  s_add_u32 m0, s32, 115200
  s_add_u32 s24, s33, 2621440
  buffer_load_dwordx4 v4, s[8:11], s24 offen lds
  s_add_u32 m0, s32, 119296
  s_add_u32 s24, s33, 2752512
  buffer_load_dwordx4 v4, s[8:11], s24 offen lds
  s_add_u32 m0, s32, 123392
  s_add_u32 s24, s33, 2883584
  buffer_load_dwordx4 v4, s[8:11], s24 offen lds
  s_add_u32 m0, s32, 127488
  s_add_u32 s24, s33, 3014656
  buffer_load_dwordx4 v4, s[8:11], s24 offen lds
  v_mul_u32_u24 v11, 7, v1
  v_add_u32 v11, s22, v11
  v_cmp_gt_u32 vcc, 64, v11
  v_mov_b32 v14, 0x40000000
  v_lshlrev_b32 v12, 2, v11
  v_cndmask_b32 v12, v14, v12, vcc
  v_lshlrev_b32 v13, 9, v11
  v_cndmask_b32 v13, v14, v13, vcc
  v_mov_b32 v11, 0
  s_lshl_b32 s24, s20, 10
  s_lshl_b32 s25, s21, 8
  s_add_u32 s24, s24, s25
  s_add_u32 s24, s24, 0x9100000
  buffer_store_dword v11, v12, s[4:7], s24 offen sc1
  s_lshl_b32 s24, s20, 2
  s_lshl_b32 s25, s21, 7
  s_add_u32 s24, s24, s25
  s_add_u32 s24, s24, 0x910c000
  buffer_store_dword v11, v13, s[4:7], s24 offen sc1
  s_lshl_b32 s24, s22, 15
  s_mul_i32 s25, s21, 1040
  s_add_u32 m0, s25, 0
  s_add_u32 s26, s24, 0
  buffer_load_dwordx4 v3, s[16:19], s26 offen lds
  s_add_u32 m0, s25, 4160
  s_add_u32 s26, s24, 4096
  buffer_load_dwordx4 v3, s[16:19], s26 offen lds
  s_add_u32 m0, s25, 8320
  s_add_u32 s26, s24, 8192
  buffer_load_dwordx4 v3, s[16:19], s26 offen lds
  s_add_u32 m0, s25, 12480
  s_add_u32 s26, s24, 12288
  buffer_load_dwordx4 v3, s[16:19], s26 offen lds
  s_add_u32 m0, s25, 16640
  s_add_u32 s26, s24, 16384
  buffer_load_dwordx4 v3, s[16:19], s26 offen lds
  s_add_u32 m0, s25, 20800
  s_add_u32 s26, s24, 20480
  buffer_load_dwordx4 v3, s[16:19], s26 offen lds
  s_add_u32 m0, s25, 24960
  s_add_u32 s26, s24, 24576
  buffer_load_dwordx4 v3, s[16:19], s26 offen lds
  s_add_u32 m0, s25, 29120
  s_add_u32 s26, s24, 28672
  buffer_load_dwordx4 v3, s[16:19], s26 offen lds
  s_waitcnt vmcnt(30)
  s_barrier
  s_add_u32 m0, s32, 131584
  s_add_u32 s24, s33, 3145728
  buffer_load_dwordx4 v4, s[8:11], s24 offen lds
  s_add_u32 m0, s32, 135680
  s_add_u32 s24, s33, 3276800
  buffer_load_dwordx4 v4, s[8:11], s24 offen lds
  s_add_u32 m0, s32, 139776
  s_add_u32 s24, s33, 3407872
  buffer_load_dwordx4 v4, s[8:11], s24 offen lds
  s_add_u32 m0, s32, 143872
  s_add_u32 s24, s33, 3538944
  buffer_load_dwordx4 v4, s[8:11], s24 offen lds
  v_add_u32 v11, 33280, v5
  ds_read_b64_tr_b16 a[0:1], v11 offset:0
  ds_read_b64_tr_b16 a[2:3], v11 offset:1024
  ds_read_b64_tr_b16 a[4:5], v11 offset:4096
  ds_read_b64_tr_b16 a[6:7], v11 offset:5120
  ds_read_b64_tr_b16 a[8:9], v11 offset:8192
  ds_read_b64_tr_b16 a[10:11], v11 offset:9216
  ds_read_b64_tr_b16 a[12:13], v11 offset:12288
  ds_read_b64_tr_b16 a[14:15], v11 offset:13312
  s_waitcnt lgkmcnt(0)
  s_waitcnt vmcnt(30)
  s_barrier
  s_add_u32 m0, s32, 33280
  s_add_u32 s24, s33, 3670016
  buffer_load_dwordx4 v4, s[8:11], s24 offen lds
  s_add_u32 m0, s32, 37376
  s_add_u32 s24, s33, 3801088
  buffer_load_dwordx4 v4, s[8:11], s24 offen lds
  s_add_u32 m0, s32, 41472
  s_add_u32 s24, s33, 3932160
  buffer_load_dwordx4 v4, s[8:11], s24 offen lds
  s_add_u32 m0, s32, 45568
  s_add_u32 s24, s33, 4063232
  buffer_load_dwordx4 v4, s[8:11], s24 offen lds
  v_add_u32 v11, 49664, v5
  ds_read_b64_tr_b16 a[16:17], v11 offset:0
  ds_read_b64_tr_b16 a[18:19], v11 offset:1024
  ds_read_b64_tr_b16 a[20:21], v11 offset:4096
  ds_read_b64_tr_b16 a[22:23], v11 offset:5120
  ds_read_b64_tr_b16 a[24:25], v11 offset:8192
  ds_read_b64_tr_b16 a[26:27], v11 offset:9216
  ds_read_b64_tr_b16 a[28:29], v11 offset:12288
  ds_read_b64_tr_b16 a[30:31], v11 offset:13312
  s_waitcnt lgkmcnt(0)
  s_waitcnt vmcnt(30)
  s_barrier
  s_add_u32 m0, s32, 49664
  s_add_u32 s24, s33, 0
  buffer_load_dwordx4 v4, s[12:15], s24 offen lds
  s_add_u32 m0, s32, 53760
  s_add_u32 s24, s33, 131072
  buffer_load_dwordx4 v4, s[12:15], s24 offen lds
  s_add_u32 m0, s32, 57856
  s_add_u32 s24, s33, 262144
  buffer_load_dwordx4 v4, s[12:15], s24 offen lds
  s_add_u32 m0, s32, 61952
  s_add_u32 s24, s33, 393216
  buffer_load_dwordx4 v4, s[12:15], s24 offen lds
  v_add_u32 v11, 66048, v5
  ds_read_b64_tr_b16 a[32:33], v11 offset:0
  ds_read_b64_tr_b16 a[34:35], v11 offset:1024
  ds_read_b64_tr_b16 a[36:37], v11 offset:4096
  ds_read_b64_tr_b16 a[38:39], v11 offset:5120
  ds_read_b64_tr_b16 a[40:41], v11 offset:8192
  ds_read_b64_tr_b16 a[42:43], v11 offset:9216
  ds_read_b64_tr_b16 a[44:45], v11 offset:12288
  ds_read_b64_tr_b16 a[46:47], v11 offset:13312
  s_waitcnt lgkmcnt(0)
  s_waitcnt vmcnt(30)
  s_barrier
  s_add_u32 m0, s32, 66048
  s_add_u32 s24, s33, 524288
  buffer_load_dwordx4 v4, s[12:15], s24 offen lds
  s_add_u32 m0, s32, 70144
  s_add_u32 s24, s33, 655360
  buffer_load_dwordx4 v4, s[12:15], s24 offen lds
  s_add_u32 m0, s32, 74240
  s_add_u32 s24, s33, 786432
  buffer_load_dwordx4 v4, s[12:15], s24 offen lds
  s_add_u32 m0, s32, 78336
  s_add_u32 s24, s33, 917504
  buffer_load_dwordx4 v4, s[12:15], s24 offen lds
  v_add_u32 v11, 82432, v5
  ds_read_b64_tr_b16 a[48:49], v11 offset:0
  ds_read_b64_tr_b16 a[50:51], v11 offset:1024
  ds_read_b64_tr_b16 a[52:53], v11 offset:4096
  ds_read_b64_tr_b16 a[54:55], v11 offset:5120
  ds_read_b64_tr_b16 a[56:57], v11 offset:8192
  ds_read_b64_tr_b16 a[58:59], v11 offset:9216
  ds_read_b64_tr_b16 a[60:61], v11 offset:12288
  ds_read_b64_tr_b16 a[62:63], v11 offset:13312
  s_waitcnt lgkmcnt(0)
  s_waitcnt vmcnt(30)
  s_barrier
  s_add_u32 m0, s32, 82432
  s_add_u32 s24, s33, 1048576
  buffer_load_dwordx4 v4, s[12:15], s24 offen lds
  s_add_u32 m0, s32, 86528
  s_add_u32 s24, s33, 1179648
  buffer_load_dwordx4 v4, s[12:15], s24 offen lds
  s_add_u32 m0, s32, 90624
  s_add_u32 s24, s33, 1310720
  buffer_load_dwordx4 v4, s[12:15], s24 offen lds
  s_add_u32 m0, s32, 94720
  s_add_u32 s24, s33, 1441792
  buffer_load_dwordx4 v4, s[12:15], s24 offen lds
  v_add_u32 v11, 98816, v5
  ds_read_b64_tr_b16 a[64:65], v11 offset:0
  ds_read_b64_tr_b16 a[66:67], v11 offset:1024
  ds_read_b64_tr_b16 a[68:69], v11 offset:4096
  ds_read_b64_tr_b16 a[70:71], v11 offset:5120
  ds_read_b64_tr_b16 a[72:73], v11 offset:8192
  ds_read_b64_tr_b16 a[74:75], v11 offset:9216
  ds_read_b64_tr_b16 a[76:77], v11 offset:12288
  ds_read_b64_tr_b16 a[78:79], v11 offset:13312
  s_waitcnt lgkmcnt(0)
  s_waitcnt vmcnt(30)
  s_barrier
  s_add_u32 m0, s32, 98816
  s_add_u32 s24, s33, 1572864
  buffer_load_dwordx4 v4, s[12:15], s24 offen lds
  s_add_u32 m0, s32, 102912
  s_add_u32 s24, s33, 1703936
  buffer_load_dwordx4 v4, s[12:15], s24 offen lds
  s_add_u32 m0, s32, 107008
  s_add_u32 s24, s33, 1835008
  buffer_load_dwordx4 v4, s[12:15], s24 offen lds
  s_add_u32 m0, s32, 111104
  s_add_u32 s24, s33, 1966080
  buffer_load_dwordx4 v4, s[12:15], s24 offen lds
  v_add_u32 v11, 115200, v5
  ds_read_b64_tr_b16 a[80:81], v11 offset:0
  ds_read_b64_tr_b16 a[82:83], v11 offset:1024
  ds_read_b64_tr_b16 a[84:85], v11 offset:4096
  ds_read_b64_tr_b16 a[86:87], v11 offset:5120
  ds_read_b64_tr_b16 a[88:89], v11 offset:8192
  ds_read_b64_tr_b16 a[90:91], v11 offset:9216
  ds_read_b64_tr_b16 a[92:93], v11 offset:12288
  ds_read_b64_tr_b16 a[94:95], v11 offset:13312
  s_waitcnt lgkmcnt(0)
  s_waitcnt vmcnt(20)
  s_barrier
  s_add_u32 m0, s32, 115200
  s_add_u32 s24, s33, 2097152
  buffer_load_dwordx4 v4, s[12:15], s24 offen lds
  s_add_u32 m0, s32, 119296
  s_add_u32 s24, s33, 2228224
  buffer_load_dwordx4 v4, s[12:15], s24 offen lds
  s_add_u32 m0, s32, 123392
  s_add_u32 s24, s33, 2359296
  buffer_load_dwordx4 v4, s[12:15], s24 offen lds
  s_add_u32 m0, s32, 127488
  s_add_u32 s24, s33, 2490368
  buffer_load_dwordx4 v4, s[12:15], s24 offen lds
  s_mov_b32 s16, s66
  s_mov_b32 s17, s67
  s_mov_b32 s18, 0x100
  s_mov_b32 s19, 0x20000
  s_cmp_lg_u32 s21, 0
  s_cbranch_scc1 L_noarr_4
  v_mov_b32_e64 v12, 1
  s_mov_b64 exec, 1
  buffer_atomic_add v12, off, s[16:19], 0 offset:0
  s_mov_b64 exec, -1
L_noarr_4:
  s_mov_b32 s16, s40
  s_mov_b32 s17, s41
  s_mov_b32 s18, 0x200000
  s_mov_b32 s19, 0x20000
  v_add_u32 v11, 131584, v5
  ds_read_b64_tr_b16 a[96:97], v11 offset:0
  ds_read_b64_tr_b16 a[98:99], v11 offset:1024
  ds_read_b64_tr_b16 a[100:101], v11 offset:4096
  ds_read_b64_tr_b16 a[102:103], v11 offset:5120
  ds_read_b64_tr_b16 a[104:105], v11 offset:8192
  ds_read_b64_tr_b16 a[106:107], v11 offset:9216
  ds_read_b64_tr_b16 a[108:109], v11 offset:12288
  ds_read_b64_tr_b16 a[110:111], v11 offset:13312
  s_waitcnt lgkmcnt(0)
  s_waitcnt vmcnt(20)
  s_barrier
  s_add_u32 m0, s32, 131584
  s_add_u32 s24, s33, 2621440
  buffer_load_dwordx4 v4, s[12:15], s24 offen lds
  s_add_u32 m0, s32, 135680
  s_add_u32 s24, s33, 2752512
  buffer_load_dwordx4 v4, s[12:15], s24 offen lds
  s_add_u32 m0, s32, 139776
  s_add_u32 s24, s33, 2883584
  buffer_load_dwordx4 v4, s[12:15], s24 offen lds
  s_add_u32 m0, s32, 143872
  s_add_u32 s24, s33, 3014656
  buffer_load_dwordx4 v4, s[12:15], s24 offen lds
  v_add_u32 v11, 33280, v5
  ds_read_b64_tr_b16 a[112:113], v11 offset:0
  ds_read_b64_tr_b16 a[114:115], v11 offset:1024
  ds_read_b64_tr_b16 a[116:117], v11 offset:4096
  ds_read_b64_tr_b16 a[118:119], v11 offset:5120
  ds_read_b64_tr_b16 a[120:121], v11 offset:8192
  ds_read_b64_tr_b16 a[122:123], v11 offset:9216
  ds_read_b64_tr_b16 a[124:125], v11 offset:12288
  ds_read_b64_tr_b16 a[126:127], v11 offset:13312
  s_waitcnt lgkmcnt(0)
  s_waitcnt vmcnt(20)
  s_barrier
  s_add_u32 m0, s32, 33280
  s_add_u32 s24, s33, 3145728
  buffer_load_dwordx4 v4, s[12:15], s24 offen lds
  s_add_u32 m0, s32, 37376
  s_add_u32 s24, s33, 3276800
  buffer_load_dwordx4 v4, s[12:15], s24 offen lds
  s_add_u32 m0, s32, 41472
  s_add_u32 s24, s33, 3407872
  buffer_load_dwordx4 v4, s[12:15], s24 offen lds
  s_add_u32 m0, s32, 45568
  s_add_u32 s24, s33, 3538944
  buffer_load_dwordx4 v4, s[12:15], s24 offen lds
  v_add_u32 v11, 49664, v5
  ds_read_b64_tr_b16 a[128:129], v11 offset:0
  ds_read_b64_tr_b16 a[130:131], v11 offset:1024
  ds_read_b64_tr_b16 a[132:133], v11 offset:4096
  ds_read_b64_tr_b16 a[134:135], v11 offset:5120
  ds_read_b64_tr_b16 a[136:137], v11 offset:8192
  ds_read_b64_tr_b16 a[138:139], v11 offset:9216
  ds_read_b64_tr_b16 a[140:141], v11 offset:12288
  ds_read_b64_tr_b16 a[142:143], v11 offset:13312
  s_waitcnt lgkmcnt(0)
  s_waitcnt vmcnt(20)
  s_barrier
  s_add_u32 m0, s32, 49664
  s_add_u32 s24, s33, 3670016
  buffer_load_dwordx4 v4, s[12:15], s24 offen lds
  s_add_u32 m0, s32, 53760
  s_add_u32 s24, s33, 3801088
  buffer_load_dwordx4 v4, s[12:15], s24 offen lds
  s_add_u32 m0, s32, 57856
  s_add_u32 s24, s33, 3932160
  buffer_load_dwordx4 v4, s[12:15], s24 offen lds
  s_add_u32 m0, s32, 61952
  s_add_u32 s24, s33, 4063232
  buffer_load_dwordx4 v4, s[12:15], s24 offen lds
  v_add_u32 v11, 66048, v5
  ds_read_b64_tr_b16 a[144:145], v11 offset:0
  ds_read_b64_tr_b16 a[146:147], v11 offset:1024
  ds_read_b64_tr_b16 a[148:149], v11 offset:4096
  ds_read_b64_tr_b16 a[150:151], v11 offset:5120
  ds_read_b64_tr_b16 a[152:153], v11 offset:8192
  ds_read_b64_tr_b16 a[154:155], v11 offset:9216
  ds_read_b64_tr_b16 a[156:157], v11 offset:12288
  ds_read_b64_tr_b16 a[158:159], v11 offset:13312
  s_waitcnt lgkmcnt(0)
  s_waitcnt vmcnt(20)
  s_barrier
  v_add_u32 v11, 82432, v5
  ds_read_b64_tr_b16 a[160:161], v11 offset:0
  ds_read_b64_tr_b16 a[162:163], v11 offset:1024
  ds_read_b64_tr_b16 a[164:165], v11 offset:4096
  ds_read_b64_tr_b16 a[166:167], v11 offset:5120
  ds_read_b64_tr_b16 a[168:169], v11 offset:8192
  ds_read_b64_tr_b16 a[170:171], v11 offset:9216
  ds_read_b64_tr_b16 a[172:173], v11 offset:12288
  ds_read_b64_tr_b16 a[174:175], v11 offset:13312
  s_waitcnt lgkmcnt(0)
  s_waitcnt vmcnt(16)
  s_barrier
  v_add_u32 v11, 98816, v5
  ds_read_b64_tr_b16 a[176:177], v11 offset:0
  ds_read_b64_tr_b16 a[178:179], v11 offset:1024
  ds_read_b64_tr_b16 a[180:181], v11 offset:4096
  ds_read_b64_tr_b16 a[182:183], v11 offset:5120
  ds_read_b64_tr_b16 a[184:185], v11 offset:8192
  ds_read_b64_tr_b16 a[186:187], v11 offset:9216
  ds_read_b64_tr_b16 a[188:189], v11 offset:12288
  ds_read_b64_tr_b16 a[190:191], v11 offset:13312
  s_waitcnt lgkmcnt(0)
  s_waitcnt vmcnt(12)
  s_barrier
  v_add_u32 v11, 115200, v5
  ds_read_b64_tr_b16 a[192:193], v11 offset:0
  ds_read_b64_tr_b16 a[194:195], v11 offset:1024
  ds_read_b64_tr_b16 a[196:197], v11 offset:4096
  ds_read_b64_tr_b16 a[198:199], v11 offset:5120
  ds_read_b64_tr_b16 a[200:201], v11 offset:8192
  ds_read_b64_tr_b16 a[202:203], v11 offset:9216
  ds_read_b64_tr_b16 a[204:205], v11 offset:12288
  ds_read_b64_tr_b16 a[206:207], v11 offset:13312
  s_waitcnt lgkmcnt(0)
  s_waitcnt vmcnt(8)
  s_barrier
  v_add_u32 v11, 131584, v5
  ds_read_b64_tr_b16 a[208:209], v11 offset:0
  ds_read_b64_tr_b16 a[210:211], v11 offset:1024
  ds_read_b64_tr_b16 a[212:213], v11 offset:4096
  ds_read_b64_tr_b16 a[214:215], v11 offset:5120
  ds_read_b64_tr_b16 a[216:217], v11 offset:8192
  ds_read_b64_tr_b16 a[218:219], v11 offset:9216
  ds_read_b64_tr_b16 a[220:221], v11 offset:12288
  ds_read_b64_tr_b16 a[222:223], v11 offset:13312
  s_waitcnt lgkmcnt(0)
  s_waitcnt vmcnt(4)
  s_barrier
  v_add_u32 v11, 33280, v5
  ds_read_b64_tr_b16 a[224:225], v11 offset:0
  ds_read_b64_tr_b16 a[226:227], v11 offset:1024
  ds_read_b64_tr_b16 a[228:229], v11 offset:4096
  ds_read_b64_tr_b16 a[230:231], v11 offset:5120
  ds_read_b64_tr_b16 a[232:233], v11 offset:8192
  ds_read_b64_tr_b16 a[234:235], v11 offset:9216
  ds_read_b64_tr_b16 a[236:237], v11 offset:12288
  ds_read_b64_tr_b16 a[238:239], v11 offset:13312
  s_waitcnt lgkmcnt(0)
  s_waitcnt vmcnt(0)
  s_barrier
  v_add_u32 v11, 49664, v5
  ds_read_b64_tr_b16 a[240:241], v11 offset:0
  ds_read_b64_tr_b16 a[242:243], v11 offset:1024
  ds_read_b64_tr_b16 a[244:245], v11 offset:4096
  ds_read_b64_tr_b16 a[246:247], v11 offset:5120
  ds_read_b64_tr_b16 a[248:249], v11 offset:8192
  ds_read_b64_tr_b16 a[250:251], v11 offset:9216
  ds_read_b64_tr_b16 a[252:253], v11 offset:12288
  ds_read_b64_tr_b16 a[254:255], v11 offset:13312
  s_waitcnt lgkmcnt(0)
  v_mov_b64 v[56:57], -1
  v_mov_b64 v[58:59], -1
  s_lshr_b32 s24, s32, 1
  v_add_u32 v11, s24, v2
  v_mov_b32 v12, 0x40000000
  v_cmp_gt_u32 vcc, 32, v1
  s_nop 1
  v_cndmask_b32 v19, v12, v11, vcc
  s_lshl_b32 s24, s21, 12
  v_add_u32 v20, s24, v2
  v_add_u32 v21, s24, v23
  v_mov_b32 v16, 1
  s_mov_b32 s30, 0
  s_mov_b32 s28, s22
  s_mov_b32 s31, 0
  s_mov_b32 s70, 0x40000000
  s_mov_b32 s74, 0x40000000
  s_mov_b32 s71, 0x40000000
L_f1a:
  s_add_u32 s72, s28, 7
  s_min_u32 s72, s72, 63
  s_lshl_b32 s72, s72, 15
  s_sub_u32 s35, 33280, s31
  s_mul_i32 s73, s21, 1040
  s_add_u32 s73, s73, s35
  v_add_u32_e64 v7, s31, v6
  s_waitcnt vmcnt(1)
  s_barrier
  ds_read_b128 v[24:27], v7 offset:0
  ds_read_b128 v[28:31], v7 offset:32
  ds_read_b128 v[32:35], v7 offset:64
  ds_read_b128 v[36:39], v7 offset:96
  s_waitcnt lgkmcnt(3)
  v_mfma_f32_32x32x16_bf16 v[64:79], a[0:3], v[24:27], 0
  v_mfma_f32_32x32x16_bf16 v[80:95], v[24:27], a[128:131], 0
  s_add_u32 m0, s73, 0
  s_add_u32 s26, s72, 0
  buffer_load_dwordx4 v3, s[16:19], s26 offen lds
  ds_read_b128 v[24:27], v7 offset:128
  s_waitcnt lgkmcnt(3)
  v_mfma_f32_32x32x16_bf16 v[64:79], a[4:7], v[28:31], v[64:79]
  v_mfma_f32_32x32x16_bf16 v[80:95], v[28:31], a[132:135], v[80:95]
  s_add_u32 m0, s73, 4160
  s_add_u32 s26, s72, 4096
  buffer_load_dwordx4 v3, s[16:19], s26 offen lds
  ds_read_b128 v[28:31], v7 offset:160
  s_waitcnt lgkmcnt(3)
  v_mfma_f32_32x32x16_bf16 v[64:79], a[8:11], v[32:35], v[64:79]
  v_mfma_f32_32x32x16_bf16 v[80:95], v[32:35], a[136:139], v[80:95]
  s_add_u32 m0, s73, 8320
  s_add_u32 s26, s72, 8192
  buffer_load_dwordx4 v3, s[16:19], s26 offen lds
  ds_read_b128 v[32:35], v7 offset:192
  s_waitcnt lgkmcnt(3)
  v_mfma_f32_32x32x16_bf16 v[64:79], a[12:15], v[36:39], v[64:79]
  v_mfma_f32_32x32x16_bf16 v[80:95], v[36:39], a[140:143], v[80:95]
  s_add_u32 m0, s73, 12480
  s_add_u32 s26, s72, 12288
  buffer_load_dwordx4 v3, s[16:19], s26 offen lds
  ds_read_b128 v[36:39], v7 offset:224
  s_waitcnt lgkmcnt(3)
  v_mfma_f32_32x32x16_bf16 v[64:79], a[16:19], v[24:27], v[64:79]
  v_mfma_f32_32x32x16_bf16 v[80:95], v[24:27], a[144:147], v[80:95]
  s_add_u32 m0, s73, 16640
  s_add_u32 s26, s72, 16384
  buffer_load_dwordx4 v3, s[16:19], s26 offen lds
  ds_read_b128 v[24:27], v7 offset:256
  s_waitcnt lgkmcnt(3)
  v_mfma_f32_32x32x16_bf16 v[64:79], a[20:23], v[28:31], v[64:79]
  v_mfma_f32_32x32x16_bf16 v[80:95], v[28:31], a[148:151], v[80:95]
  s_add_u32 m0, s73, 20800
  s_add_u32 s26, s72, 20480
  buffer_load_dwordx4 v3, s[16:19], s26 offen lds
  ds_read_b128 v[28:31], v7 offset:288
  s_waitcnt lgkmcnt(3)
  v_mfma_f32_32x32x16_bf16 v[64:79], a[24:27], v[32:35], v[64:79]
  v_mfma_f32_32x32x16_bf16 v[80:95], v[32:35], a[152:155], v[80:95]
  s_add_u32 m0, s73, 24960
  s_add_u32 s26, s72, 24576
  buffer_load_dwordx4 v3, s[16:19], s26 offen lds
  ds_read_b128 v[32:35], v7 offset:320
  s_waitcnt lgkmcnt(3)
  v_mfma_f32_32x32x16_bf16 v[64:79], a[28:31], v[36:39], v[64:79]
  v_mfma_f32_32x32x16_bf16 v[80:95], v[36:39], a[156:159], v[80:95]
  s_add_u32 m0, s73, 29120
  s_add_u32 s26, s72, 28672
  buffer_load_dwordx4 v3, s[16:19], s26 offen lds
  ds_read_b128 v[36:39], v7 offset:352
  s_waitcnt lgkmcnt(3)
  v_mfma_f32_32x32x16_bf16 v[64:79], a[32:35], v[24:27], v[64:79]
  v_mfma_f32_32x32x16_bf16 v[80:95], v[24:27], a[160:163], v[80:95]
  buffer_store_dwordx4 v[40:43], v21, s[4:7], s70 offen offset:0 sc1
  ds_read_b128 v[24:27], v7 offset:384
  s_waitcnt lgkmcnt(3)
  v_mfma_f32_32x32x16_bf16 v[64:79], a[36:39], v[28:31], v[64:79]
  v_mfma_f32_32x32x16_bf16 v[80:95], v[28:31], a[164:167], v[80:95]
  buffer_store_dwordx4 v[44:47], v21, s[4:7], s70 offen offset:1024 sc1
  ds_read_b128 v[28:31], v7 offset:416
  s_waitcnt lgkmcnt(3)
  v_mfma_f32_32x32x16_bf16 v[64:79], a[40:43], v[32:35], v[64:79]
  v_mfma_f32_32x32x16_bf16 v[80:95], v[32:35], a[168:171], v[80:95]
  buffer_store_dwordx4 v[48:51], v20, s[4:7], s70 offen offset:2048 sc1
  ds_read_b128 v[32:35], v7 offset:448
  s_waitcnt lgkmcnt(3)
  v_mfma_f32_32x32x16_bf16 v[64:79], a[44:47], v[36:39], v[64:79]
  v_mfma_f32_32x32x16_bf16 v[80:95], v[36:39], a[172:175], v[80:95]
  buffer_store_dwordx4 v[52:55], v20, s[4:7], s70 offen offset:3072 sc1
  ds_read_b128 v[36:39], v7 offset:480
  s_waitcnt lgkmcnt(3)
  v_mfma_f32_32x32x16_bf16 v[64:79], a[48:51], v[24:27], v[64:79]
  v_mfma_f32_32x32x16_bf16 v[80:95], v[24:27], a[176:179], v[80:95]
  s_add_u32 s27, s70, 0x4000
  buffer_store_dwordx4 v[56:59], v19, s[4:7], s27 offen sc1
  ds_read_b128 v[24:27], v7 offset:512
  s_waitcnt lgkmcnt(3)
  v_mfma_f32_32x32x16_bf16 v[64:79], a[52:55], v[28:31], v[64:79]
  v_mfma_f32_32x32x16_bf16 v[80:95], v[28:31], a[180:183], v[80:95]
  buffer_store_dwordx4 v[56:59], v3, s[4:7], s27 offen offset:2048 sc1
  ds_read_b128 v[28:31], v7 offset:544
  s_waitcnt lgkmcnt(3)
  v_mfma_f32_32x32x16_bf16 v[64:79], a[56:59], v[32:35], v[64:79]
  v_mfma_f32_32x32x16_bf16 v[80:95], v[32:35], a[184:187], v[80:95]
  ds_read_b128 v[32:35], v7 offset:576
  s_waitcnt lgkmcnt(3)
  v_mfma_f32_32x32x16_bf16 v[64:79], a[60:63], v[36:39], v[64:79]
  v_mfma_f32_32x32x16_bf16 v[80:95], v[36:39], a[188:191], v[80:95]
  ds_read_b128 v[36:39], v7 offset:608
  s_waitcnt lgkmcnt(3)
  v_mfma_f32_32x32x16_bf16 v[64:79], a[64:67], v[24:27], v[64:79]
  v_mfma_f32_32x32x16_bf16 v[80:95], v[24:27], a[192:195], v[80:95]
  ds_read_b128 v[24:27], v7 offset:640
  s_waitcnt lgkmcnt(3)
  v_mfma_f32_32x32x16_bf16 v[64:79], a[68:71], v[28:31], v[64:79]
  v_mfma_f32_32x32x16_bf16 v[80:95], v[28:31], a[196:199], v[80:95]
  ds_read_b128 v[28:31], v7 offset:672
  s_waitcnt lgkmcnt(3)
  v_mfma_f32_32x32x16_bf16 v[64:79], a[72:75], v[32:35], v[64:79]
  v_mfma_f32_32x32x16_bf16 v[80:95], v[32:35], a[200:203], v[80:95]
  ds_read_b128 v[32:35], v7 offset:704
  s_waitcnt lgkmcnt(3)
  v_mfma_f32_32x32x16_bf16 v[64:79], a[76:79], v[36:39], v[64:79]
  v_mfma_f32_32x32x16_bf16 v[80:95], v[36:39], a[204:207], v[80:95]
  ds_read_b128 v[36:39], v7 offset:736
  s_waitcnt lgkmcnt(3)
  v_mfma_f32_32x32x16_bf16 v[64:79], a[80:83], v[24:27], v[64:79]
  v_mfma_f32_32x32x16_bf16 v[80:95], v[24:27], a[208:211], v[80:95]
  ds_read_b128 v[24:27], v7 offset:768
  s_waitcnt lgkmcnt(3)
  v_mfma_f32_32x32x16_bf16 v[64:79], a[84:87], v[28:31], v[64:79]
  v_mfma_f32_32x32x16_bf16 v[80:95], v[28:31], a[212:215], v[80:95]
  ds_read_b128 v[28:31], v7 offset:800
  s_waitcnt lgkmcnt(3)
  v_mfma_f32_32x32x16_bf16 v[64:79], a[88:91], v[32:35], v[64:79]
  v_mfma_f32_32x32x16_bf16 v[80:95], v[32:35], a[216:219], v[80:95]
  ds_read_b128 v[32:35], v7 offset:832
  s_waitcnt lgkmcnt(3)
  v_mfma_f32_32x32x16_bf16 v[64:79], a[92:95], v[36:39], v[64:79]
  v_mfma_f32_32x32x16_bf16 v[80:95], v[36:39], a[220:223], v[80:95]
  ds_read_b128 v[36:39], v7 offset:864
  s_waitcnt lgkmcnt(3)
  v_mfma_f32_32x32x16_bf16 v[64:79], a[96:99], v[24:27], v[64:79]
  v_mfma_f32_32x32x16_bf16 v[80:95], v[24:27], a[224:227], v[80:95]
  ds_read_b128 v[24:27], v7 offset:896
  s_waitcnt lgkmcnt(3)
  v_mfma_f32_32x32x16_bf16 v[64:79], a[100:103], v[28:31], v[64:79]
  v_mfma_f32_32x32x16_bf16 v[80:95], v[28:31], a[228:231], v[80:95]
  ds_read_b128 v[28:31], v7 offset:928
  s_waitcnt lgkmcnt(3)
  v_mfma_f32_32x32x16_bf16 v[64:79], a[104:107], v[32:35], v[64:79]
  v_mfma_f32_32x32x16_bf16 v[80:95], v[32:35], a[232:235], v[80:95]
  ds_read_b128 v[32:35], v7 offset:960
  s_waitcnt lgkmcnt(3)
  v_mfma_f32_32x32x16_bf16 v[64:79], a[108:111], v[36:39], v[64:79]
  v_mfma_f32_32x32x16_bf16 v[80:95], v[36:39], a[236:239], v[80:95]
  ds_read_b128 v[36:39], v7 offset:992
  s_waitcnt lgkmcnt(3)
  v_mfma_f32_32x32x16_bf16 v[64:79], a[112:115], v[24:27], v[64:79]
  v_mfma_f32_32x32x16_bf16 v[80:95], v[24:27], a[240:243], v[80:95]
  s_waitcnt lgkmcnt(2)
  v_mfma_f32_32x32x16_bf16 v[64:79], a[116:119], v[28:31], v[64:79]
  v_mfma_f32_32x32x16_bf16 v[80:95], v[28:31], a[244:247], v[80:95]
  s_waitcnt lgkmcnt(1)
  v_mfma_f32_32x32x16_bf16 v[64:79], a[120:123], v[32:35], v[64:79]
  v_mfma_f32_32x32x16_bf16 v[80:95], v[32:35], a[248:251], v[80:95]
  s_waitcnt lgkmcnt(0)
  v_mfma_f32_32x32x16_bf16 v[64:79], a[124:127], v[36:39], v[64:79]
  s_waitcnt vmcnt(0)
  buffer_store_dword v16, v15, s[4:7], s71 offen sc1
  v_mfma_f32_32x32x16_bf16 v[80:95], v[36:39], a[252:255], v[80:95]
  s_lshl_b32 s24, s20, 6
  s_add_u32 s24, s24, s28
  s_lshl_b32 s70, s24, 15
  s_lshl_b32 s74, s24, 13
  s_add_u32 s74, s74, 0x4000000
  s_lshl_b32 s24, s20, 10
  s_lshl_b32 s25, s21, 8
  s_add_u32 s24, s24, s25
  s_lshl_b32 s25, s28, 2
  s_add_u32 s24, s24, s25
  s_add_u32 s71, s24, 0x9100000
  s_mov_b32 s31, s35
  s_add_u32 s28, s28, 7
  s_add_u32 s30, s30, 1
  v_cvt_pk_bf16_f32 v40, v64, v65
  v_cvt_pk_bf16_f32 v41, v66, v67
  v_cvt_pk_bf16_f32 v42, v68, v69
  v_cvt_pk_bf16_f32 v43, v70, v71
  v_cvt_pk_bf16_f32 v44, v72, v73
  v_cvt_pk_bf16_f32 v45, v74, v75
  v_cvt_pk_bf16_f32 v46, v76, v77
  v_cvt_pk_bf16_f32 v47, v78, v79
  v_cvt_pk_bf16_f32 v48, v80, v81
  v_cvt_pk_bf16_f32 v49, v82, v83
  v_cvt_pk_bf16_f32 v50, v84, v85
  v_cvt_pk_bf16_f32 v51, v86, v87
  v_cvt_pk_bf16_f32 v52, v88, v89
  v_cvt_pk_bf16_f32 v53, v90, v91
  v_cvt_pk_bf16_f32 v54, v92, v93
  v_cvt_pk_bf16_f32 v55, v94, v95
  s_cmp_gt_u32 s30, 1
  s_cbranch_scc1 L_f1a_lazy
  buffer_store_dwordx4 v[40:43], v21, s[4:7], s70 offen offset:0 sc1
  buffer_store_dwordx4 v[44:47], v21, s[4:7], s70 offen offset:1024 sc1
  buffer_store_dwordx4 v[48:51], v20, s[4:7], s70 offen offset:2048 sc1
  buffer_store_dwordx4 v[52:55], v20, s[4:7], s70 offen offset:3072 sc1
  s_add_u32 s27, s70, 0x4000
  buffer_store_dwordx4 v[56:59], v19, s[4:7], s27 offen sc1
  buffer_store_dwordx4 v[56:59], v3, s[4:7], s27 offen offset:2048 sc1
  s_waitcnt vmcnt(0)
  buffer_store_dword v16, v15, s[4:7], s71 offen sc1
  s_mov_b32 s70, 0x40000000
  s_mov_b32 s71, 0x40000000
  s_mov_b32 s8, s66
  s_mov_b32 s9, s67
  s_mov_b32 s10, 0x100
  s_mov_b32 s11, 0x20000
L_f1a_yield:
  buffer_load_dword v11, off, s[8:11], 0 offset:64 sc1
  s_waitcnt vmcnt(0)
  v_readfirstlane_b32 s24, v11
  s_nop 0
  s_cmp_ge_u32 s24, 32
  s_cbranch_scc1 L_f1a_lazy
  s_sleep 8
  s_add_u32 s23, s23, 1
  s_cmp_lt_u32 s23, 0x40000
  s_cbranch_scc1 L_f1a_yield
  s_branch L_exit
L_f1a_lazy:
  s_cmp_lt_u32 s30, s29
  s_cbranch_scc1 L_f1a
  buffer_store_dwordx4 v[40:43], v21, s[4:7], s70 offen offset:0 sc1
  buffer_store_dwordx4 v[44:47], v21, s[4:7], s70 offen offset:1024 sc1
  buffer_store_dwordx4 v[48:51], v20, s[4:7], s70 offen offset:2048 sc1
  buffer_store_dwordx4 v[52:55], v20, s[4:7], s70 offen offset:3072 sc1
  s_add_u32 s27, s70, 0x4000
  buffer_store_dwordx4 v[56:59], v19, s[4:7], s27 offen sc1
  buffer_store_dwordx4 v[56:59], v3, s[4:7], s27 offen offset:2048 sc1
  s_waitcnt vmcnt(0)
  buffer_store_dword v16, v15, s[4:7], s71 offen sc1
  s_waitcnt vmcnt(0)
  s_barrier
  s_lshl_b32 s24, s22, 15
  s_mul_i32 s25, s21, 1040
  s_add_u32 m0, s25, 0
  s_add_u32 s26, s24, 0
  buffer_load_dwordx4 v3, s[16:19], s26 offen lds
  s_add_u32 m0, s25, 4160
  s_add_u32 s26, s24, 4096
  buffer_load_dwordx4 v3, s[16:19], s26 offen lds
  s_add_u32 m0, s25, 8320
  s_add_u32 s26, s24, 8192
  buffer_load_dwordx4 v3, s[16:19], s26 offen lds
  s_add_u32 m0, s25, 12480
  s_add_u32 s26, s24, 12288
  buffer_load_dwordx4 v3, s[16:19], s26 offen lds
  s_add_u32 m0, s25, 16640
  s_add_u32 s26, s24, 16384
  buffer_load_dwordx4 v3, s[16:19], s26 offen lds
  s_add_u32 m0, s25, 20800
  s_add_u32 s26, s24, 20480
  buffer_load_dwordx4 v3, s[16:19], s26 offen lds
  s_add_u32 m0, s25, 24960
  s_add_u32 s26, s24, 24576
  buffer_load_dwordx4 v3, s[16:19], s26 offen lds
  s_add_u32 m0, s25, 29120
  s_add_u32 s26, s24, 28672
  buffer_load_dwordx4 v3, s[16:19], s26 offen lds
  s_mov_b32 s8, s62
  s_mov_b32 s9, s63
  s_mov_b32 s10, 0x400
  s_mov_b32 s11, 0x20000
  v_and_b32_e64 v11, 7, v0
  v_lshlrev_b32 v11, 4, v11
  buffer_load_dwordx4 v[96:99], v11, s[8:11], 0 offen offset:0
  buffer_load_dwordx4 v[100:103], v11, s[8:11], 0 offen offset:128
  buffer_load_dwordx4 v[104:107], v11, s[8:11], 0 offen offset:256
  buffer_load_dwordx4 v[108:111], v11, s[8:11], 0 offen offset:384
  buffer_load_dwordx4 v[112:115], v11, s[8:11], 0 offen offset:512
  buffer_load_dwordx4 v[116:119], v11, s[8:11], 0 offen offset:640
  buffer_load_dwordx4 v[120:123], v11, s[8:11], 0 offen offset:768
  buffer_load_dwordx4 v[124:127], v11, s[8:11], 0 offen offset:896
  s_mov_b32 s8, s44
  s_mov_b32 s9, s45
  s_mov_b32 s10, 0x400000
  s_mov_b32 s11, 0x20000
  s_add_u32 m0, s32, 68608
  s_add_u32 s24, s33, 0
  buffer_load_dwordx4 v4, s[8:11], s24 offen lds
  s_add_u32 m0, s32, 72704
  s_add_u32 s24, s33, 131072
  buffer_load_dwordx4 v4, s[8:11], s24 offen lds
  s_add_u32 m0, s32, 76800
  s_add_u32 s24, s33, 262144
  buffer_load_dwordx4 v4, s[8:11], s24 offen lds
  s_add_u32 m0, s32, 80896
  s_add_u32 s24, s33, 393216
  buffer_load_dwordx4 v4, s[8:11], s24 offen lds
  s_add_u32 m0, s32, 84992
  s_add_u32 s24, s33, 524288
  buffer_load_dwordx4 v4, s[8:11], s24 offen lds
  s_add_u32 m0, s32, 89088
  s_add_u32 s24, s33, 655360
  buffer_load_dwordx4 v4, s[8:11], s24 offen lds
  s_add_u32 m0, s32, 93184
  s_add_u32 s24, s33, 786432
  buffer_load_dwordx4 v4, s[8:11], s24 offen lds
  s_add_u32 m0, s32, 97280
  s_add_u32 s24, s33, 917504
  buffer_load_dwordx4 v4, s[8:11], s24 offen lds
  s_waitcnt vmcnt(4)
  s_barrier
  s_add_u32 m0, s32, 101376
  s_add_u32 s24, s33, 1048576
  buffer_load_dwordx4 v4, s[8:11], s24 offen lds
  s_add_u32 m0, s32, 105472
  s_add_u32 s24, s33, 1179648
  buffer_load_dwordx4 v4, s[8:11], s24 offen lds
  s_add_u32 m0, s32, 109568
  s_add_u32 s24, s33, 1310720
  buffer_load_dwordx4 v4, s[8:11], s24 offen lds
  s_add_u32 m0, s32, 113664
  s_add_u32 s24, s33, 1441792
  buffer_load_dwordx4 v4, s[8:11], s24 offen lds
  v_add_u32 v11, 68608, v5
  ds_read_b64_tr_b16 a[0:1], v11 offset:0
  ds_read_b64_tr_b16 a[2:3], v11 offset:1024
  ds_read_b64_tr_b16 a[4:5], v11 offset:4096
  ds_read_b64_tr_b16 a[6:7], v11 offset:5120
  ds_read_b64_tr_b16 a[8:9], v11 offset:8192
  ds_read_b64_tr_b16 a[10:11], v11 offset:9216
  ds_read_b64_tr_b16 a[12:13], v11 offset:12288
  ds_read_b64_tr_b16 a[14:15], v11 offset:13312
  s_waitcnt lgkmcnt(0)
  s_waitcnt vmcnt(4)
  s_barrier
  s_add_u32 m0, s32, 68608
  s_add_u32 s24, s33, 1572864
  buffer_load_dwordx4 v4, s[8:11], s24 offen lds
  s_add_u32 m0, s32, 72704
  s_add_u32 s24, s33, 1703936
  buffer_load_dwordx4 v4, s[8:11], s24 offen lds
  s_add_u32 m0, s32, 76800
  s_add_u32 s24, s33, 1835008
  buffer_load_dwordx4 v4, s[8:11], s24 offen lds
  s_add_u32 m0, s32, 80896
  s_add_u32 s24, s33, 1966080
  buffer_load_dwordx4 v4, s[8:11], s24 offen lds
  v_add_u32 v11, 84992, v5
  ds_read_b64_tr_b16 a[16:17], v11 offset:0
  ds_read_b64_tr_b16 a[18:19], v11 offset:1024
  ds_read_b64_tr_b16 a[20:21], v11 offset:4096
  ds_read_b64_tr_b16 a[22:23], v11 offset:5120
  ds_read_b64_tr_b16 a[24:25], v11 offset:8192
  ds_read_b64_tr_b16 a[26:27], v11 offset:9216
  ds_read_b64_tr_b16 a[28:29], v11 offset:12288
  ds_read_b64_tr_b16 a[30:31], v11 offset:13312
  s_waitcnt lgkmcnt(0)
  s_waitcnt vmcnt(4)
  s_barrier
  s_add_u32 m0, s32, 84992
  s_add_u32 s24, s33, 2097152
  buffer_load_dwordx4 v4, s[8:11], s24 offen lds
  s_add_u32 m0, s32, 89088
  s_add_u32 s24, s33, 2228224
  buffer_load_dwordx4 v4, s[8:11], s24 offen lds
  s_add_u32 m0, s32, 93184
  s_add_u32 s24, s33, 2359296
  buffer_load_dwordx4 v4, s[8:11], s24 offen lds
  s_add_u32 m0, s32, 97280
  s_add_u32 s24, s33, 2490368
  buffer_load_dwordx4 v4, s[8:11], s24 offen lds
  v_add_u32 v11, 101376, v5
  ds_read_b64_tr_b16 a[32:33], v11 offset:0
  ds_read_b64_tr_b16 a[34:35], v11 offset:1024
  ds_read_b64_tr_b16 a[36:37], v11 offset:4096
  ds_read_b64_tr_b16 a[38:39], v11 offset:5120
  ds_read_b64_tr_b16 a[40:41], v11 offset:8192
  ds_read_b64_tr_b16 a[42:43], v11 offset:9216
  ds_read_b64_tr_b16 a[44:45], v11 offset:12288
  ds_read_b64_tr_b16 a[46:47], v11 offset:13312
  s_waitcnt lgkmcnt(0)
  s_waitcnt vmcnt(4)
  s_barrier
  s_add_u32 m0, s32, 101376
  s_add_u32 s24, s33, 2621440
  buffer_load_dwordx4 v4, s[8:11], s24 offen lds
  s_add_u32 m0, s32, 105472
  s_add_u32 s24, s33, 2752512
  buffer_load_dwordx4 v4, s[8:11], s24 offen lds
  s_add_u32 m0, s32, 109568
  s_add_u32 s24, s33, 2883584
  buffer_load_dwordx4 v4, s[8:11], s24 offen lds
  s_add_u32 m0, s32, 113664
  s_add_u32 s24, s33, 3014656
  buffer_load_dwordx4 v4, s[8:11], s24 offen lds
  v_add_u32 v11, 68608, v5
  ds_read_b64_tr_b16 a[48:49], v11 offset:0
  ds_read_b64_tr_b16 a[50:51], v11 offset:1024
  ds_read_b64_tr_b16 a[52:53], v11 offset:4096
  ds_read_b64_tr_b16 a[54:55], v11 offset:5120
  ds_read_b64_tr_b16 a[56:57], v11 offset:8192
  ds_read_b64_tr_b16 a[58:59], v11 offset:9216
  ds_read_b64_tr_b16 a[60:61], v11 offset:12288
  ds_read_b64_tr_b16 a[62:63], v11 offset:13312
  s_waitcnt lgkmcnt(0)
  s_waitcnt vmcnt(4)
  s_barrier
  s_add_u32 m0, s32, 68608
  s_add_u32 s24, s33, 3145728
  buffer_load_dwordx4 v4, s[8:11], s24 offen lds
  s_add_u32 m0, s32, 72704
  s_add_u32 s24, s33, 3276800
  buffer_load_dwordx4 v4, s[8:11], s24 offen lds
  s_add_u32 m0, s32, 76800
  s_add_u32 s24, s33, 3407872
  buffer_load_dwordx4 v4, s[8:11], s24 offen lds
  s_add_u32 m0, s32, 80896
  s_add_u32 s24, s33, 3538944
  buffer_load_dwordx4 v4, s[8:11], s24 offen lds
  v_add_u32 v11, 84992, v5
  ds_read_b64_tr_b16 a[64:65], v11 offset:0
  ds_read_b64_tr_b16 a[66:67], v11 offset:1024
  ds_read_b64_tr_b16 a[68:69], v11 offset:4096
  ds_read_b64_tr_b16 a[70:71], v11 offset:5120
  ds_read_b64_tr_b16 a[72:73], v11 offset:8192
  ds_read_b64_tr_b16 a[74:75], v11 offset:9216
  ds_read_b64_tr_b16 a[76:77], v11 offset:12288
  ds_read_b64_tr_b16 a[78:79], v11 offset:13312
  s_waitcnt lgkmcnt(0)
  s_waitcnt vmcnt(4)
  s_barrier
  s_add_u32 m0, s32, 84992
  s_add_u32 s24, s33, 3670016
  buffer_load_dwordx4 v4, s[8:11], s24 offen lds
  s_add_u32 m0, s32, 89088
  s_add_u32 s24, s33, 3801088
  buffer_load_dwordx4 v4, s[8:11], s24 offen lds
  s_add_u32 m0, s32, 93184
  s_add_u32 s24, s33, 3932160
  buffer_load_dwordx4 v4, s[8:11], s24 offen lds
  s_add_u32 m0, s32, 97280
  s_add_u32 s24, s33, 4063232
  buffer_load_dwordx4 v4, s[8:11], s24 offen lds
  v_add_u32 v11, 101376, v5
  ds_read_b64_tr_b16 a[80:81], v11 offset:0
  ds_read_b64_tr_b16 a[82:83], v11 offset:1024
  ds_read_b64_tr_b16 a[84:85], v11 offset:4096
  ds_read_b64_tr_b16 a[86:87], v11 offset:5120
  ds_read_b64_tr_b16 a[88:89], v11 offset:8192
  ds_read_b64_tr_b16 a[90:91], v11 offset:9216
  ds_read_b64_tr_b16 a[92:93], v11 offset:12288
  ds_read_b64_tr_b16 a[94:95], v11 offset:13312
  s_waitcnt lgkmcnt(0)
  s_waitcnt vmcnt(4)
  s_barrier
  v_add_u32 v11, 68608, v5
  ds_read_b64_tr_b16 a[96:97], v11 offset:0
  ds_read_b64_tr_b16 a[98:99], v11 offset:1024
  ds_read_b64_tr_b16 a[100:101], v11 offset:4096
  ds_read_b64_tr_b16 a[102:103], v11 offset:5120
  ds_read_b64_tr_b16 a[104:105], v11 offset:8192
  ds_read_b64_tr_b16 a[106:107], v11 offset:9216
  ds_read_b64_tr_b16 a[108:109], v11 offset:12288
  ds_read_b64_tr_b16 a[110:111], v11 offset:13312
  s_waitcnt lgkmcnt(0)
  s_waitcnt vmcnt(0)
  s_barrier
  v_add_u32 v11, 84992, v5
  ds_read_b64_tr_b16 a[112:113], v11 offset:0
  ds_read_b64_tr_b16 a[114:115], v11 offset:1024
  ds_read_b64_tr_b16 a[116:117], v11 offset:4096
  ds_read_b64_tr_b16 a[118:119], v11 offset:5120
  ds_read_b64_tr_b16 a[120:121], v11 offset:8192
  ds_read_b64_tr_b16 a[122:123], v11 offset:9216
  ds_read_b64_tr_b16 a[124:125], v11 offset:12288
  ds_read_b64_tr_b16 a[126:127], v11 offset:13312
  s_waitcnt lgkmcnt(0)
  s_cmp_eq_u32 s34, 0
  s_cbranch_scc1 L_f1b_skipw
  s_mov_b32 s8, s56
  s_mov_b32 s9, s57
  s_mov_b32 s10, 0x1c0000
  s_mov_b32 s11, 0x20000
  s_mov_b32 s12, s58
  s_mov_b32 s13, s59
  s_mov_b32 s14, 0x1c0000
  s_mov_b32 s15, 0x20000
  s_lshl_b32 s33, s20, 7
  s_barrier
  s_add_u32 m0, s32, 68608
  s_add_u32 s24, s33, 0
  buffer_load_dwordx4 v8, s[8:11], s24 offen lds
  s_add_u32 m0, s32, 72704
  s_add_u32 s24, s33, 114688
  buffer_load_dwordx4 v8, s[8:11], s24 offen lds
  s_add_u32 m0, s32, 76800
  s_add_u32 s24, s33, 0
  buffer_load_dwordx4 v9, s[12:15], s24 offen lds
  s_add_u32 m0, s32, 80896
  s_add_u32 s24, s33, 114688
  buffer_load_dwordx4 v9, s[12:15], s24 offen lds
  s_add_u32 m0, s32, 84992
  s_add_u32 s24, s33, 229376
  buffer_load_dwordx4 v8, s[8:11], s24 offen lds
  s_add_u32 m0, s32, 89088
  s_add_u32 s24, s33, 344064
  buffer_load_dwordx4 v8, s[8:11], s24 offen lds
  s_add_u32 m0, s32, 93184
  s_add_u32 s24, s33, 229376
  buffer_load_dwordx4 v9, s[12:15], s24 offen lds
  s_add_u32 m0, s32, 97280
  s_add_u32 s24, s33, 344064
  buffer_load_dwordx4 v9, s[12:15], s24 offen lds
  s_waitcnt vmcnt(4)
  s_barrier
  s_add_u32 m0, s32, 101376
  s_add_u32 s24, s33, 458752
  buffer_load_dwordx4 v8, s[8:11], s24 offen lds
  s_add_u32 m0, s32, 105472
  s_add_u32 s24, s33, 573440
  buffer_load_dwordx4 v8, s[8:11], s24 offen lds
  s_add_u32 m0, s32, 109568
  s_add_u32 s24, s33, 458752
  buffer_load_dwordx4 v9, s[12:15], s24 offen lds
  s_add_u32 m0, s32, 113664
  s_add_u32 s24, s33, 573440
  buffer_load_dwordx4 v9, s[12:15], s24 offen lds
  v_add_u32 v11, 68608, v10
  ds_read_b64_tr_b16 a[128:129], v11 offset:0
  ds_read_b64_tr_b16 a[130:131], v11 offset:512
  ds_read_b64_tr_b16 a[132:133], v11 offset:2048
  ds_read_b64_tr_b16 a[134:135], v11 offset:2560
  ds_read_b64_tr_b16 a[136:137], v11 offset:4096
  ds_read_b64_tr_b16 a[138:139], v11 offset:4608
  ds_read_b64_tr_b16 a[140:141], v11 offset:6144
  ds_read_b64_tr_b16 a[142:143], v11 offset:6656
  s_waitcnt lgkmcnt(0)
  s_waitcnt vmcnt(4)
  s_barrier
  s_add_u32 m0, s32, 68608
  s_add_u32 s24, s33, 688128
  buffer_load_dwordx4 v8, s[8:11], s24 offen lds
  s_add_u32 m0, s32, 72704
  s_add_u32 s24, s33, 802816
  buffer_load_dwordx4 v8, s[8:11], s24 offen lds
  s_add_u32 m0, s32, 76800
  s_add_u32 s24, s33, 688128
  buffer_load_dwordx4 v9, s[12:15], s24 offen lds
  s_add_u32 m0, s32, 80896
  s_add_u32 s24, s33, 802816
  buffer_load_dwordx4 v9, s[12:15], s24 offen lds
  v_add_u32 v11, 84992, v10
  ds_read_b64_tr_b16 a[144:145], v11 offset:0
  ds_read_b64_tr_b16 a[146:147], v11 offset:512
  ds_read_b64_tr_b16 a[148:149], v11 offset:2048
  ds_read_b64_tr_b16 a[150:151], v11 offset:2560
  ds_read_b64_tr_b16 a[152:153], v11 offset:4096
  ds_read_b64_tr_b16 a[154:155], v11 offset:4608
  ds_read_b64_tr_b16 a[156:157], v11 offset:6144
  ds_read_b64_tr_b16 a[158:159], v11 offset:6656
  s_waitcnt lgkmcnt(0)
  s_waitcnt vmcnt(4)
  s_barrier
  s_add_u32 m0, s32, 84992
  s_add_u32 s24, s33, 917504
  buffer_load_dwordx4 v8, s[8:11], s24 offen lds
  s_add_u32 m0, s32, 89088
  s_add_u32 s24, s33, 1032192
  buffer_load_dwordx4 v8, s[8:11], s24 offen lds
  s_add_u32 m0, s32, 93184
  s_add_u32 s24, s33, 917504
  buffer_load_dwordx4 v9, s[12:15], s24 offen lds
  s_add_u32 m0, s32, 97280
  s_add_u32 s24, s33, 1032192
  buffer_load_dwordx4 v9, s[12:15], s24 offen lds
  v_add_u32 v11, 101376, v10
  ds_read_b64_tr_b16 a[160:161], v11 offset:0
  ds_read_b64_tr_b16 a[162:163], v11 offset:512
  ds_read_b64_tr_b16 a[164:165], v11 offset:2048
  ds_read_b64_tr_b16 a[166:167], v11 offset:2560
  ds_read_b64_tr_b16 a[168:169], v11 offset:4096
  ds_read_b64_tr_b16 a[170:171], v11 offset:4608
  ds_read_b64_tr_b16 a[172:173], v11 offset:6144
  ds_read_b64_tr_b16 a[174:175], v11 offset:6656
  s_waitcnt lgkmcnt(0)
  s_waitcnt vmcnt(4)
  s_barrier
  s_add_u32 m0, s32, 101376
  s_add_u32 s24, s33, 1146880
  buffer_load_dwordx4 v8, s[8:11], s24 offen lds
  s_add_u32 m0, s32, 105472
  s_add_u32 s24, s33, 1261568
  buffer_load_dwordx4 v8, s[8:11], s24 offen lds
  s_add_u32 m0, s32, 109568
  s_add_u32 s24, s33, 1146880
  buffer_load_dwordx4 v9, s[12:15], s24 offen lds
  s_add_u32 m0, s32, 113664
  s_add_u32 s24, s33, 1261568
  buffer_load_dwordx4 v9, s[12:15], s24 offen lds
  v_add_u32 v11, 68608, v10
  ds_read_b64_tr_b16 a[176:177], v11 offset:0
  ds_read_b64_tr_b16 a[178:179], v11 offset:512
  ds_read_b64_tr_b16 a[180:181], v11 offset:2048
  ds_read_b64_tr_b16 a[182:183], v11 offset:2560
  ds_read_b64_tr_b16 a[184:185], v11 offset:4096
  ds_read_b64_tr_b16 a[186:187], v11 offset:4608
  ds_read_b64_tr_b16 a[188:189], v11 offset:6144
  ds_read_b64_tr_b16 a[190:191], v11 offset:6656
  s_waitcnt lgkmcnt(0)
  s_waitcnt vmcnt(4)
  s_barrier
  s_add_u32 m0, s32, 68608
  s_add_u32 s24, s33, 1376256
  buffer_load_dwordx4 v8, s[8:11], s24 offen lds
  s_add_u32 m0, s32, 72704
  s_add_u32 s24, s33, 1490944
  buffer_load_dwordx4 v8, s[8:11], s24 offen lds
  s_add_u32 m0, s32, 76800
  s_add_u32 s24, s33, 1376256
  buffer_load_dwordx4 v9, s[12:15], s24 offen lds
  s_add_u32 m0, s32, 80896
  s_add_u32 s24, s33, 1490944
  buffer_load_dwordx4 v9, s[12:15], s24 offen lds
  v_add_u32 v11, 84992, v10
  ds_read_b64_tr_b16 a[192:193], v11 offset:0
  ds_read_b64_tr_b16 a[194:195], v11 offset:512
  ds_read_b64_tr_b16 a[196:197], v11 offset:2048
  ds_read_b64_tr_b16 a[198:199], v11 offset:2560
  ds_read_b64_tr_b16 a[200:201], v11 offset:4096
  ds_read_b64_tr_b16 a[202:203], v11 offset:4608
  ds_read_b64_tr_b16 a[204:205], v11 offset:6144
  ds_read_b64_tr_b16 a[206:207], v11 offset:6656
  s_waitcnt lgkmcnt(0)
  s_waitcnt vmcnt(4)
  s_barrier
  s_add_u32 m0, s32, 84992
  s_add_u32 s24, s33, 1605632
  buffer_load_dwordx4 v8, s[8:11], s24 offen lds
  s_add_u32 m0, s32, 89088
  s_add_u32 s24, s33, 1720320
  buffer_load_dwordx4 v8, s[8:11], s24 offen lds
  s_add_u32 m0, s32, 93184
  s_add_u32 s24, s33, 1605632
  buffer_load_dwordx4 v9, s[12:15], s24 offen lds
  s_add_u32 m0, s32, 97280
  s_add_u32 s24, s33, 1720320
  buffer_load_dwordx4 v9, s[12:15], s24 offen lds
  v_add_u32 v11, 101376, v10
  ds_read_b64_tr_b16 a[208:209], v11 offset:0
  ds_read_b64_tr_b16 a[210:211], v11 offset:512
  ds_read_b64_tr_b16 a[212:213], v11 offset:2048
  ds_read_b64_tr_b16 a[214:215], v11 offset:2560
  ds_read_b64_tr_b16 a[216:217], v11 offset:4096
  ds_read_b64_tr_b16 a[218:219], v11 offset:4608
  ds_read_b64_tr_b16 a[220:221], v11 offset:6144
  ds_read_b64_tr_b16 a[222:223], v11 offset:6656
  s_waitcnt lgkmcnt(0)
  s_waitcnt vmcnt(4)
  s_barrier
  v_add_u32 v11, 68608, v10
  ds_read_b64_tr_b16 a[224:225], v11 offset:0
  ds_read_b64_tr_b16 a[226:227], v11 offset:512
  ds_read_b64_tr_b16 a[228:229], v11 offset:2048
  ds_read_b64_tr_b16 a[230:231], v11 offset:2560
  ds_read_b64_tr_b16 a[232:233], v11 offset:4096
  ds_read_b64_tr_b16 a[234:235], v11 offset:4608
  ds_read_b64_tr_b16 a[236:237], v11 offset:6144
  ds_read_b64_tr_b16 a[238:239], v11 offset:6656
  s_waitcnt lgkmcnt(0)
  s_waitcnt vmcnt(0)
  s_barrier
  v_add_u32 v11, 84992, v10
  ds_read_b64_tr_b16 a[240:241], v11 offset:0
  ds_read_b64_tr_b16 a[242:243], v11 offset:512
  ds_read_b64_tr_b16 a[244:245], v11 offset:2048
  ds_read_b64_tr_b16 a[246:247], v11 offset:2560
  ds_read_b64_tr_b16 a[248:249], v11 offset:4096
  ds_read_b64_tr_b16 a[250:251], v11 offset:4608
  ds_read_b64_tr_b16 a[252:253], v11 offset:6144
  ds_read_b64_tr_b16 a[254:255], v11 offset:6656
  s_waitcnt lgkmcnt(0)
L_f1b_skipw:
  v_mov_b32 v19, 0xbdd2d3e8
  v_mov_b64 v[80:81], 0
  v_mov_b64 v[160:161], 0
  v_mov_b64 v[82:83], 0
  v_mov_b64 v[162:163], 0
  v_mov_b64 v[84:85], 0
  v_mov_b64 v[164:165], 0
  v_mov_b64 v[86:87], 0
  v_mov_b64 v[166:167], 0
  v_mov_b64 v[88:89], 0
  v_mov_b64 v[168:169], 0
  v_mov_b64 v[90:91], 0
  v_mov_b64 v[170:171], 0
  v_mov_b64 v[92:93], 0
  v_mov_b64 v[172:173], 0
  v_mov_b64 v[94:95], 0
  v_mov_b64 v[174:175], 0
  s_lshl_b32 s24, s21, 11
  v_add_u32 v21, s24, v2
  v_lshrrev_b32 v22, 3, v0
  v_lshlrev_b32 v22, 2, v22
  v_add_u32 v22, 66560, v22
  v_and_b32_e64 v18, 31, v1
  v_lshlrev_b32 v18, 2, v18
  v_add_u32 v18, 66432, v18
  s_mov_b32 s30, 0
  s_mov_b32 s28, s22
  s_mov_b32 s31, 0
  s_mov_b32 s70, 0x40000000
  s_mov_b32 s74, 0x40000000
  s_mov_b32 s71, 0x40000000
L_f1b:
  s_add_u32 s72, s28, 7
  s_min_u32 s72, s72, 63
  s_lshl_b32 s72, s72, 15
  s_sub_u32 s35, 33280, s31
  s_mul_i32 s73, s21, 1040
  s_add_u32 s73, s73, s35
  v_add_u32 v7, s31, v6
  s_waitcnt vmcnt(3)
  s_barrier
  s_cmp_eq_u32 s34, 0
  s_cbranch_scc1 L_f1b_noffn
  ds_read_b128 v[24:27], v7 offset:0
  ds_read_b128 v[28:31], v7 offset:32
  ds_read_b128 v[32:35], v7 offset:64
  ds_read_b128 v[36:39], v7 offset:96
  s_waitcnt lgkmcnt(3)
  v_mfma_f32_32x32x16_bf16 v[64:79], a[0:3], v[24:27], 0
  ds_read_b32 v16, v18
  v_add_u32_e64 v11, s31, v17
  v_mfma_f32_32x32x16_bf16 v[80:95], a[128:131], v[24:27], 0
  s_add_u32 m0, s73, 0
  s_add_u32 s26, s72, 0
  buffer_load_dwordx4 v3, s[16:19], s26 offen lds
  ds_read_b128 v[24:27], v7 offset:128
  s_waitcnt lgkmcnt(4)
  v_mfma_f32_32x32x16_bf16 v[64:79], a[4:7], v[28:31], v[64:79]
  ds_read_b128 v[128:131], v11 offset:0
  v_mfma_f32_32x32x16_bf16 v[80:95], a[132:135], v[28:31], v[80:95]
  s_add_u32 m0, s73, 4160
  s_add_u32 s26, s72, 4096
  buffer_load_dwordx4 v3, s[16:19], s26 offen lds
  ds_read_b128 v[132:135], v11 offset:128
  ds_read_b128 v[28:31], v7 offset:160
  s_waitcnt lgkmcnt(6)
  v_mfma_f32_32x32x16_bf16 v[64:79], a[8:11], v[32:35], v[64:79]
  ds_read_b128 v[136:139], v11 offset:256
  v_mul_f32 v176, v160, v160
  v_fmaak_f32 v176, v19, v176, 0xc0135761
  v_mul_f32_e64 v176, v176, v160
  v_mfma_f32_32x32x16_bf16 v[80:95], a[136:139], v[32:35], v[80:95]
  s_add_u32 m0, s73, 8320
  s_add_u32 s26, s72, 8192
  buffer_load_dwordx4 v3, s[16:19], s26 offen lds
  ds_read_b128 v[140:143], v11 offset:384
  v_exp_f32 v176, v176
  v_mul_f32 v177, v161, v161
  v_fmaak_f32 v177, v19, v177, 0xc0135761
  ds_read_b128 v[32:35], v7 offset:192
  s_waitcnt lgkmcnt(8)
  v_mfma_f32_32x32x16_bf16 v[64:79], a[12:15], v[36:39], v[64:79]
  ds_read_b128 v[144:147], v11 offset:512
  v_mul_f32 v177, v177, v161
  v_exp_f32 v177, v177
  v_mul_f32 v178, v162, v162
  v_mfma_f32_32x32x16_bf16 v[80:95], a[140:143], v[36:39], v[80:95]
  s_add_u32 m0, s73, 12480
  s_add_u32 s26, s72, 12288
  buffer_load_dwordx4 v3, s[16:19], s26 offen lds
  ds_read_b128 v[148:151], v11 offset:640
  v_fmaak_f32 v178, v19, v178, 0xc0135761
  v_mul_f32_e64 v178, v178, v162
  v_exp_f32 v178, v178
  ds_read_b128 v[36:39], v7 offset:224
  s_waitcnt lgkmcnt(9)
  v_mfma_f32_32x32x16_bf16 v[64:79], a[16:19], v[24:27], v[64:79]
  ds_read_b128 v[152:155], v11 offset:768
  v_mul_f32_e64 v179, v163, v163
  v_fmaak_f32 v179, v19, v179, 0xc0135761
  v_mul_f32_e64 v179, v179, v163
  v_mfma_f32_32x32x16_bf16 v[80:95], a[144:147], v[24:27], v[80:95]
  s_add_u32 m0, s73, 16640
  s_add_u32 s26, s72, 16384
  buffer_load_dwordx4 v3, s[16:19], s26 offen lds
  ds_read_b128 v[156:159], v11 offset:896
  v_exp_f32 v179, v179
  v_mul_f32 v180, v164, v164
  v_fmaak_f32 v180, v19, v180, 0xc0135761
  ds_read_b128 v[24:27], v7 offset:256
  s_waitcnt lgkmcnt(9)
  v_mfma_f32_32x32x16_bf16 v[64:79], a[20:23], v[28:31], v[64:79]
  v_mul_f32 v180, v180, v164
  v_exp_f32 v180, v180
  v_mul_f32 v181, v165, v165
  v_mfma_f32_32x32x16_bf16 v[80:95], a[148:151], v[28:31], v[80:95]
  s_add_u32 m0, s73, 20800
  s_add_u32 s26, s72, 20480
  buffer_load_dwordx4 v3, s[16:19], s26 offen lds
  v_fmaak_f32 v181, v19, v181, 0xc0135761
  v_mul_f32 v181, v181, v165
  v_exp_f32 v181, v181
  ds_read_b128 v[28:31], v7 offset:288
  s_waitcnt lgkmcnt(7)
  v_mfma_f32_32x32x16_bf16 v[64:79], a[24:27], v[32:35], v[64:79]
  v_mul_f32 v182, v166, v166
  v_fmaak_f32 v182, v19, v182, 0xc0135761
  v_mul_f32_e64 v182, v182, v166
  v_mfma_f32_32x32x16_bf16 v[80:95], a[152:155], v[32:35], v[80:95]
  s_add_u32 m0, s73, 24960
  s_add_u32 s26, s72, 24576
  buffer_load_dwordx4 v3, s[16:19], s26 offen lds
  v_exp_f32 v182, v182
  v_mul_f32 v183, v167, v167
  v_fmaak_f32 v183, v19, v183, 0xc0135761
  ds_read_b128 v[32:35], v7 offset:320
  s_waitcnt lgkmcnt(5)
  v_mfma_f32_32x32x16_bf16 v[64:79], a[28:31], v[36:39], v[64:79]
  v_mul_f32 v183, v183, v167
  v_exp_f32_e64 v183, v183
  v_mfma_f32_32x32x16_bf16 v[80:95], a[156:159], v[36:39], v[80:95]
  s_add_u32 m0, s73, 29120
  s_add_u32 s26, s72, 28672
  buffer_load_dwordx4 v3, s[16:19], s26 offen lds
  v_sub_f32 v16, 1.0, v16
  v_add_f32 v176, 1.0, v176
  v_mul_f32 v168, v168, v16
  ds_read_b128 v[36:39], v7 offset:352
  s_waitcnt lgkmcnt(3)
  v_mfma_f32_32x32x16_bf16 v[64:79], a[32:35], v[24:27], v[64:79]
  v_rcp_f32 v176, v176
  v_add_f32 v177, 1.0, v177
  v_mul_f32 v169, v169, v16
  v_rcp_f32 v177, v177
  v_mfma_f32_32x32x16_bf16 v[80:95], a[160:163], v[24:27], v[80:95]
  v_add_f32 v178, 1.0, v178
  v_mul_f32 v170, v170, v16
  v_rcp_f32 v178, v178
  v_add_f32 v179, 1.0, v179
  buffer_store_dwordx4 v[40:43], v21, s[4:7], s74 offen offset:0
  ds_read_b128 v[24:27], v7 offset:384
  s_waitcnt lgkmcnt(3)
  v_mfma_f32_32x32x16_bf16 v[64:79], a[36:39], v[28:31], v[64:79]
  v_mul_f32 v171, v171, v16
  v_rcp_f32 v179, v179
  v_add_f32 v180, 1.0, v180
  v_mul_f32_e64 v172, v172, v16
  buffer_store_dwordx4 v[44:47], v21, s[4:7], s74 offen offset:1024
  v_mfma_f32_32x32x16_bf16 v[80:95], a[164:167], v[28:31], v[80:95]
  v_rcp_f32 v180, v180
  v_add_f32 v181, 1.0, v181
  v_mul_f32 v173, v173, v16
  v_rcp_f32 v181, v181
  ds_read_b128 v[28:31], v7 offset:416
  s_waitcnt lgkmcnt(3)
  v_mfma_f32_32x32x16_bf16 v[64:79], a[40:43], v[32:35], v[64:79]
  v_add_f32 v182, 1.0, v182
  v_mul_f32 v174, v174, v16
  v_rcp_f32 v182, v182
  v_add_f32_e64 v183, 1.0, v183
  v_mfma_f32_32x32x16_bf16 v[80:95], a[168:171], v[32:35], v[80:95]
  v_mul_f32 v175, v175, v16
  v_rcp_f32 v183, v183
  v_mul_f32 v176, v176, v168
  v_mul_f32 v177, v177, v169
  ds_read_b128 v[32:35], v7 offset:448
  s_waitcnt lgkmcnt(3)
  v_mfma_f32_32x32x16_bf16 v[64:79], a[44:47], v[36:39], v[64:79]
  v_mul_f32 v178, v178, v170
  v_mul_f32 v179, v179, v171
  v_mul_f32 v180, v180, v172
  v_mul_f32_e64 v181, v181, v173
  v_mfma_f32_32x32x16_bf16 v[80:95], a[172:175], v[36:39], v[80:95]
  v_mul_f32 v182, v182, v174
  v_mul_f32 v183, v183, v175
  v_cvt_pk_bf16_f32 v48, v176, v177
  v_cvt_pk_bf16_f32 v49, v178, v179
  ds_read_b128 v[36:39], v7 offset:480
  s_waitcnt lgkmcnt(3)
  v_mfma_f32_32x32x16_bf16 v[64:79], a[48:51], v[24:27], v[64:79]
  v_cvt_pk_bf16_f32 v50, v180, v181
  v_cvt_pk_bf16_f32 v51, v182, v183
  v_mfma_f32_32x32x16_bf16 v[80:95], a[176:179], v[24:27], v[80:95]
  ds_read_b128 v[24:27], v7 offset:512
  s_waitcnt lgkmcnt(3)
  v_mfma_f32_32x32x16_bf16 v[64:79], a[52:55], v[28:31], v[64:79]
  v_mfma_f32_32x32x16_bf16 v[80:95], a[180:183], v[28:31], v[80:95]
  ds_read_b128 v[28:31], v7 offset:544
  s_waitcnt lgkmcnt(3)
  v_mfma_f32_32x32x16_bf16 v[64:79], a[56:59], v[32:35], v[64:79]
  v_mfma_f32_32x32x16_bf16 v[80:95], a[184:187], v[32:35], v[80:95]
  ds_read_b128 v[32:35], v7 offset:576
  s_waitcnt lgkmcnt(3)
  v_mfma_f32_32x32x16_bf16 v[64:79], a[60:63], v[36:39], v[64:79]
  s_add_u32 s27, s70, 0x6000
  buffer_store_dwordx4 v[48:51], v3, s[4:7], s27 offen
  v_mfma_f32_32x32x16_bf16 v[80:95], a[188:191], v[36:39], v[80:95]
  ds_read_b128 v[36:39], v7 offset:608
  s_waitcnt lgkmcnt(3)
  v_mfma_f32_32x32x16_bf16 v[64:79], a[64:67], v[24:27], v[64:79]
  v_dot2_f32_bf16 v12, v128, v96, 0
  v_mfma_f32_32x32x16_bf16 v[80:95], a[192:195], v[24:27], v[80:95]
  v_dot2_f32_bf16 v13, v129, v97, 0
  v_dot2_f32_bf16 v12, v130, v98, v12
  ds_read_b128 v[24:27], v7 offset:640
  s_waitcnt lgkmcnt(3)
  v_mfma_f32_32x32x16_bf16 v[64:79], a[68:71], v[28:31], v[64:79]
  v_dot2_f32_bf16 v13, v131, v99, v13
  v_dot2_f32_bf16 v12, v132, v100, v12
  v_mfma_f32_32x32x16_bf16 v[80:95], a[196:199], v[28:31], v[80:95]
  v_dot2_f32_bf16 v13, v133, v101, v13
  v_dot2_f32_bf16 v12, v134, v102, v12
  ds_read_b128 v[28:31], v7 offset:672
  s_waitcnt lgkmcnt(3)
  v_mfma_f32_32x32x16_bf16 v[64:79], a[72:75], v[32:35], v[64:79]
  v_dot2_f32_bf16 v13, v135, v103, v13
  v_dot2_f32_bf16 v12, v136, v104, v12
  v_mfma_f32_32x32x16_bf16 v[80:95], a[200:203], v[32:35], v[80:95]
  v_dot2_f32_bf16 v13, v137, v105, v13
  v_dot2_f32_bf16 v12, v138, v106, v12
  ds_read_b128 v[32:35], v7 offset:704
  s_waitcnt lgkmcnt(3)
  v_mfma_f32_32x32x16_bf16 v[64:79], a[76:79], v[36:39], v[64:79]
  v_dot2_f32_bf16 v13, v139, v107, v13
  v_dot2_f32_bf16 v12, v140, v108, v12
  v_mfma_f32_32x32x16_bf16 v[80:95], a[204:207], v[36:39], v[80:95]
  v_dot2_f32_bf16 v13, v141, v109, v13
  v_dot2_f32_bf16 v12, v142, v110, v12
  ds_read_b128 v[36:39], v7 offset:736
  s_waitcnt lgkmcnt(3)
  v_mfma_f32_32x32x16_bf16 v[64:79], a[80:83], v[24:27], v[64:79]
  v_dot2_f32_bf16 v13, v143, v111, v13
  v_dot2_f32_bf16 v12, v144, v112, v12
  v_mfma_f32_32x32x16_bf16 v[80:95], a[208:211], v[24:27], v[80:95]
  v_dot2_f32_bf16 v13, v145, v113, v13
  v_dot2_f32_bf16 v12, v146, v114, v12
  ds_read_b128 v[24:27], v7 offset:768
  s_waitcnt lgkmcnt(3)
  v_mfma_f32_32x32x16_bf16 v[64:79], a[84:87], v[28:31], v[64:79]
  v_dot2_f32_bf16 v13, v147, v115, v13
  v_dot2_f32_bf16 v12, v148, v116, v12
  v_mfma_f32_32x32x16_bf16 v[80:95], a[212:215], v[28:31], v[80:95]
  v_dot2_f32_bf16 v13, v149, v117, v13
  v_dot2_f32_bf16 v12, v150, v118, v12
  ds_read_b128 v[28:31], v7 offset:800
  s_waitcnt lgkmcnt(3)
  v_mfma_f32_32x32x16_bf16 v[64:79], a[88:91], v[32:35], v[64:79]
  v_dot2_f32_bf16 v13, v151, v119, v13
  v_dot2_f32_bf16 v12, v152, v120, v12
  v_mfma_f32_32x32x16_bf16 v[80:95], a[216:219], v[32:35], v[80:95]
  v_dot2_f32_bf16 v13, v153, v121, v13
  v_dot2_f32_bf16 v12, v154, v122, v12
  ds_read_b128 v[32:35], v7 offset:832
  s_waitcnt lgkmcnt(3)
  v_mfma_f32_32x32x16_bf16 v[64:79], a[92:95], v[36:39], v[64:79]
  v_dot2_f32_bf16 v13, v155, v123, v13
  v_dot2_f32_bf16 v12, v156, v124, v12
  v_mfma_f32_32x32x16_bf16 v[80:95], a[220:223], v[36:39], v[80:95]
  v_dot2_f32_bf16 v13, v157, v125, v13
  v_dot2_f32_bf16 v12, v158, v126, v12
  ds_read_b128 v[36:39], v7 offset:864
  s_waitcnt lgkmcnt(3)
  v_mfma_f32_32x32x16_bf16 v[64:79], a[96:99], v[24:27], v[64:79]
  v_dot2_f32_bf16 v13, v159, v127, v13
  v_mfma_f32_32x32x16_bf16 v[80:95], a[224:227], v[24:27], v[80:95]
  ds_read_b128 v[24:27], v7 offset:896
  s_waitcnt lgkmcnt(3)
  v_mfma_f32_32x32x16_bf16 v[64:79], a[100:103], v[28:31], v[64:79]
  v_add_f32_e64 v12, v12, v13
  v_mfma_f32_32x32x16_bf16 v[80:95], a[228:231], v[28:31], v[80:95]
  s_nop 0
  v_add_f32_dpp v12, v12, v12 quad_perm:[1,0,3,2] row_mask:0xf bank_mask:0xf
  ds_read_b128 v[28:31], v7 offset:928
  s_waitcnt lgkmcnt(3)
  v_mfma_f32_32x32x16_bf16 v[64:79], a[104:107], v[32:35], v[64:79]
  v_add_f32_dpp v12, v12, v12 quad_perm:[2,3,0,1] row_mask:0xf bank_mask:0xf
  v_mfma_f32_32x32x16_bf16 v[80:95], a[232:235], v[32:35], v[80:95]
  s_nop 0
  v_add_f32_dpp v12, v12, v12 row_half_mirror row_mask:0xf bank_mask:0xf
  ds_read_b128 v[32:35], v7 offset:960
  s_waitcnt lgkmcnt(3)
  v_mfma_f32_32x32x16_bf16 v[64:79], a[108:111], v[36:39], v[64:79]
  v_mul_f32 v12, 0xbfb8aa3b, v12
  v_mfma_f32_32x32x16_bf16 v[80:95], a[236:239], v[36:39], v[80:95]
  v_exp_f32 v12, v12
  ds_read_b128 v[36:39], v7 offset:992
  s_waitcnt lgkmcnt(3)
  v_mfma_f32_32x32x16_bf16 v[64:79], a[112:115], v[24:27], v[64:79]
  v_add_f32_e64 v12, 1.0, v12
  v_mfma_f32_32x32x16_bf16 v[80:95], a[240:243], v[24:27], v[80:95]
  v_rcp_f32 v12, v12
  s_waitcnt lgkmcnt(2)
  v_mfma_f32_32x32x16_bf16 v[64:79], a[116:119], v[28:31], v[64:79]
  ds_write_b32 v22, v12
  v_mfma_f32_32x32x16_bf16 v[80:95], a[244:247], v[28:31], v[80:95]
  s_waitcnt lgkmcnt(2)
  v_mfma_f32_32x32x16_bf16 v[64:79], a[120:123], v[32:35], v[64:79]
  v_mfma_f32_32x32x16_bf16 v[80:95], a[248:251], v[32:35], v[80:95]
  s_waitcnt lgkmcnt(1)
  v_mfma_f32_32x32x16_bf16 v[64:79], a[124:127], v[36:39], v[64:79]
  v_mfma_f32_32x32x16_bf16 v[80:95], a[252:255], v[36:39], v[80:95]
  s_branch L_f1b_join
L_f1b_noffn:
  ds_read_b128 v[24:27], v7 offset:0
  ds_read_b128 v[28:31], v7 offset:32
  ds_read_b128 v[32:35], v7 offset:64
  ds_read_b128 v[36:39], v7 offset:96
  s_waitcnt lgkmcnt(3)
  v_mfma_f32_32x32x16_bf16 v[64:79], a[0:3], v[24:27], 0
  ds_read_b32 v16, v18
  v_add_u32 v11, s31, v17
  s_add_u32 m0, s73, 0
  s_add_u32 s26, s72, 0
  buffer_load_dwordx4 v3, s[16:19], s26 offen lds
  ds_read_b128 v[24:27], v7 offset:128
  s_waitcnt lgkmcnt(4)
  v_mfma_f32_32x32x16_bf16 v[64:79], a[4:7], v[28:31], v[64:79]
  ds_read_b128 v[128:131], v11 offset:0
  s_add_u32 m0, s73, 4160
  s_add_u32 s26, s72, 4096
  buffer_load_dwordx4 v3, s[16:19], s26 offen lds
  ds_read_b128 v[132:135], v11 offset:128
  ds_read_b128 v[28:31], v7 offset:160
  s_waitcnt lgkmcnt(6)
  v_mfma_f32_32x32x16_bf16 v[64:79], a[8:11], v[32:35], v[64:79]
  ds_read_b128 v[136:139], v11 offset:256
  v_mul_f32 v176, v160, v160
  v_fmaak_f32 v176, v19, v176, 0xc0135761
  v_mul_f32_e64 v176, v176, v160
  s_add_u32 m0, s73, 8320
  s_add_u32 s26, s72, 8192
  buffer_load_dwordx4 v3, s[16:19], s26 offen lds
  ds_read_b128 v[140:143], v11 offset:384
  v_exp_f32 v176, v176
  v_mul_f32 v177, v161, v161
  v_fmaak_f32 v177, v19, v177, 0xc0135761
  ds_read_b128 v[32:35], v7 offset:192
  s_waitcnt lgkmcnt(8)
  v_mfma_f32_32x32x16_bf16 v[64:79], a[12:15], v[36:39], v[64:79]
  ds_read_b128 v[144:147], v11 offset:512
  v_mul_f32 v177, v177, v161
  v_exp_f32 v177, v177
  v_mul_f32 v178, v162, v162
  s_add_u32 m0, s73, 12480
  s_add_u32 s26, s72, 12288
  buffer_load_dwordx4 v3, s[16:19], s26 offen lds
  ds_read_b128 v[148:151], v11 offset:640
  v_fmaak_f32 v178, v19, v178, 0xc0135761
  v_mul_f32_e64 v178, v178, v162
  v_exp_f32 v178, v178
  ds_read_b128 v[36:39], v7 offset:224
  s_waitcnt lgkmcnt(9)
  v_mfma_f32_32x32x16_bf16 v[64:79], a[16:19], v[24:27], v[64:79]
  ds_read_b128 v[152:155], v11 offset:768
  v_mul_f32_e64 v179, v163, v163
  v_fmaak_f32 v179, v19, v179, 0xc0135761
  v_mul_f32_e64 v179, v179, v163
  s_add_u32 m0, s73, 16640
  s_add_u32 s26, s72, 16384
  buffer_load_dwordx4 v3, s[16:19], s26 offen lds
  ds_read_b128 v[156:159], v11 offset:896
  v_exp_f32 v179, v179
  v_mul_f32 v180, v164, v164
  v_fmaak_f32 v180, v19, v180, 0xc0135761
  ds_read_b128 v[24:27], v7 offset:256
  s_waitcnt lgkmcnt(9)
  v_mfma_f32_32x32x16_bf16 v[64:79], a[20:23], v[28:31], v[64:79]
  v_mul_f32 v180, v180, v164
  v_exp_f32 v180, v180
  v_mul_f32 v181, v165, v165
  s_add_u32 m0, s73, 20800
  s_add_u32 s26, s72, 20480
  buffer_load_dwordx4 v3, s[16:19], s26 offen lds
  v_fmaak_f32 v181, v19, v181, 0xc0135761
  v_mul_f32 v181, v181, v165
  v_exp_f32 v181, v181
  ds_read_b128 v[28:31], v7 offset:288
  s_waitcnt lgkmcnt(7)
  v_mfma_f32_32x32x16_bf16 v[64:79], a[24:27], v[32:35], v[64:79]
  v_mul_f32 v182, v166, v166
  v_fmaak_f32 v182, v19, v182, 0xc0135761
  v_mul_f32_e64 v182, v182, v166
  s_add_u32 m0, s73, 24960
  s_add_u32 s26, s72, 24576
  buffer_load_dwordx4 v3, s[16:19], s26 offen lds
  v_exp_f32 v182, v182
  v_mul_f32 v183, v167, v167
  v_fmaak_f32 v183, v19, v183, 0xc0135761
  ds_read_b128 v[32:35], v7 offset:320
  s_waitcnt lgkmcnt(5)
  v_mfma_f32_32x32x16_bf16 v[64:79], a[28:31], v[36:39], v[64:79]
  v_mul_f32 v183, v183, v167
  v_exp_f32_e64 v183, v183
  s_add_u32 m0, s73, 29120
  s_add_u32 s26, s72, 28672
  buffer_load_dwordx4 v3, s[16:19], s26 offen lds
  v_sub_f32 v16, 1.0, v16
  v_add_f32 v176, 1.0, v176
  v_mul_f32 v168, v168, v16
  ds_read_b128 v[36:39], v7 offset:352
  s_waitcnt lgkmcnt(3)
  v_mfma_f32_32x32x16_bf16 v[64:79], a[32:35], v[24:27], v[64:79]
  v_rcp_f32 v176, v176
  v_add_f32 v177, 1.0, v177
  v_mul_f32 v169, v169, v16
  v_rcp_f32 v177, v177
  v_add_f32 v178, 1.0, v178
  v_mul_f32 v170, v170, v16
  v_rcp_f32 v178, v178
  v_add_f32 v179, 1.0, v179
  buffer_store_dwordx4 v[40:43], v21, s[4:7], s74 offen offset:0
  ds_read_b128 v[24:27], v7 offset:384
  s_waitcnt lgkmcnt(3)
  v_mfma_f32_32x32x16_bf16 v[64:79], a[36:39], v[28:31], v[64:79]
  v_mul_f32 v171, v171, v16
  v_rcp_f32 v179, v179
  v_add_f32 v180, 1.0, v180
  v_mul_f32_e64 v172, v172, v16
  buffer_store_dwordx4 v[44:47], v21, s[4:7], s74 offen offset:1024
  v_rcp_f32 v180, v180
  v_add_f32 v181, 1.0, v181
  v_mul_f32 v173, v173, v16
  v_rcp_f32 v181, v181
  ds_read_b128 v[28:31], v7 offset:416
  s_waitcnt lgkmcnt(3)
  v_mfma_f32_32x32x16_bf16 v[64:79], a[40:43], v[32:35], v[64:79]
  v_add_f32 v182, 1.0, v182
  v_mul_f32 v174, v174, v16
  v_rcp_f32 v182, v182
  v_add_f32 v183, 1.0, v183
  v_mul_f32 v175, v175, v16
  v_rcp_f32 v183, v183
  v_mul_f32 v176, v176, v168
  v_mul_f32 v177, v177, v169
  ds_read_b128 v[32:35], v7 offset:448
  s_waitcnt lgkmcnt(3)
  v_mfma_f32_32x32x16_bf16 v[64:79], a[44:47], v[36:39], v[64:79]
  v_mul_f32 v178, v178, v170
  v_mul_f32 v179, v179, v171
  v_mul_f32 v180, v180, v172
  v_mul_f32 v181, v181, v173
  v_mul_f32 v182, v182, v174
  v_mul_f32 v183, v183, v175
  v_cvt_pk_bf16_f32 v48, v176, v177
  v_cvt_pk_bf16_f32 v49, v178, v179
  ds_read_b128 v[36:39], v7 offset:480
  s_waitcnt lgkmcnt(3)
  v_mfma_f32_32x32x16_bf16 v[64:79], a[48:51], v[24:27], v[64:79]
  v_cvt_pk_bf16_f32 v50, v180, v181
  v_cvt_pk_bf16_f32 v51, v182, v183
  ds_read_b128 v[24:27], v7 offset:512
  s_waitcnt lgkmcnt(3)
  v_mfma_f32_32x32x16_bf16 v[64:79], a[52:55], v[28:31], v[64:79]
  ds_read_b128 v[28:31], v7 offset:544
  s_waitcnt lgkmcnt(3)
  v_mfma_f32_32x32x16_bf16 v[64:79], a[56:59], v[32:35], v[64:79]
  ds_read_b128 v[32:35], v7 offset:576
  s_waitcnt lgkmcnt(3)
  v_mfma_f32_32x32x16_bf16 v[64:79], a[60:63], v[36:39], v[64:79]
  s_add_u32 s27, s70, 0x6000
  buffer_store_dwordx4 v[48:51], v3, s[4:7], s27 offen
  ds_read_b128 v[36:39], v7 offset:608
  s_waitcnt lgkmcnt(3)
  v_mfma_f32_32x32x16_bf16 v[64:79], a[64:67], v[24:27], v[64:79]
  v_dot2_f32_bf16 v12, v128, v96, 0
  v_dot2_f32_bf16 v13, v129, v97, 0
  v_dot2_f32_bf16 v12, v130, v98, v12
  ds_read_b128 v[24:27], v7 offset:640
  s_waitcnt lgkmcnt(3)
  v_mfma_f32_32x32x16_bf16 v[64:79], a[68:71], v[28:31], v[64:79]
  v_dot2_f32_bf16 v13, v131, v99, v13
  v_dot2_f32_bf16 v12, v132, v100, v12
  v_dot2_f32_bf16 v13, v133, v101, v13
  v_dot2_f32_bf16 v12, v134, v102, v12
  ds_read_b128 v[28:31], v7 offset:672
  s_waitcnt lgkmcnt(3)
  v_mfma_f32_32x32x16_bf16 v[64:79], a[72:75], v[32:35], v[64:79]
  v_dot2_f32_bf16 v13, v135, v103, v13
  v_dot2_f32_bf16 v12, v136, v104, v12
  v_dot2_f32_bf16 v13, v137, v105, v13
  v_dot2_f32_bf16 v12, v138, v106, v12
  ds_read_b128 v[32:35], v7 offset:704
  s_waitcnt lgkmcnt(3)
  v_mfma_f32_32x32x16_bf16 v[64:79], a[76:79], v[36:39], v[64:79]
  v_dot2_f32_bf16 v13, v139, v107, v13
  v_dot2_f32_bf16 v12, v140, v108, v12
  v_dot2_f32_bf16 v13, v141, v109, v13
  v_dot2_f32_bf16 v12, v142, v110, v12
  ds_read_b128 v[36:39], v7 offset:736
  s_waitcnt lgkmcnt(3)
  v_mfma_f32_32x32x16_bf16 v[64:79], a[80:83], v[24:27], v[64:79]
  v_dot2_f32_bf16 v13, v143, v111, v13
  v_dot2_f32_bf16 v12, v144, v112, v12
  v_dot2_f32_bf16 v13, v145, v113, v13
  v_dot2_f32_bf16 v12, v146, v114, v12
  ds_read_b128 v[24:27], v7 offset:768
  s_waitcnt lgkmcnt(3)
  v_mfma_f32_32x32x16_bf16 v[64:79], a[84:87], v[28:31], v[64:79]
  v_dot2_f32_bf16 v13, v147, v115, v13
  v_dot2_f32_bf16 v12, v148, v116, v12
  v_dot2_f32_bf16 v13, v149, v117, v13
  v_dot2_f32_bf16 v12, v150, v118, v12
  ds_read_b128 v[28:31], v7 offset:800
  s_waitcnt lgkmcnt(3)
  v_mfma_f32_32x32x16_bf16 v[64:79], a[88:91], v[32:35], v[64:79]
  v_dot2_f32_bf16 v13, v151, v119, v13
  v_dot2_f32_bf16 v12, v152, v120, v12
  v_dot2_f32_bf16 v13, v153, v121, v13
  v_dot2_f32_bf16 v12, v154, v122, v12
  ds_read_b128 v[32:35], v7 offset:832
  s_waitcnt lgkmcnt(3)
  v_mfma_f32_32x32x16_bf16 v[64:79], a[92:95], v[36:39], v[64:79]
  v_dot2_f32_bf16 v13, v155, v123, v13
  v_dot2_f32_bf16 v12, v156, v124, v12
  v_dot2_f32_bf16 v13, v157, v125, v13
  v_dot2_f32_bf16 v12, v158, v126, v12
  ds_read_b128 v[36:39], v7 offset:864
  s_waitcnt lgkmcnt(3)
  v_mfma_f32_32x32x16_bf16 v[64:79], a[96:99], v[24:27], v[64:79]
  v_dot2_f32_bf16 v13, v159, v127, v13
  ds_read_b128 v[24:27], v7 offset:896
  s_waitcnt lgkmcnt(3)
  v_mfma_f32_32x32x16_bf16 v[64:79], a[100:103], v[28:31], v[64:79]
  v_add_f32 v12, v12, v13
  s_nop 1
  v_add_f32_dpp v12, v12, v12 quad_perm:[1,0,3,2] row_mask:0xf bank_mask:0xf
  ds_read_b128 v[28:31], v7 offset:928
  s_waitcnt lgkmcnt(3)
  v_mfma_f32_32x32x16_bf16 v[64:79], a[104:107], v[32:35], v[64:79]
  v_add_f32_dpp v12, v12, v12 quad_perm:[2,3,0,1] row_mask:0xf bank_mask:0xf
  s_nop 1
  v_add_f32_dpp v12, v12, v12 row_half_mirror row_mask:0xf bank_mask:0xf
  ds_read_b128 v[32:35], v7 offset:960
  s_waitcnt lgkmcnt(3)
  v_mfma_f32_32x32x16_bf16 v[64:79], a[108:111], v[36:39], v[64:79]
  v_mul_f32 v12, 0xbfb8aa3b, v12
  v_exp_f32 v12, v12
  ds_read_b128 v[36:39], v7 offset:992
  s_waitcnt lgkmcnt(3)
  v_mfma_f32_32x32x16_bf16 v[64:79], a[112:115], v[24:27], v[64:79]
  v_add_f32 v12, 1.0, v12
  v_rcp_f32 v12, v12
  s_waitcnt lgkmcnt(2)
  v_mfma_f32_32x32x16_bf16 v[64:79], a[116:119], v[28:31], v[64:79]
  ds_write_b32 v22, v12
  s_waitcnt lgkmcnt(2)
  v_mfma_f32_32x32x16_bf16 v[64:79], a[120:123], v[32:35], v[64:79]
  s_waitcnt lgkmcnt(1)
  v_mfma_f32_32x32x16_bf16 v[64:79], a[124:127], v[36:39], v[64:79]
L_f1b_join:
  s_lshl_b32 s24, s20, 6
  s_add_u32 s24, s24, s28
  s_lshl_b32 s70, s24, 15
  s_lshl_b32 s74, s24, 13
  s_add_u32 s74, s74, 0x4000000
  s_lshl_b32 s24, s20, 10
  s_lshl_b32 s25, s21, 8
  s_add_u32 s24, s24, s25
  s_lshl_b32 s25, s28, 2
  s_add_u32 s24, s24, s25
  s_add_u32 s71, s24, 0x9100000
  s_mov_b32 s31, s35
  s_add_u32 s28, s28, 7
  s_add_u32 s30, s30, 1
  v_mul_f32 v168, v80, v88
  v_mov_b32 v160, v80
  v_mul_f32 v169, v81, v89
  v_mov_b32 v161, v81
  v_mul_f32 v170, v82, v90
  v_mov_b32 v162, v82
  v_mul_f32 v171, v83, v91
  v_mov_b32 v163, v83
  v_mul_f32 v172, v84, v92
  v_mov_b32 v164, v84
  v_mul_f32 v173, v85, v93
  v_mov_b32 v165, v85
  v_mul_f32 v174, v86, v94
  v_mov_b32 v166, v86
  v_mul_f32 v175, v87, v95
  v_mov_b32 v167, v87
  v_cvt_pk_bf16_f32 v40, v64, v65
  v_cvt_pk_bf16_f32 v41, v66, v67
  v_cvt_pk_bf16_f32 v42, v68, v69
  v_cvt_pk_bf16_f32 v43, v70, v71
  v_cvt_pk_bf16_f32 v44, v72, v73
  v_cvt_pk_bf16_f32 v45, v74, v75
  v_cvt_pk_bf16_f32 v46, v76, v77
  v_cvt_pk_bf16_f32 v47, v78, v79
  v_add_u32 v18, 128, v18
  v_add_u32 v22, 128, v22
  s_waitcnt lgkmcnt(0)
  s_cmp_lt_u32 s30, s29
  s_cbranch_scc1 L_f1b
  s_barrier
  ds_read_b32 v16, v18
  buffer_store_dwordx4 v[40:43], v21, s[4:7], s74 offen offset:0
  buffer_store_dwordx4 v[44:47], v21, s[4:7], s74 offen offset:1024
  v_mul_f32_e64 v176, v160, v160
  v_fmaak_f32 v176, v19, v176, 0xc0135761
  v_mul_f32 v176, v176, v160
  v_exp_f32 v176, v176
  v_mul_f32_e64 v177, v161, v161
  v_fmaak_f32 v177, v19, v177, 0xc0135761
  v_mul_f32 v177, v177, v161
  v_exp_f32 v177, v177
  v_mul_f32_e64 v178, v162, v162
  v_fmaak_f32 v178, v19, v178, 0xc0135761
  v_mul_f32 v178, v178, v162
  v_exp_f32 v178, v178
  v_mul_f32_e64 v179, v163, v163
  v_fmaak_f32 v179, v19, v179, 0xc0135761
  v_mul_f32 v179, v179, v163
  v_exp_f32 v179, v179
  v_mul_f32_e64 v180, v164, v164
  v_fmaak_f32 v180, v19, v180, 0xc0135761
  v_mul_f32 v180, v180, v164
  v_exp_f32 v180, v180
  v_mul_f32_e64 v181, v165, v165
  v_fmaak_f32 v181, v19, v181, 0xc0135761
  v_mul_f32 v181, v181, v165
  v_exp_f32 v181, v181
  v_mul_f32_e64 v182, v166, v166
  v_fmaak_f32 v182, v19, v182, 0xc0135761
  v_mul_f32 v182, v182, v166
  v_exp_f32 v182, v182
  v_mul_f32_e64 v183, v167, v167
  v_fmaak_f32 v183, v19, v183, 0xc0135761
  v_mul_f32 v183, v183, v167
  v_exp_f32 v183, v183
  s_waitcnt lgkmcnt(0)
  v_sub_f32 v16, 1.0, v16
  v_add_f32 v176, 1.0, v176
  v_mul_f32 v168, v168, v16
  v_rcp_f32 v176, v176
  v_add_f32 v177, 1.0, v177
  v_mul_f32 v169, v169, v16
  v_rcp_f32 v177, v177
  v_add_f32 v178, 1.0, v178
  v_mul_f32 v170, v170, v16
  v_rcp_f32 v178, v178
  v_add_f32 v179, 1.0, v179
  v_mul_f32 v171, v171, v16
  v_rcp_f32 v179, v179
  v_add_f32 v180, 1.0, v180
  v_mul_f32 v172, v172, v16
  v_rcp_f32 v180, v180
  v_add_f32 v181, 1.0, v181
  v_mul_f32 v173, v173, v16
  v_rcp_f32 v181, v181
  v_add_f32 v182, 1.0, v182
  v_mul_f32 v174, v174, v16
  v_rcp_f32 v182, v182
  v_add_f32 v183, 1.0, v183
  v_mul_f32 v175, v175, v16
  v_rcp_f32 v183, v183
  v_mul_f32 v176, v176, v168
  v_mul_f32 v177, v177, v169
  v_mul_f32 v178, v178, v170
  v_mul_f32 v179, v179, v171
  v_mul_f32 v180, v180, v172
  v_mul_f32 v181, v181, v173
  v_mul_f32 v182, v182, v174
  v_mul_f32 v183, v183, v175
  v_cvt_pk_bf16_f32 v48, v176, v177
  v_cvt_pk_bf16_f32 v49, v178, v179
  v_cvt_pk_bf16_f32 v50, v180, v181
  v_cvt_pk_bf16_f32 v51, v182, v183
  s_add_u32 s27, s70, 0x6000
  buffer_store_dwordx4 v[48:51], v3, s[4:7], s27 offen
  s_waitcnt vmcnt(0)
  s_barrier
  s_mov_b32 s8, s50
  s_mov_b32 s9, s51
  s_mov_b32 s10, 0x400000
  s_mov_b32 s11, 0x20000
  s_mov_b32 s12, s60
  s_mov_b32 s13, s61
  s_mov_b32 s14, 0x1c0000
  s_mov_b32 s15, 0x20000
  v_lshrrev_b32_e64 v11, 5, v1
  v_bfe_u32 v12, v1, 2, 2
  v_lshl_add_u32 v11, v11, 2, v12
  v_mul_u32_u24 v11, 1088, v11
  v_bfe_u32 v12, v1, 4, 1
  v_lshl_add_u32 v11, v12, 5, v11
  v_and_b32_e64 v12, 3, v1
  v_lshl_add_u32 v11, v12, 3, v11
  s_lshl_b32 s24, s21, 8
  v_add_u32 v5, s24, v11
  s_mul_i32 s35, s21, 1088
  s_lshl_b32 s33, s20, 17
  s_add_u32 m0, s35, 68608
  s_add_u32 s24, s33, 0
  buffer_load_dwordx4 v3, s[8:11], s24 offen lds
  s_add_u32 m0, s35, 72960
  s_add_u32 s24, s33, 4096
  buffer_load_dwordx4 v3, s[8:11], s24 offen lds
  s_add_u32 m0, s35, 77312
  s_add_u32 s24, s33, 8192
  buffer_load_dwordx4 v3, s[8:11], s24 offen lds
  s_add_u32 m0, s35, 81664
  s_add_u32 s24, s33, 12288
  buffer_load_dwordx4 v3, s[8:11], s24 offen lds
  s_add_u32 m0, s35, 86016
  s_add_u32 s24, s33, 16384
  buffer_load_dwordx4 v3, s[8:11], s24 offen lds
  s_add_u32 m0, s35, 90368
  s_add_u32 s24, s33, 20480
  buffer_load_dwordx4 v3, s[8:11], s24 offen lds
  s_add_u32 m0, s35, 94720
  s_add_u32 s24, s33, 24576
  buffer_load_dwordx4 v3, s[8:11], s24 offen lds
  s_add_u32 m0, s35, 99072
  s_add_u32 s24, s33, 28672
  buffer_load_dwordx4 v3, s[8:11], s24 offen lds
  s_waitcnt vmcnt(4)
  s_barrier
  s_add_u32 m0, s35, 103424
  s_add_u32 s24, s33, 32768
  buffer_load_dwordx4 v3, s[8:11], s24 offen lds
  s_add_u32 m0, s35, 107776
  s_add_u32 s24, s33, 36864
  buffer_load_dwordx4 v3, s[8:11], s24 offen lds
  s_add_u32 m0, s35, 112128
  s_add_u32 s24, s33, 40960
  buffer_load_dwordx4 v3, s[8:11], s24 offen lds
  s_add_u32 m0, s35, 116480
  s_add_u32 s24, s33, 45056
  buffer_load_dwordx4 v3, s[8:11], s24 offen lds
  v_add_u32 v11, 68608, v5
  ds_read_b64_tr_b16 a[0:1], v11 offset:0
  ds_read_b64_tr_b16 a[2:3], v11 offset:8704
  ds_read_b64_tr_b16 a[32:33], v11 offset:64
  ds_read_b64_tr_b16 a[34:35], v11 offset:8768
  ds_read_b64_tr_b16 a[64:65], v11 offset:128
  ds_read_b64_tr_b16 a[66:67], v11 offset:8832
  ds_read_b64_tr_b16 a[96:97], v11 offset:192
  ds_read_b64_tr_b16 a[98:99], v11 offset:8896
  s_waitcnt lgkmcnt(0)
  s_waitcnt vmcnt(4)
  s_barrier
  s_add_u32 m0, s35, 68608
  s_add_u32 s24, s33, 49152
  buffer_load_dwordx4 v3, s[8:11], s24 offen lds
  s_add_u32 m0, s35, 72960
  s_add_u32 s24, s33, 53248
  buffer_load_dwordx4 v3, s[8:11], s24 offen lds
  s_add_u32 m0, s35, 77312
  s_add_u32 s24, s33, 57344
  buffer_load_dwordx4 v3, s[8:11], s24 offen lds
  s_add_u32 m0, s35, 81664
  s_add_u32 s24, s33, 61440
  buffer_load_dwordx4 v3, s[8:11], s24 offen lds
  v_add_u32 v11, 86016, v5
  ds_read_b64_tr_b16 a[4:5], v11 offset:0
  ds_read_b64_tr_b16 a[6:7], v11 offset:8704
  ds_read_b64_tr_b16 a[36:37], v11 offset:64
  ds_read_b64_tr_b16 a[38:39], v11 offset:8768
  ds_read_b64_tr_b16 a[68:69], v11 offset:128
  ds_read_b64_tr_b16 a[70:71], v11 offset:8832
  ds_read_b64_tr_b16 a[100:101], v11 offset:192
  ds_read_b64_tr_b16 a[102:103], v11 offset:8896
  s_waitcnt lgkmcnt(0)
  s_waitcnt vmcnt(4)
  s_barrier
  s_add_u32 m0, s35, 86016
  s_add_u32 s24, s33, 65536
  buffer_load_dwordx4 v3, s[8:11], s24 offen lds
  s_add_u32 m0, s35, 90368
  s_add_u32 s24, s33, 69632
  buffer_load_dwordx4 v3, s[8:11], s24 offen lds
  s_add_u32 m0, s35, 94720
  s_add_u32 s24, s33, 73728
  buffer_load_dwordx4 v3, s[8:11], s24 offen lds
  s_add_u32 m0, s35, 99072
  s_add_u32 s24, s33, 77824
  buffer_load_dwordx4 v3, s[8:11], s24 offen lds
  v_add_u32 v11, 103424, v5
  ds_read_b64_tr_b16 a[8:9], v11 offset:0
  ds_read_b64_tr_b16 a[10:11], v11 offset:8704
  ds_read_b64_tr_b16 a[40:41], v11 offset:64
  ds_read_b64_tr_b16 a[42:43], v11 offset:8768
  ds_read_b64_tr_b16 a[72:73], v11 offset:128
  ds_read_b64_tr_b16 a[74:75], v11 offset:8832
  ds_read_b64_tr_b16 a[104:105], v11 offset:192
  ds_read_b64_tr_b16 a[106:107], v11 offset:8896
  s_waitcnt lgkmcnt(0)
  s_waitcnt vmcnt(4)
  s_barrier
  s_add_u32 m0, s35, 103424
  s_add_u32 s24, s33, 81920
  buffer_load_dwordx4 v3, s[8:11], s24 offen lds
  s_add_u32 m0, s35, 107776
  s_add_u32 s24, s33, 86016
  buffer_load_dwordx4 v3, s[8:11], s24 offen lds
  s_add_u32 m0, s35, 112128
  s_add_u32 s24, s33, 90112
  buffer_load_dwordx4 v3, s[8:11], s24 offen lds
  s_add_u32 m0, s35, 116480
  s_add_u32 s24, s33, 94208
  buffer_load_dwordx4 v3, s[8:11], s24 offen lds
  v_add_u32 v11, 68608, v5
  ds_read_b64_tr_b16 a[12:13], v11 offset:0
  ds_read_b64_tr_b16 a[14:15], v11 offset:8704
  ds_read_b64_tr_b16 a[44:45], v11 offset:64
  ds_read_b64_tr_b16 a[46:47], v11 offset:8768
  ds_read_b64_tr_b16 a[76:77], v11 offset:128
  ds_read_b64_tr_b16 a[78:79], v11 offset:8832
  ds_read_b64_tr_b16 a[108:109], v11 offset:192
  ds_read_b64_tr_b16 a[110:111], v11 offset:8896
  s_waitcnt lgkmcnt(0)
  s_waitcnt vmcnt(4)
  s_barrier
  s_add_u32 m0, s35, 68608
  s_add_u32 s24, s33, 98304
  buffer_load_dwordx4 v3, s[8:11], s24 offen lds
  s_add_u32 m0, s35, 72960
  s_add_u32 s24, s33, 102400
  buffer_load_dwordx4 v3, s[8:11], s24 offen lds
  s_add_u32 m0, s35, 77312
  s_add_u32 s24, s33, 106496
  buffer_load_dwordx4 v3, s[8:11], s24 offen lds
  s_add_u32 m0, s35, 81664
  s_add_u32 s24, s33, 110592
  buffer_load_dwordx4 v3, s[8:11], s24 offen lds
  v_add_u32 v11, 86016, v5
  ds_read_b64_tr_b16 a[16:17], v11 offset:0
  ds_read_b64_tr_b16 a[18:19], v11 offset:8704
  ds_read_b64_tr_b16 a[48:49], v11 offset:64
  ds_read_b64_tr_b16 a[50:51], v11 offset:8768
  ds_read_b64_tr_b16 a[80:81], v11 offset:128
  ds_read_b64_tr_b16 a[82:83], v11 offset:8832
  ds_read_b64_tr_b16 a[112:113], v11 offset:192
  ds_read_b64_tr_b16 a[114:115], v11 offset:8896
  s_waitcnt lgkmcnt(0)
  s_waitcnt vmcnt(4)
  s_barrier
  s_add_u32 m0, s35, 86016
  s_add_u32 s24, s33, 114688
  buffer_load_dwordx4 v3, s[8:11], s24 offen lds
  s_add_u32 m0, s35, 90368
  s_add_u32 s24, s33, 118784
  buffer_load_dwordx4 v3, s[8:11], s24 offen lds
  s_add_u32 m0, s35, 94720
  s_add_u32 s24, s33, 122880
  buffer_load_dwordx4 v3, s[8:11], s24 offen lds
  s_add_u32 m0, s35, 99072
  s_add_u32 s24, s33, 126976
  buffer_load_dwordx4 v3, s[8:11], s24 offen lds
  v_add_u32 v11, 103424, v5
  ds_read_b64_tr_b16 a[20:21], v11 offset:0
  ds_read_b64_tr_b16 a[22:23], v11 offset:8704
  ds_read_b64_tr_b16 a[52:53], v11 offset:64
  ds_read_b64_tr_b16 a[54:55], v11 offset:8768
  ds_read_b64_tr_b16 a[84:85], v11 offset:128
  ds_read_b64_tr_b16 a[86:87], v11 offset:8832
  ds_read_b64_tr_b16 a[116:117], v11 offset:192
  ds_read_b64_tr_b16 a[118:119], v11 offset:8896
  s_waitcnt lgkmcnt(0)
  s_waitcnt vmcnt(4)
  s_barrier
  v_add_u32 v11, 68608, v5
  ds_read_b64_tr_b16 a[24:25], v11 offset:0
  ds_read_b64_tr_b16 a[26:27], v11 offset:8704
  ds_read_b64_tr_b16 a[56:57], v11 offset:64
  ds_read_b64_tr_b16 a[58:59], v11 offset:8768
  ds_read_b64_tr_b16 a[88:89], v11 offset:128
  ds_read_b64_tr_b16 a[90:91], v11 offset:8832
  ds_read_b64_tr_b16 a[120:121], v11 offset:192
  ds_read_b64_tr_b16 a[122:123], v11 offset:8896
  s_waitcnt lgkmcnt(0)
  s_waitcnt vmcnt(0)
  s_barrier
  v_add_u32 v11, 86016, v5
  ds_read_b64_tr_b16 a[28:29], v11 offset:0
  ds_read_b64_tr_b16 a[30:31], v11 offset:8704
  ds_read_b64_tr_b16 a[60:61], v11 offset:64
  ds_read_b64_tr_b16 a[62:63], v11 offset:8768
  ds_read_b64_tr_b16 a[92:93], v11 offset:128
  ds_read_b64_tr_b16 a[94:95], v11 offset:8832
  ds_read_b64_tr_b16 a[124:125], v11 offset:192
  ds_read_b64_tr_b16 a[126:127], v11 offset:8896
  s_waitcnt lgkmcnt(0)
  s_cmp_eq_u32 s34, 0
  s_cbranch_scc1 L_f3_skipw
  s_barrier
  s_lshl_b32 s33, s20, 16
  s_add_u32 m0, s35, 68608
  s_add_u32 s24, s33, 0
  buffer_load_dwordx4 v3, s[12:15], s24 offen lds
  s_add_u32 m0, s35, 72960
  s_add_u32 s24, s33, 4096
  buffer_load_dwordx4 v3, s[12:15], s24 offen lds
  s_add_u32 m0, s35, 77312
  s_add_u32 s24, s33, 8192
  buffer_load_dwordx4 v3, s[12:15], s24 offen lds
  s_add_u32 m0, s35, 81664
  s_add_u32 s24, s33, 12288
  buffer_load_dwordx4 v3, s[12:15], s24 offen lds
  s_add_u32 m0, s35, 86016
  s_add_u32 s24, s33, 16384
  buffer_load_dwordx4 v3, s[12:15], s24 offen lds
  s_add_u32 m0, s35, 90368
  s_add_u32 s24, s33, 20480
  buffer_load_dwordx4 v3, s[12:15], s24 offen lds
  s_add_u32 m0, s35, 94720
  s_add_u32 s24, s33, 24576
  buffer_load_dwordx4 v3, s[12:15], s24 offen lds
  s_add_u32 m0, s35, 99072
  s_add_u32 s24, s33, 28672
  buffer_load_dwordx4 v3, s[12:15], s24 offen lds
  s_waitcnt vmcnt(4)
  s_barrier
  s_add_u32 m0, s35, 103424
  s_add_u32 s24, s33, 32768
  buffer_load_dwordx4 v3, s[12:15], s24 offen lds
  s_add_u32 m0, s35, 107776
  s_add_u32 s24, s33, 36864
  buffer_load_dwordx4 v3, s[12:15], s24 offen lds
  s_add_u32 m0, s35, 112128
  s_add_u32 s24, s33, 40960
  buffer_load_dwordx4 v3, s[12:15], s24 offen lds
  s_add_u32 m0, s35, 116480
  s_add_u32 s24, s33, 45056
  buffer_load_dwordx4 v3, s[12:15], s24 offen lds
  v_add_u32 v11, 68608, v5
  ds_read_b64_tr_b16 a[128:129], v11 offset:0
  ds_read_b64_tr_b16 a[130:131], v11 offset:8704
  ds_read_b64_tr_b16 a[144:145], v11 offset:64
  ds_read_b64_tr_b16 a[146:147], v11 offset:8768
  ds_read_b64_tr_b16 a[160:161], v11 offset:128
  ds_read_b64_tr_b16 a[162:163], v11 offset:8832
  ds_read_b64_tr_b16 a[176:177], v11 offset:192
  ds_read_b64_tr_b16 a[178:179], v11 offset:8896
  s_waitcnt lgkmcnt(0)
  s_waitcnt vmcnt(4)
  s_barrier
  s_add_u32 m0, s35, 68608
  s_add_u32 s24, s33, 49152
  buffer_load_dwordx4 v3, s[12:15], s24 offen lds
  s_add_u32 m0, s35, 72960
  s_add_u32 s24, s33, 53248
  buffer_load_dwordx4 v3, s[12:15], s24 offen lds
  s_add_u32 m0, s35, 77312
  s_add_u32 s24, s33, 57344
  buffer_load_dwordx4 v3, s[12:15], s24 offen lds
  s_add_u32 m0, s35, 81664
  s_add_u32 s24, s33, 61440
  buffer_load_dwordx4 v3, s[12:15], s24 offen lds
  v_add_u32 v11, 86016, v5
  ds_read_b64_tr_b16 a[132:133], v11 offset:0
  ds_read_b64_tr_b16 a[134:135], v11 offset:8704
  ds_read_b64_tr_b16 a[148:149], v11 offset:64
  ds_read_b64_tr_b16 a[150:151], v11 offset:8768
  ds_read_b64_tr_b16 a[164:165], v11 offset:128
  ds_read_b64_tr_b16 a[166:167], v11 offset:8832
  ds_read_b64_tr_b16 a[180:181], v11 offset:192
  ds_read_b64_tr_b16 a[182:183], v11 offset:8896
  s_waitcnt lgkmcnt(0)
  s_waitcnt vmcnt(4)
  s_barrier
  v_add_u32 v11, 103424, v5
  ds_read_b64_tr_b16 a[136:137], v11 offset:0
  ds_read_b64_tr_b16 a[138:139], v11 offset:8704
  ds_read_b64_tr_b16 a[152:153], v11 offset:64
  ds_read_b64_tr_b16 a[154:155], v11 offset:8768
  ds_read_b64_tr_b16 a[168:169], v11 offset:128
  ds_read_b64_tr_b16 a[170:171], v11 offset:8832
  ds_read_b64_tr_b16 a[184:185], v11 offset:192
  ds_read_b64_tr_b16 a[186:187], v11 offset:8896
  s_waitcnt lgkmcnt(0)
  s_waitcnt vmcnt(0)
  s_barrier
  v_add_u32 v11, 68608, v5
  ds_read_b64_tr_b16 a[140:141], v11 offset:0
  ds_read_b64_tr_b16 a[142:143], v11 offset:8704
  ds_read_b64_tr_b16 a[156:157], v11 offset:64
  ds_read_b64_tr_b16 a[158:159], v11 offset:8768
  ds_read_b64_tr_b16 a[172:173], v11 offset:128
  ds_read_b64_tr_b16 a[174:175], v11 offset:8832
  ds_read_b64_tr_b16 a[188:189], v11 offset:192
  ds_read_b64_tr_b16 a[190:191], v11 offset:8896
  s_waitcnt lgkmcnt(0)
L_f3_skipw:
  v_lshrrev_b32 v11, 5, v1
  v_and_b32 v12, 7, v1
  v_lshlrev_b32 v12, 4, v12
  v_lshl_add_u32 v19, v11, 7, v12
  v_and_b32 v12, 15, v1
  v_lshlrev_b32 v12, 4, v12
  v_lshl_add_u32 v13, v11, 9, v12
  v_bfe_u32 v14, v1, 4, 1
  v_lshl_add_u32 v20, v14, 3, v13
  v_lshrrev_b32_e64 v13, 4, v1
  v_lshl_add_u32 v12, v13, 10, v12
  s_lshl_b32 s24, s21, 8
  v_add_u32 v21, s24, v12
  s_and_b32 s24, s21, 1
  s_lshl_b32 s24, s24, 14
  s_lshr_b32 s25, s21, 1
  s_lshl_b32 s25, s25, 3
  s_add_u32 s24, s24, s25
  s_lshl_b32 s25, s20, 5
  s_add_u32 s24, s24, s25
  v_and_b32 v12, 15, v1
  v_lshlrev_b32_e64 v12, 10, v12
  v_lshl_add_u32 v12, v13, 4, v12
  v_add_u32 v12, s24, v12
  v_cmp_gt_u32 vcc, 2, v13
  v_mov_b32 v14, 0x40000000
  s_nop 0
  v_cndmask_b32 v22, v14, v12, vcc
  v_and_b32 v12, 15, v1
  v_and_b32 v13, 1, v1
  v_lshlrev_b32 v13, 4, v13
  v_mov_b32 v14, 0x3f80
  v_lshlrev_b32 v14, v13, v14
  v_lshrrev_b32 v12, 1, v12
  v_cmp_eq_u32 vcc, 0, v12
  s_nop 1
  v_cndmask_b32 v252, 0, v14, vcc
  v_cmp_eq_u32 vcc, 1, v12
  s_nop 1
  v_cndmask_b32 v253, 0, v14, vcc
  v_cmp_eq_u32 vcc, 2, v12
  s_nop 1
  v_cndmask_b32 v254, 0, v14, vcc
  v_cmp_eq_u32 vcc, 3, v12
  s_nop 1
  v_cndmask_b32 v255, 0, v14, vcc
  v_and_b32 v12, 31, v1
  v_lshlrev_b32 v11, 2, v11
  v_sub_u32 v12, v12, v11
  v_cmp_le_i32 s[70:71], 0, v12
  v_cmp_le_i32 s[72:73], 1, v12
  v_cmp_le_i32 s[74:75], 2, v12
  v_cmp_le_i32 s[76:77], 3, v12
  v_cmp_le_i32 s[78:79], 8, v12
  v_cmp_le_i32 s[80:81], 9, v12
  v_cmp_le_i32 s[82:83], 10, v12
  v_cmp_le_i32 s[84:85], 11, v12
  v_cmp_le_i32 s[86:87], 16, v12
  v_cmp_le_i32 s[88:89], 17, v12
  v_cmp_le_i32 s[90:91], 18, v12
  v_cmp_le_i32 s[92:93], 19, v12
  v_cmp_le_i32 s[94:95], 24, v12
  v_cmp_le_i32 s[96:97], 25, v12
  v_cmp_le_i32 s[98:99], 26, v12
  v_cmp_le_i32 s[100:101], 27, v12
  s_mov_b32 s8, s64
  s_mov_b32 s9, s65
  s_mov_b32 s10, 0x200000
  s_mov_b32 s11, 0x20000
  s_sub_u32 s26, s28, 7
  s_lshl_b32 s24, s26, 20
  s_lshl_b32 s25, s21, 18
  s_add_u32 s24, s24, s25
  s_lshl_b32 s25, s20, 10
  s_add_u32 s24, s24, s25
  s_add_u32 s24, s24, 0x5000000
  s_add_u32 s25, s24, 0
  buffer_store_dwordx4 v[56:59], v2, s[4:7], s25 offen sc1
  s_add_u32 s25, s24, 32768
  buffer_store_dwordx4 v[56:59], v2, s[4:7], s25 offen sc1
  s_add_u32 s25, s24, 65536
  buffer_store_dwordx4 v[56:59], v2, s[4:7], s25 offen sc1
  s_add_u32 s25, s24, 98304
  buffer_store_dwordx4 v[56:59], v2, s[4:7], s25 offen sc1
  s_add_u32 s25, s24, 131072
  buffer_store_dwordx4 v[56:59], v2, s[4:7], s25 offen sc1
  s_add_u32 s25, s24, 163840
  buffer_store_dwordx4 v[56:59], v2, s[4:7], s25 offen sc1
  s_add_u32 s25, s24, 196608
  buffer_store_dwordx4 v[56:59], v2, s[4:7], s25 offen sc1
  s_add_u32 s25, s24, 229376
  buffer_store_dwordx4 v[56:59], v2, s[4:7], s25 offen sc1
  s_mov_b32 s16, s66
  s_mov_b32 s17, s67
  s_mov_b32 s18, 0x100
  s_mov_b32 s19, 0x20000
L_arr_5:
  buffer_load_dword v11, off, s[16:19], 0 sc1
  s_waitcnt vmcnt(0)
  v_readfirstlane_b32 s24, v11
  s_nop 0
  s_cmp_ge_u32 s24, 256
  s_cbranch_scc1 L_arr_5_ok
  s_sleep 2
  s_add_u32 s23, s23, 1
  s_cmp_lt_u32 s23, 0x40000
  s_cbranch_scc1 L_arr_5
  s_branch L_exit
L_arr_5_ok:
  v_and_b32 v11, 31, v1
  s_lshr_b32 s24, s32, 1
  v_lshl_add_u32 v6, v11, 4, s24
  v_mov_b64 v[26:27], 0
  v_mov_b64 v[30:31], 0
  v_mov_b64 v[34:35], 0
  v_mov_b64 v[38:39], 0
  s_mov_b32 s30, 0
  s_mov_b32 s28, s22
  s_lshl_b32 s31, s20, 6
  s_add_u32 s31, s31, s28
  s_lshl_b32 s35, s31, 13
  s_lshl_b32 s31, s31, 15
  s_add_u32 s27, s31, 0x6000
  buffer_load_dwordx4 v[160:163], v2, s[4:7], s27 offen offset:0
  s_add_u32 s27, s31, 0x6000
  buffer_load_dwordx4 v[164:167], v2, s[4:7], s27 offen offset:1024
  s_add_u32 s27, s31, 0x6000
  buffer_load_dwordx4 v[168:171], v2, s[4:7], s27 offen offset:2048
  s_add_u32 s27, s31, 0x6000
  buffer_load_dwordx4 v[172:175], v2, s[4:7], s27 offen offset:3072
  s_add_u32 s27, s31, 0x0
  buffer_load_dwordx4 a[224:227], v23, s[4:7], s27 offen offset:0
  s_add_u32 s27, s31, 0x0
  buffer_load_dwordx4 a[228:231], v23, s[4:7], s27 offen offset:1024
  s_add_u32 s27, s31, 0x1000
  buffer_load_dwordx4 a[232:235], v23, s[4:7], s27 offen offset:0
  s_add_u32 s27, s31, 0x1000
  buffer_load_dwordx4 a[236:239], v23, s[4:7], s27 offen offset:1024
  s_add_u32 s27, s31, 0x2000
  buffer_load_dwordx4 a[240:243], v23, s[4:7], s27 offen offset:0
  s_add_u32 s27, s31, 0x2000
  buffer_load_dwordx4 a[244:247], v23, s[4:7], s27 offen offset:1024
  s_add_u32 s27, s31, 0x3000
  buffer_load_dwordx4 a[248:251], v23, s[4:7], s27 offen offset:0
  s_add_u32 s27, s31, 0x3000
  buffer_load_dwordx4 a[252:255], v23, s[4:7], s27 offen offset:1024
  s_add_u32 s27, s31, 0x0
  buffer_load_dwordx4 a[192:195], v2, s[4:7], s27 offen offset:2048
  s_add_u32 s27, s31, 0x0
  buffer_load_dwordx4 a[196:199], v2, s[4:7], s27 offen offset:3072
  s_add_u32 s27, s31, 0x1000
  buffer_load_dwordx4 a[200:203], v2, s[4:7], s27 offen offset:2048
  s_add_u32 s27, s31, 0x1000
  buffer_load_dwordx4 a[204:207], v2, s[4:7], s27 offen offset:3072
  s_add_u32 s27, s31, 0x2000
  buffer_load_dwordx4 a[208:211], v2, s[4:7], s27 offen offset:2048
  s_add_u32 s27, s31, 0x2000
  buffer_load_dwordx4 a[212:215], v2, s[4:7], s27 offen offset:3072
  s_add_u32 s27, s31, 0x3000
  buffer_load_dwordx4 a[216:219], v2, s[4:7], s27 offen offset:2048
  s_add_u32 s27, s31, 0x3000
  buffer_load_dwordx4 a[220:223], v2, s[4:7], s27 offen offset:3072
  s_add_u32 s27, s35, 0x4000000
  buffer_load_dwordx4 v[128:131], v2, s[4:7], s27 offen offset:0
  s_add_u32 s27, s35, 0x4000000
  buffer_load_dwordx4 v[132:135], v2, s[4:7], s27 offen offset:1024
  s_add_u32 s27, s35, 0x4000000
  buffer_load_dwordx4 v[136:139], v2, s[4:7], s27 offen offset:2048
  s_add_u32 s27, s35, 0x4000000
  buffer_load_dwordx4 v[140:143], v2, s[4:7], s27 offen offset:3072
  s_add_u32 s27, s35, 0x4001000
  buffer_load_dwordx4 v[144:147], v2, s[4:7], s27 offen offset:0
  s_add_u32 s27, s35, 0x4001000
  buffer_load_dwordx4 v[148:151], v2, s[4:7], s27 offen offset:1024
  s_add_u32 s27, s35, 0x4001000
  buffer_load_dwordx4 v[152:155], v2, s[4:7], s27 offen offset:2048
  s_add_u32 s27, s35, 0x4001000
  buffer_load_dwordx4 v[156:159], v2, s[4:7], s27 offen offset:3072
L_f3:
  s_mov_b32 s33, s31
  s_lshl_b32 s24, s30, 7
  v_and_b32 v11, 31, v1
  v_lshl_add_u32 v11, v11, 2, s24
  v_add_u32 v11, 66560, v11
  ds_read_b32 v16, v11
  s_cmp_eq_u32 s34, 0
  s_cbranch_scc1 L_f3_zero
  s_waitcnt vmcnt(9)
  v_mfma_f32_32x32x16_bf16 v[64:79], a[128:131], v[160:163], 0
  v_mfma_f32_32x32x16_bf16 v[80:95], a[144:147], v[160:163], 0
  v_mfma_f32_32x32x16_bf16 v[96:111], a[160:163], v[160:163], 0
  v_mfma_f32_32x32x16_bf16 v[112:127], a[176:179], v[160:163], 0
  v_mfma_f32_32x32x16_bf16 v[64:79], a[132:135], v[164:167], v[64:79]
  v_mfma_f32_32x32x16_bf16 v[80:95], a[148:151], v[164:167], v[80:95]
  v_mfma_f32_32x32x16_bf16 v[96:111], a[164:167], v[164:167], v[96:111]
  v_mfma_f32_32x32x16_bf16 v[112:127], a[180:183], v[164:167], v[112:127]
  v_mfma_f32_32x32x16_bf16 v[64:79], a[136:139], v[168:171], v[64:79]
  v_mfma_f32_32x32x16_bf16 v[80:95], a[152:155], v[168:171], v[80:95]
  v_mfma_f32_32x32x16_bf16 v[96:111], a[168:171], v[168:171], v[96:111]
  v_mfma_f32_32x32x16_bf16 v[112:127], a[184:187], v[168:171], v[112:127]
  v_mfma_f32_32x32x16_bf16 v[64:79], a[140:143], v[172:175], v[64:79]
  v_mfma_f32_32x32x16_bf16 v[80:95], a[156:159], v[172:175], v[80:95]
  v_mfma_f32_32x32x16_bf16 v[96:111], a[172:175], v[172:175], v[96:111]
  v_mfma_f32_32x32x16_bf16 v[112:127], a[188:191], v[172:175], v[112:127]
  s_branch L_f3_ffn_done
L_f3_zero:
  v_mov_b64 v[64:65], 0
  v_mov_b64 v[66:67], 0
  v_mov_b64 v[68:69], 0
  v_mov_b64 v[70:71], 0
  v_mov_b64 v[72:73], 0
  v_mov_b64 v[74:75], 0
  v_mov_b64 v[76:77], 0
  v_mov_b64 v[78:79], 0
  v_mov_b64 v[80:81], 0
  v_mov_b64 v[82:83], 0
  v_mov_b64 v[84:85], 0
  v_mov_b64 v[86:87], 0
  v_mov_b64 v[88:89], 0
  v_mov_b64 v[90:91], 0
  v_mov_b64 v[92:93], 0
  v_mov_b64 v[94:95], 0
  v_mov_b64 v[96:97], 0
  v_mov_b64 v[98:99], 0
  v_mov_b64 v[100:101], 0
  v_mov_b64 v[102:103], 0
  v_mov_b64 v[104:105], 0
  v_mov_b64 v[106:107], 0
  v_mov_b64 v[108:109], 0
  v_mov_b64 v[110:111], 0
  v_mov_b64 v[112:113], 0
  v_mov_b64 v[114:115], 0
  v_mov_b64 v[116:117], 0
  v_mov_b64 v[118:119], 0
  v_mov_b64 v[120:121], 0
  v_mov_b64 v[122:123], 0
  v_mov_b64 v[124:125], 0
  v_mov_b64 v[126:127], 0
L_f3_ffn_done:
  s_waitcnt vmcnt(0) lgkmcnt(0)
  v_mfma_f32_32x32x16_bf16 v[176:191], a[224:227], v[128:131], 0
  v_mfma_f32_32x32x16_bf16 v[176:191], a[228:231], v[132:135], v[176:191]
  v_mfma_f32_32x32x16_bf16 v[176:191], a[232:235], v[136:139], v[176:191]
  v_mfma_f32_32x32x16_bf16 v[176:191], a[236:239], v[140:143], v[176:191]
  v_mfma_f32_32x32x16_bf16 v[176:191], a[240:243], v[144:147], v[176:191]
  v_mfma_f32_32x32x16_bf16 v[176:191], a[244:247], v[148:151], v[176:191]
  v_mfma_f32_32x32x16_bf16 v[176:191], a[248:251], v[152:155], v[176:191]
  v_mfma_f32_32x32x16_bf16 v[176:191], a[252:255], v[156:159], v[176:191]
  v_mov_b32 v14, 0xff800000
  s_nop 0
  s_nop 9
  v_cndmask_b32 v176, v14, v176, s[70:71]
  v_cndmask_b32 v177, v14, v177, s[72:73]
  v_cndmask_b32 v178, v14, v178, s[74:75]
  v_cndmask_b32 v179, v14, v179, s[76:77]
  v_cndmask_b32 v180, v14, v180, s[78:79]
  v_cndmask_b32 v181, v14, v181, s[80:81]
  v_cndmask_b32 v182, v14, v182, s[82:83]
  v_cndmask_b32 v183, v14, v183, s[84:85]
  v_cndmask_b32 v184, v14, v184, s[86:87]
  v_cndmask_b32 v185, v14, v185, s[88:89]
  v_cndmask_b32 v186, v14, v186, s[90:91]
  v_cndmask_b32 v187, v14, v187, s[92:93]
  v_cndmask_b32 v188, v14, v188, s[94:95]
  v_cndmask_b32 v189, v14, v189, s[96:97]
  v_cndmask_b32 v190, v14, v190, s[98:99]
  v_cndmask_b32 v191, v14, v191, s[100:101]
  v_max3_f32 v13, v176, v177, v178
  v_max3_f32 v13, v13, v179, v180
  v_max3_f32 v13, v13, v181, v182
  v_max3_f32 v13, v13, v183, v184
  v_max3_f32 v13, v13, v185, v186
  v_max3_f32 v13, v13, v187, v188
  v_max3_f32 v13, v13, v189, v190
  v_max_f32_e64 v13, v13, v191
  s_mov_b32 s24, 0x3e0293ee
  v_mov_b32 v12, v13
  s_nop 1
  v_permlane32_swap_b32 v12, v13
  v_max_f32 v17, v12, v13
  v_sub_f32 v176, v176, v17
  v_mul_f32 v176, s24, v176
  v_exp_f32 v176, v176
  v_sub_f32 v177, v177, v17
  v_mul_f32 v177, s24, v177
  v_exp_f32 v177, v177
  v_sub_f32 v178, v178, v17
  v_mul_f32 v178, s24, v178
  v_exp_f32 v178, v178
  v_sub_f32 v179, v179, v17
  v_mul_f32 v179, s24, v179
  v_exp_f32 v179, v179
  v_sub_f32 v180, v180, v17
  v_mul_f32 v180, s24, v180
  v_exp_f32 v180, v180
  v_sub_f32 v181, v181, v17
  v_mul_f32 v181, s24, v181
  v_exp_f32 v181, v181
  v_sub_f32 v182, v182, v17
  v_mul_f32 v182, s24, v182
  v_exp_f32 v182, v182
  v_sub_f32 v183, v183, v17
  v_mul_f32 v183, s24, v183
  v_exp_f32 v183, v183
  v_sub_f32 v184, v184, v17
  v_mul_f32 v184, s24, v184
  v_exp_f32 v184, v184
  v_sub_f32 v185, v185, v17
  v_mul_f32 v185, s24, v185
  v_exp_f32 v185, v185
  v_sub_f32 v186, v186, v17
  v_mul_f32 v186, s24, v186
  v_exp_f32 v186, v186
  v_sub_f32 v187, v187, v17
  v_mul_f32 v187, s24, v187
  v_exp_f32 v187, v187
  v_sub_f32 v188, v188, v17
  v_mul_f32 v188, s24, v188
  v_exp_f32 v188, v188
  v_sub_f32 v189, v189, v17
  v_mul_f32 v189, s24, v189
  v_exp_f32 v189, v189
  v_sub_f32 v190, v190, v17
  v_mul_f32 v190, s24, v190
  v_exp_f32 v190, v190
  v_sub_f32 v191, v191, v17
  v_mul_f32 v191, s24, v191
  v_exp_f32 v191, v191
  v_add_f32 v18, v176, v177
  v_add_f32 v12, v178, v179
  v_add_f32 v18, v18, v180
  v_add_f32 v12, v12, v181
  v_add_f32 v18, v18, v182
  v_add_f32 v12, v12, v183
  v_add_f32 v18, v18, v184
  v_add_f32 v12, v12, v185
  v_add_f32 v18, v18, v186
  v_add_f32 v12, v12, v187
  v_add_f32 v18, v18, v188
  v_add_f32 v12, v12, v189
  v_add_f32 v18, v18, v190
  v_add_f32 v12, v12, v191
  v_add_f32 v18, v18, v12
  s_cmp_eq_u32 s30, 0
  s_cbranch_scc1 L_f3_nog
  s_sub_u32 s27, s28, 7
  s_lshl_b32 s25, s27, 9
  s_lshr_b32 s26, s20, 3
  s_lshl_b32 s26, s26, 7
  s_add_u32 s25, s25, s26
  s_add_u32 s25, s25, 0x910c000
  v_and_b32_e64 v12, 31, v1
  v_lshlrev_b32 v12, 2, v12
L_f3g_fp:
  buffer_load_dword v11, v12, s[4:7], s25 offen sc1
  s_waitcnt vmcnt(0)
  v_cmp_ne_u32 vcc, 1, v11
  s_cbranch_vccz L_f3g_fp_ok
  s_sleep 1
  s_add_u32 s23, s23, 1
  s_cmp_lt_u32 s23, 0x40000
  s_cbranch_scc1 L_f3g_fp
  s_branch L_exit
L_f3g_fp_ok:
  s_lshl_b32 s24, s27, 20
  s_lshl_b32 s25, s20, 15
  s_add_u32 s24, s24, s25
  s_add_u32 s24, s24, 0x5000000
L_f3g_rd:
  s_add_u32 s25, s24, 0
  buffer_load_dwordx4 v[40:43], v21, s[4:7], s25 offen sc1
  s_add_u32 s25, s24, 4096
  buffer_load_dwordx4 v[44:47], v21, s[4:7], s25 offen sc1
  s_add_u32 s25, s24, 8192
  buffer_load_dwordx4 v[48:51], v21, s[4:7], s25 offen sc1
  s_add_u32 s25, s24, 12288
  buffer_load_dwordx4 v[52:55], v21, s[4:7], s25 offen sc1
  s_add_u32 s25, s24, 16384
  buffer_load_dwordx4 v[56:59], v21, s[4:7], s25 offen sc1
  s_add_u32 s25, s24, 20480
  buffer_load_dwordx4 v[60:63], v21, s[4:7], s25 offen sc1
  s_add_u32 s25, s24, 24576
  buffer_load_dwordx4 v[192:195], v21, s[4:7], s25 offen sc1
  s_add_u32 s25, s24, 28672
  buffer_load_dwordx4 v[196:199], v21, s[4:7], s25 offen sc1
  s_waitcnt vmcnt(7)
  v_mfma_f32_16x16x32_bf16 v[200:203], v[252:255], v[40:43], 0
  s_waitcnt vmcnt(6)
  v_mfma_f32_16x16x32_bf16 v[200:203], v[252:255], v[44:47], v[200:203]
  s_waitcnt vmcnt(5)
  v_mfma_f32_16x16x32_bf16 v[200:203], v[252:255], v[48:51], v[200:203]
  s_waitcnt vmcnt(4)
  v_mfma_f32_16x16x32_bf16 v[200:203], v[252:255], v[52:55], v[200:203]
  s_waitcnt vmcnt(3)
  v_mfma_f32_16x16x32_bf16 v[200:203], v[252:255], v[56:59], v[200:203]
  s_waitcnt vmcnt(2)
  v_mfma_f32_16x16x32_bf16 v[200:203], v[252:255], v[60:63], v[200:203]
  s_waitcnt vmcnt(1)
  v_mfma_f32_16x16x32_bf16 v[200:203], v[252:255], v[192:195], v[200:203]
  s_waitcnt vmcnt(0)
  v_mfma_f32_16x16x32_bf16 v[200:203], v[252:255], v[196:199], v[200:203]
  s_lshl_b32 s24, s27, 15
  s_nop 6
  v_cvt_pk_bf16_f32 v200, v200, v201
  v_cvt_pk_bf16_f32 v201, v202, v203
  buffer_store_dwordx2 v[200:201], v22, s[8:11], s24 offen
L_f3_nog:
  s_movk_i32 s25, 0x4800
  s_cmp_eq_u32 s28, 63
  s_cselect_b32 s25, 0xffffc000, s25
  s_add_u32 s25, s25, s33
L_f3_far:
  v_mov_b32 v11, 0
  s_mov_b64 exec, 1
  buffer_atomic_or v11, off, s[4:7], s25 sc0
  s_mov_b64 exec, -1
  s_waitcnt vmcnt(0)
  v_readfirstlane_b32 s24, v11
  s_nop 0
  s_cmp_lg_u32 s24, -1
  s_cbranch_scc1 L_f3_near
  s_sleep 2
  s_add_u32 s23, s23, 1
  s_cmp_lt_u32 s23, 0x40000
  s_cbranch_scc1 L_f3_far
  s_branch L_exit
L_f3_near:
  s_cmp_eq_u32 s28, 63
  s_cbranch_scc0 L_f3_n1
  s_branch L_f3_km
L_f3_n1:
L_f3_km:
  s_add_u32 s25, s33, 0x4000
  buffer_load_dwordx4 v[240:243], v6, s[4:7], s25 offen sc1
  buffer_load_dwordx4 v[244:247], v3, s[4:7], s25 offen offset:2048 sc1
  s_and_b32 s24, s30, 1
  s_lshl_b32 s24, s24, 13
  v_add_u32 v12, s24, v6
  v_add_u32 v13, s24, v3
  s_waitcnt vmcnt(0)
  v_max_u32 v11, v240, v241
  v_max3_u32 v11, v11, v242, v243
  v_max3_u32 v11, v11, v244, v245
  v_max3_u32 v11, v11, v246, v247
  v_cmp_eq_u32_e64 vcc, -1, v11
  s_cbranch_vccz L_f3_got
  s_add_u32 s23, s23, 1
  s_cmp_lt_u32 s23, 0x40000
  s_cbranch_scc1 L_f3_km
  s_branch L_exit
L_f3_got:
  ds_write_b128 v12, v[240:243]
  ds_write_b128 v13, v[244:247] offset:2048
  v_add_u32 v12, s24, v19
  v_add_u32 v13, s24, v20
  s_waitcnt lgkmcnt(0)
  s_barrier
  ds_read_b128 v[208:211], v12 offset:0
  ds_read_b128 v[212:215], v12 offset:256
  ds_read_b128 v[216:219], v12 offset:512
  ds_read_b128 v[220:223], v12 offset:768
  ds_read_b128 v[224:227], v12 offset:1024
  ds_read_b128 v[228:231], v12 offset:1280
  ds_read_b128 v[232:235], v12 offset:1536
  ds_read_b128 v[236:239], v12 offset:1792
  ds_read2st64_b32 v[24:25], v13 offset0:8 offset1:9
  ds_read2st64_b32 v[28:29], v13 offset0:12 offset1:13
  ds_read2st64_b32 v[32:33], v13 offset0:16 offset1:17
  ds_read2st64_b32 v[36:37], v13 offset0:20 offset1:21
  s_waitcnt lgkmcnt(11)
  v_mfma_f32_32x32x16_bf16 v[192:207], v[208:211], v[128:131], 0
  s_waitcnt lgkmcnt(10)
  v_mfma_f32_32x32x16_bf16 v[192:207], v[212:215], v[132:135], v[192:207]
  s_waitcnt lgkmcnt(9)
  v_mfma_f32_32x32x16_bf16 v[192:207], v[216:219], v[136:139], v[192:207]
  s_waitcnt lgkmcnt(8)
  v_mfma_f32_32x32x16_bf16 v[192:207], v[220:223], v[140:143], v[192:207]
  s_waitcnt lgkmcnt(7)
  v_mfma_f32_32x32x16_bf16 v[192:207], v[224:227], v[144:147], v[192:207]
  s_waitcnt lgkmcnt(6)
  v_mfma_f32_32x32x16_bf16 v[192:207], v[228:231], v[148:151], v[192:207]
  s_waitcnt lgkmcnt(5)
  v_mfma_f32_32x32x16_bf16 v[192:207], v[232:235], v[152:155], v[192:207]
  s_waitcnt lgkmcnt(4)
  v_mfma_f32_32x32x16_bf16 v[192:207], v[236:239], v[156:159], v[192:207]
  s_waitcnt lgkmcnt(0)
L_f3_km_ok:
  s_mov_b32 s24, 0x3e0293ee
  s_nop 9
  v_max3_f32 v13, v192, v193, v194
  v_max_f32 v13, v13, v195
  v_mov_b32 v12, v13
  s_nop 1
  v_permlane32_swap_b32 v12, v13
  v_max3_f32 v13, v12, v13, v17
  v_sub_f32 v14, v17, v13
  v_sub_f32 v192, v192, v13
  v_sub_f32 v193, v193, v13
  v_sub_f32 v194, v194, v13
  v_sub_f32 v195, v195, v13
  v_mul_f32 v14, s24, v14
  v_mul_f32 v192, s24, v192
  v_mul_f32 v193, s24, v193
  v_mul_f32 v194, s24, v194
  v_mul_f32 v195, s24, v195
  v_exp_f32 v14, v14
  v_exp_f32 v192, v192
  v_exp_f32 v193, v193
  v_exp_f32 v194, v194
  v_exp_f32 v195, v195
  v_add_f32 v11, v192, v193
  v_add_f32 v12, v194, v195
  v_add_f32 v11, v11, v12
  v_fma_f32 v11, v18, v14, v11
  v_mov_b32 v12, v11
  s_nop 1
  v_permlane32_swap_b32 v12, v11
  v_add_f32 v11, v12, v11
  v_rcp_f32 v11, v11
  s_nop 0
  v_mul_f32 v11, v11, v16
  v_mul_f32 v13, v14, v11
  v_pk_mul_f32 v[176:177], v[176:177], v[12:13] op_sel:[0,1] op_sel_hi:[1,1]
  v_pk_mul_f32 v[178:179], v[178:179], v[12:13] op_sel:[0,1] op_sel_hi:[1,1]
  v_pk_mul_f32 v[180:181], v[180:181], v[12:13] op_sel:[0,1] op_sel_hi:[1,1]
  v_pk_mul_f32 v[182:183], v[182:183], v[12:13] op_sel:[0,1] op_sel_hi:[1,1]
  v_pk_mul_f32 v[184:185], v[184:185], v[12:13] op_sel:[0,1] op_sel_hi:[1,1]
  v_pk_mul_f32 v[186:187], v[186:187], v[12:13] op_sel:[0,1] op_sel_hi:[1,1]
  v_pk_mul_f32 v[188:189], v[188:189], v[12:13] op_sel:[0,1] op_sel_hi:[1,1]
  v_pk_mul_f32 v[190:191], v[190:191], v[12:13] op_sel:[0,1] op_sel_hi:[1,1]
  v_mul_f32 v192, v192, v11
  v_mul_f32 v193, v193, v11
  v_mul_f32 v194, v194, v11
  v_mul_f32 v195, v195, v11
  v_cvt_pk_bf16_f32 v240, v176, v177
  v_cvt_pk_bf16_f32 v241, v178, v179
  v_cvt_pk_bf16_f32 v242, v180, v181
  v_cvt_pk_bf16_f32 v243, v182, v183
  v_cvt_pk_bf16_f32 v244, v184, v185
  v_cvt_pk_bf16_f32 v245, v186, v187
  v_cvt_pk_bf16_f32 v246, v188, v189
  v_cvt_pk_bf16_f32 v247, v190, v191
  v_cvt_pk_bf16_f32 v248, v192, v193
  v_cvt_pk_bf16_f32 v249, v194, v195
  v_mov_b64_e64 v[250:251], 0
  v_mfma_f32_32x32x16_bf16 v[208:223], a[192:195], v[240:243], 0
  v_mfma_f32_32x32x16_bf16 v[208:223], a[196:199], v[244:247], v[208:223]
  v_mfma_f32_32x32x16_bf16 v[208:223], v[24:27], v[248:251], v[208:223]
  v_mfma_f32_32x32x16_bf16 v[224:239], a[200:203], v[240:243], 0
  v_mfma_f32_32x32x16_bf16 v[224:239], a[204:207], v[244:247], v[224:239]
  v_mfma_f32_32x32x16_bf16 v[224:239], v[28:31], v[248:251], v[224:239]
  s_nop 0
  s_nop 7
  v_cvt_pk_bf16_f32 v128, v208, v209
  v_cvt_pk_bf16_f32 v129, v210, v211
  v_cvt_pk_bf16_f32 v130, v212, v213
  v_cvt_pk_bf16_f32 v131, v214, v215
  v_cvt_pk_bf16_f32 v132, v216, v217
  v_cvt_pk_bf16_f32 v133, v218, v219
  v_cvt_pk_bf16_f32 v134, v220, v221
  v_cvt_pk_bf16_f32 v135, v222, v223
  v_mfma_f32_32x32x16_bf16 v[208:223], a[208:211], v[240:243], 0
  v_mfma_f32_32x32x16_bf16 v[208:223], a[212:215], v[244:247], v[208:223]
  v_mfma_f32_32x32x16_bf16 v[208:223], v[32:35], v[248:251], v[208:223]
  v_cvt_pk_bf16_f32 v136, v224, v225
  v_cvt_pk_bf16_f32 v137, v226, v227
  v_cvt_pk_bf16_f32 v138, v228, v229
  v_cvt_pk_bf16_f32 v139, v230, v231
  v_cvt_pk_bf16_f32 v140, v232, v233
  v_cvt_pk_bf16_f32 v141, v234, v235
  v_cvt_pk_bf16_f32 v142, v236, v237
  v_cvt_pk_bf16_f32 v143, v238, v239
  v_mfma_f32_32x32x16_bf16 v[224:239], a[216:219], v[240:243], 0
  v_mfma_f32_32x32x16_bf16 v[224:239], a[220:223], v[244:247], v[224:239]
  v_mfma_f32_32x32x16_bf16 v[224:239], v[36:39], v[248:251], v[224:239]
  s_nop 0
  v_cvt_pk_bf16_f32 v144, v208, v209
  v_cvt_pk_bf16_f32 v145, v210, v211
  v_cvt_pk_bf16_f32 v146, v212, v213
  v_cvt_pk_bf16_f32 v147, v214, v215
  v_cvt_pk_bf16_f32 v148, v216, v217
  v_cvt_pk_bf16_f32 v149, v218, v219
  v_cvt_pk_bf16_f32 v150, v220, v221
  v_cvt_pk_bf16_f32 v151, v222, v223
  s_lshl_b32 s24, s28, 20
  s_lshl_b32 s25, s21, 18
  s_add_u32 s24, s24, s25
  s_lshl_b32 s25, s20, 10
  s_add_u32 s24, s24, s25
  s_add_u32 s24, s24, 0x5000000
  s_add_u32 s26, s28, 7
  s_lshl_b32 s31, s20, 6
  s_add_u32 s31, s31, s26
  s_lshl_b32 s35, s31, 13
  s_lshl_b32 s31, s31, 15
  s_add_u32 s25, s30, 1
  s_cmp_eq_u32 s25, s29
  s_cbranch_scc1 L_f3_last
  v_mfma_f32_32x32x16_bf16 v[64:79], a[0:3], v[128:131], v[64:79]
  v_mfma_f32_32x32x16_bf16 v[64:79], a[4:7], v[132:135], v[64:79]
  v_mfma_f32_32x32x16_bf16 v[64:79], a[8:11], v[136:139], v[64:79]
  v_cvt_pk_bf16_f32 v152, v224, v225
  v_cvt_pk_bf16_f32 v153, v226, v227
  v_cvt_pk_bf16_f32 v154, v228, v229
  v_cvt_pk_bf16_f32 v155, v230, v231
  v_cvt_pk_bf16_f32 v156, v232, v233
  v_cvt_pk_bf16_f32 v157, v234, v235
  v_cvt_pk_bf16_f32 v158, v236, v237
  v_cvt_pk_bf16_f32 v159, v238, v239
  v_mfma_f32_32x32x16_bf16 v[64:79], a[12:15], v[140:143], v[64:79]
  s_add_u32 s27, s31, 0x6000
  buffer_load_dwordx4 v[160:163], v2, s[4:7], s27 offen offset:0
  v_mfma_f32_32x32x16_bf16 v[64:79], a[16:19], v[144:147], v[64:79]
  s_add_u32 s27, s31, 0x6000
  buffer_load_dwordx4 v[164:167], v2, s[4:7], s27 offen offset:1024
  v_mfma_f32_32x32x16_bf16 v[64:79], a[20:23], v[148:151], v[64:79]
  s_add_u32 s27, s31, 0x6000
  buffer_load_dwordx4 v[168:171], v2, s[4:7], s27 offen offset:2048
  v_mfma_f32_32x32x16_bf16 v[64:79], a[24:27], v[152:155], v[64:79]
  s_add_u32 s27, s31, 0x6000
  buffer_load_dwordx4 v[172:175], v2, s[4:7], s27 offen offset:3072
  v_mfma_f32_32x32x16_bf16 v[64:79], a[28:31], v[156:159], v[64:79]
  s_add_u32 s27, s31, 0x0
  buffer_load_dwordx4 a[224:227], v23, s[4:7], s27 offen offset:0
  v_mfma_f32_32x32x16_bf16 v[80:95], a[32:35], v[128:131], v[80:95]
  s_add_u32 s27, s31, 0x0
  buffer_load_dwordx4 a[228:231], v23, s[4:7], s27 offen offset:1024
  s_add_u32 s27, s31, 0x1000
  buffer_load_dwordx4 a[232:235], v23, s[4:7], s27 offen offset:0
  v_mfma_f32_32x32x16_bf16 v[80:95], a[36:39], v[132:135], v[80:95]
  s_add_u32 s27, s31, 0x1000
  buffer_load_dwordx4 a[236:239], v23, s[4:7], s27 offen offset:1024
  s_add_u32 s27, s31, 0x2000
  buffer_load_dwordx4 a[240:243], v23, s[4:7], s27 offen offset:0
  v_mfma_f32_32x32x16_bf16 v[80:95], a[40:43], v[136:139], v[80:95]
  s_add_u32 s27, s31, 0x2000
  buffer_load_dwordx4 a[244:247], v23, s[4:7], s27 offen offset:1024
  s_add_u32 s27, s31, 0x3000
  buffer_load_dwordx4 a[248:251], v23, s[4:7], s27 offen offset:0
  v_mfma_f32_32x32x16_bf16 v[80:95], a[44:47], v[140:143], v[80:95]
  s_add_u32 s27, s31, 0x3000
  buffer_load_dwordx4 a[252:255], v23, s[4:7], s27 offen offset:1024
  s_add_u32 s27, s31, 0x0
  buffer_load_dwordx4 a[192:195], v2, s[4:7], s27 offen offset:2048
  v_cvt_pk_bf16_f32 v176, v64, v65
  v_cvt_pk_bf16_f32 v177, v66, v67
  v_cvt_pk_bf16_f32 v178, v68, v69
  v_cvt_pk_bf16_f32 v179, v70, v71
  s_add_u32 s25, s24, 0
  buffer_store_dwordx4 v[176:179], v2, s[4:7], s25 offen sc1
  v_mfma_f32_32x32x16_bf16 v[80:95], a[48:51], v[144:147], v[80:95]
  s_add_u32 s27, s31, 0x0
  buffer_load_dwordx4 a[196:199], v2, s[4:7], s27 offen offset:3072
  v_mfma_f32_32x32x16_bf16 v[80:95], a[52:55], v[148:151], v[80:95]
  s_add_u32 s27, s31, 0x1000
  buffer_load_dwordx4 a[200:203], v2, s[4:7], s27 offen offset:2048
  v_cvt_pk_bf16_f32 v180, v72, v73
  v_cvt_pk_bf16_f32 v181, v74, v75
  v_cvt_pk_bf16_f32 v182, v76, v77
  v_cvt_pk_bf16_f32 v183, v78, v79
  s_add_u32 s25, s24, 32768
  buffer_store_dwordx4 v[180:183], v2, s[4:7], s25 offen sc1
  v_mfma_f32_32x32x16_bf16 v[80:95], a[56:59], v[152:155], v[80:95]
  s_add_u32 s27, s31, 0x1000
  buffer_load_dwordx4 a[204:207], v2, s[4:7], s27 offen offset:3072
  v_mfma_f32_32x32x16_bf16 v[80:95], a[60:63], v[156:159], v[80:95]
  s_add_u32 s27, s31, 0x2000
  buffer_load_dwordx4 a[208:211], v2, s[4:7], s27 offen offset:2048
  v_mfma_f32_32x32x16_bf16 v[96:111], a[64:67], v[128:131], v[96:111]
  s_add_u32 s27, s31, 0x2000
  buffer_load_dwordx4 a[212:215], v2, s[4:7], s27 offen offset:3072
  s_add_u32 s27, s31, 0x3000
  buffer_load_dwordx4 a[216:219], v2, s[4:7], s27 offen offset:2048
  v_mfma_f32_32x32x16_bf16 v[96:111], a[68:71], v[132:135], v[96:111]
  s_add_u32 s27, s31, 0x3000
  buffer_load_dwordx4 a[220:223], v2, s[4:7], s27 offen offset:3072
  v_mfma_f32_32x32x16_bf16 v[96:111], a[72:75], v[136:139], v[96:111]
  v_mfma_f32_32x32x16_bf16 v[96:111], a[76:79], v[140:143], v[96:111]
  v_cvt_pk_bf16_f32 v184, v80, v81
  v_cvt_pk_bf16_f32 v185, v82, v83
  v_cvt_pk_bf16_f32 v186, v84, v85
  v_cvt_pk_bf16_f32 v187, v86, v87
  s_add_u32 s25, s24, 65536
  buffer_store_dwordx4 v[184:187], v2, s[4:7], s25 offen sc1
  v_mfma_f32_32x32x16_bf16 v[96:111], a[80:83], v[144:147], v[96:111]
  v_mfma_f32_32x32x16_bf16 v[96:111], a[84:87], v[148:151], v[96:111]
  v_cvt_pk_bf16_f32 v188, v88, v89
  v_cvt_pk_bf16_f32 v189, v90, v91
  v_cvt_pk_bf16_f32 v190, v92, v93
  v_cvt_pk_bf16_f32 v191, v94, v95
  s_add_u32 s25, s24, 98304
  buffer_store_dwordx4 v[188:191], v2, s[4:7], s25 offen sc1
  v_mfma_f32_32x32x16_bf16 v[96:111], a[88:91], v[152:155], v[96:111]
  v_mfma_f32_32x32x16_bf16 v[96:111], a[92:95], v[156:159], v[96:111]
  v_mfma_f32_32x32x16_bf16 v[112:127], a[96:99], v[128:131], v[112:127]
  v_mfma_f32_32x32x16_bf16 v[112:127], a[100:103], v[132:135], v[112:127]
  v_mfma_f32_32x32x16_bf16 v[112:127], a[104:107], v[136:139], v[112:127]
  v_mfma_f32_32x32x16_bf16 v[112:127], a[108:111], v[140:143], v[112:127]
  s_nop 7
  v_cvt_pk_bf16_f32 v192, v96, v97
  v_cvt_pk_bf16_f32 v193, v98, v99
  v_cvt_pk_bf16_f32 v194, v100, v101
  v_cvt_pk_bf16_f32 v195, v102, v103
  s_add_u32 s25, s24, 131072
  buffer_store_dwordx4 v[192:195], v2, s[4:7], s25 offen sc1
  v_mfma_f32_32x32x16_bf16 v[112:127], a[112:115], v[144:147], v[112:127]
  v_mfma_f32_32x32x16_bf16 v[112:127], a[116:119], v[148:151], v[112:127]
  v_cvt_pk_bf16_f32 v196, v104, v105
  v_cvt_pk_bf16_f32 v197, v106, v107
  v_cvt_pk_bf16_f32 v198, v108, v109
  v_cvt_pk_bf16_f32 v199, v110, v111
  s_add_u32 s25, s24, 163840
  buffer_store_dwordx4 v[196:199], v2, s[4:7], s25 offen sc1
  v_mfma_f32_32x32x16_bf16 v[112:127], a[120:123], v[152:155], v[112:127]
  v_mfma_f32_32x32x16_bf16 v[112:127], a[124:127], v[156:159], v[112:127]
  s_nop 0
  s_nop 10
  v_cvt_pk_bf16_f32 v200, v112, v113
  v_cvt_pk_bf16_f32 v201, v114, v115
  v_cvt_pk_bf16_f32 v202, v116, v117
  v_cvt_pk_bf16_f32 v203, v118, v119
  s_add_u32 s25, s24, 196608
  buffer_store_dwordx4 v[200:203], v2, s[4:7], s25 offen sc1
  v_cvt_pk_bf16_f32 v204, v120, v121
  v_cvt_pk_bf16_f32 v205, v122, v123
  v_cvt_pk_bf16_f32 v206, v124, v125
  v_cvt_pk_bf16_f32 v207, v126, v127
  s_add_u32 s25, s24, 229376
  buffer_store_dwordx4 v[204:207], v2, s[4:7], s25 offen sc1
  s_add_u32 s27, s35, 0x4000000
  buffer_load_dwordx4 v[128:131], v2, s[4:7], s27 offen offset:0
  s_add_u32 s27, s35, 0x4000000
  buffer_load_dwordx4 v[132:135], v2, s[4:7], s27 offen offset:1024
  s_add_u32 s27, s35, 0x4000000
  buffer_load_dwordx4 v[136:139], v2, s[4:7], s27 offen offset:2048
  s_add_u32 s27, s35, 0x4000000
  buffer_load_dwordx4 v[140:143], v2, s[4:7], s27 offen offset:3072
  s_add_u32 s27, s35, 0x4001000
  buffer_load_dwordx4 v[144:147], v2, s[4:7], s27 offen offset:0
  s_add_u32 s27, s35, 0x4001000
  buffer_load_dwordx4 v[148:151], v2, s[4:7], s27 offen offset:1024
  s_add_u32 s27, s35, 0x4001000
  buffer_load_dwordx4 v[152:155], v2, s[4:7], s27 offen offset:2048
  s_add_u32 s27, s35, 0x4001000
  buffer_load_dwordx4 v[156:159], v2, s[4:7], s27 offen offset:3072
  s_lshl_b32 s25, s28, 9
  s_lshl_b32 s26, s21, 7
  s_add_u32 s25, s25, s26
  s_lshl_b32 s26, s20, 2
  s_add_u32 s25, s25, s26
  s_add_u32 s25, s25, 0x910c000
  v_mov_b32 v11, 1
  s_waitcnt vmcnt(8)
  buffer_store_dword v11, v15, s[4:7], s25 offen sc1
  s_add_u32 s28, s28, 7
  s_add_u32 s30, s30, 1
  s_branch L_f3
L_f3_last:
  v_mfma_f32_32x32x16_bf16 v[64:79], a[0:3], v[128:131], v[64:79]
  v_mfma_f32_32x32x16_bf16 v[64:79], a[4:7], v[132:135], v[64:79]
  v_mfma_f32_32x32x16_bf16 v[64:79], a[8:11], v[136:139], v[64:79]
  v_cvt_pk_bf16_f32 v152, v224, v225
  v_cvt_pk_bf16_f32 v153, v226, v227
  v_cvt_pk_bf16_f32 v154, v228, v229
  v_cvt_pk_bf16_f32 v155, v230, v231
  v_cvt_pk_bf16_f32 v156, v232, v233
  v_cvt_pk_bf16_f32 v157, v234, v235
  v_cvt_pk_bf16_f32 v158, v236, v237
  v_cvt_pk_bf16_f32 v159, v238, v239
  v_mfma_f32_32x32x16_bf16 v[64:79], a[12:15], v[140:143], v[64:79]
  v_mfma_f32_32x32x16_bf16 v[64:79], a[16:19], v[144:147], v[64:79]
  v_mfma_f32_32x32x16_bf16 v[64:79], a[20:23], v[148:151], v[64:79]
  v_mfma_f32_32x32x16_bf16 v[64:79], a[24:27], v[152:155], v[64:79]
  v_mfma_f32_32x32x16_bf16 v[64:79], a[28:31], v[156:159], v[64:79]
  v_mfma_f32_32x32x16_bf16 v[80:95], a[32:35], v[128:131], v[80:95]
  v_mfma_f32_32x32x16_bf16 v[80:95], a[36:39], v[132:135], v[80:95]
  v_mfma_f32_32x32x16_bf16 v[80:95], a[40:43], v[136:139], v[80:95]
  v_mfma_f32_32x32x16_bf16 v[80:95], a[44:47], v[140:143], v[80:95]
  s_nop 7
  v_cvt_pk_bf16_f32 v176, v64, v65
  v_cvt_pk_bf16_f32 v177, v66, v67
  v_cvt_pk_bf16_f32 v178, v68, v69
  v_cvt_pk_bf16_f32 v179, v70, v71
  s_add_u32 s25, s24, 0
  buffer_store_dwordx4 v[176:179], v2, s[4:7], s25 offen sc1
  v_mfma_f32_32x32x16_bf16 v[80:95], a[48:51], v[144:147], v[80:95]
  v_mfma_f32_32x32x16_bf16 v[80:95], a[52:55], v[148:151], v[80:95]
  v_cvt_pk_bf16_f32 v180, v72, v73
  v_cvt_pk_bf16_f32 v181, v74, v75
  v_cvt_pk_bf16_f32 v182, v76, v77
  v_cvt_pk_bf16_f32 v183, v78, v79
  s_add_u32 s25, s24, 32768
  buffer_store_dwordx4 v[180:183], v2, s[4:7], s25 offen sc1
  v_mfma_f32_32x32x16_bf16 v[80:95], a[56:59], v[152:155], v[80:95]
  v_mfma_f32_32x32x16_bf16 v[80:95], a[60:63], v[156:159], v[80:95]
  v_mfma_f32_32x32x16_bf16 v[96:111], a[64:67], v[128:131], v[96:111]
  v_mfma_f32_32x32x16_bf16 v[96:111], a[68:71], v[132:135], v[96:111]
  v_mfma_f32_32x32x16_bf16 v[96:111], a[72:75], v[136:139], v[96:111]
  v_mfma_f32_32x32x16_bf16 v[96:111], a[76:79], v[140:143], v[96:111]
  s_nop 0
  s_nop 6
  v_cvt_pk_bf16_f32 v184, v80, v81
  v_cvt_pk_bf16_f32 v185, v82, v83
  v_cvt_pk_bf16_f32 v186, v84, v85
  v_cvt_pk_bf16_f32 v187, v86, v87
  s_add_u32 s25, s24, 65536
  buffer_store_dwordx4 v[184:187], v2, s[4:7], s25 offen sc1
  v_mfma_f32_32x32x16_bf16 v[96:111], a[80:83], v[144:147], v[96:111]
  v_mfma_f32_32x32x16_bf16 v[96:111], a[84:87], v[148:151], v[96:111]
  v_cvt_pk_bf16_f32 v188, v88, v89
  v_cvt_pk_bf16_f32 v189, v90, v91
  v_cvt_pk_bf16_f32 v190, v92, v93
  v_cvt_pk_bf16_f32 v191, v94, v95
  s_add_u32 s25, s24, 98304
  buffer_store_dwordx4 v[188:191], v2, s[4:7], s25 offen sc1
  v_mfma_f32_32x32x16_bf16 v[96:111], a[88:91], v[152:155], v[96:111]
  v_mfma_f32_32x32x16_bf16 v[96:111], a[92:95], v[156:159], v[96:111]
  v_mfma_f32_32x32x16_bf16 v[112:127], a[96:99], v[128:131], v[112:127]
  v_mfma_f32_32x32x16_bf16 v[112:127], a[100:103], v[132:135], v[112:127]
  v_mfma_f32_32x32x16_bf16 v[112:127], a[104:107], v[136:139], v[112:127]
  v_mfma_f32_32x32x16_bf16 v[112:127], a[108:111], v[140:143], v[112:127]
  s_nop 0
  s_nop 6
  v_cvt_pk_bf16_f32 v192, v96, v97
  v_cvt_pk_bf16_f32 v193, v98, v99
  v_cvt_pk_bf16_f32 v194, v100, v101
  v_cvt_pk_bf16_f32 v195, v102, v103
  s_add_u32 s25, s24, 131072
  buffer_store_dwordx4 v[192:195], v2, s[4:7], s25 offen sc1
  v_mfma_f32_32x32x16_bf16 v[112:127], a[112:115], v[144:147], v[112:127]
  v_mfma_f32_32x32x16_bf16 v[112:127], a[116:119], v[148:151], v[112:127]
  v_cvt_pk_bf16_f32 v196, v104, v105
  v_cvt_pk_bf16_f32 v197, v106, v107
  v_cvt_pk_bf16_f32 v198, v108, v109
  v_cvt_pk_bf16_f32 v199, v110, v111
  s_add_u32 s25, s24, 163840
  buffer_store_dwordx4 v[196:199], v2, s[4:7], s25 offen sc1
  v_mfma_f32_32x32x16_bf16 v[112:127], a[120:123], v[152:155], v[112:127]
  v_mfma_f32_32x32x16_bf16 v[112:127], a[124:127], v[156:159], v[112:127]
  s_nop 0
  s_nop 10
  v_cvt_pk_bf16_f32 v200, v112, v113
  v_cvt_pk_bf16_f32 v201, v114, v115
  v_cvt_pk_bf16_f32 v202, v116, v117
  v_cvt_pk_bf16_f32 v203, v118, v119
  s_add_u32 s25, s24, 196608
  buffer_store_dwordx4 v[200:203], v2, s[4:7], s25 offen sc1
  v_cvt_pk_bf16_f32 v204, v120, v121
  v_cvt_pk_bf16_f32 v205, v122, v123
  v_cvt_pk_bf16_f32 v206, v124, v125
  v_cvt_pk_bf16_f32 v207, v126, v127
  s_add_u32 s25, s24, 229376
  buffer_store_dwordx4 v[204:207], v2, s[4:7], s25 offen sc1
  s_waitcnt vmcnt(0)
  s_lshl_b32 s24, s28, 20
  s_lshl_b32 s25, s20, 15
  s_add_u32 s24, s24, s25
  s_add_u32 s24, s24, 0x5000000
L_f3l_rd:
  s_add_u32 s25, s24, 0
  buffer_load_dwordx4 v[40:43], v21, s[4:7], s25 offen sc1
  s_add_u32 s25, s24, 4096
  buffer_load_dwordx4 v[44:47], v21, s[4:7], s25 offen sc1
  s_add_u32 s25, s24, 8192
  buffer_load_dwordx4 v[48:51], v21, s[4:7], s25 offen sc1
  s_add_u32 s25, s24, 12288
  buffer_load_dwordx4 v[52:55], v21, s[4:7], s25 offen sc1
  s_add_u32 s25, s24, 16384
  buffer_load_dwordx4 v[56:59], v21, s[4:7], s25 offen sc1
  s_add_u32 s25, s24, 20480
  buffer_load_dwordx4 v[60:63], v21, s[4:7], s25 offen sc1
  s_add_u32 s25, s24, 24576
  buffer_load_dwordx4 v[192:195], v21, s[4:7], s25 offen sc1
  s_add_u32 s25, s24, 28672
  buffer_load_dwordx4 v[196:199], v21, s[4:7], s25 offen sc1
  s_waitcnt vmcnt(7)
  v_mfma_f32_16x16x32_bf16 v[200:203], v[252:255], v[40:43], 0
  v_max_u32 v11, v40, v41
  v_max3_u32 v11, v11, v42, v43
  s_waitcnt vmcnt(6)
  v_mfma_f32_16x16x32_bf16 v[200:203], v[252:255], v[44:47], v[200:203]
  v_max3_u32 v11, v11, v44, v45
  v_max3_u32 v11, v11, v46, v47
  s_waitcnt vmcnt(5)
  v_mfma_f32_16x16x32_bf16 v[200:203], v[252:255], v[48:51], v[200:203]
  v_max3_u32 v11, v11, v48, v49
  v_max3_u32 v11, v11, v50, v51
  s_waitcnt vmcnt(4)
  v_mfma_f32_16x16x32_bf16 v[200:203], v[252:255], v[52:55], v[200:203]
  v_max3_u32 v11, v11, v52, v53
  v_max3_u32 v11, v11, v54, v55
  s_waitcnt vmcnt(3)
  v_mfma_f32_16x16x32_bf16 v[200:203], v[252:255], v[56:59], v[200:203]
  v_max3_u32 v11, v11, v56, v57
  v_max3_u32 v11, v11, v58, v59
  s_waitcnt vmcnt(2)
  v_mfma_f32_16x16x32_bf16 v[200:203], v[252:255], v[60:63], v[200:203]
  v_max3_u32 v11, v11, v60, v61
  v_max3_u32 v11, v11, v62, v63
  s_waitcnt vmcnt(1)
  v_mfma_f32_16x16x32_bf16 v[200:203], v[252:255], v[192:195], v[200:203]
  v_max3_u32 v11, v11, v192, v193
  v_max3_u32 v11, v11, v194, v195
  s_waitcnt vmcnt(0)
  v_mfma_f32_16x16x32_bf16 v[200:203], v[252:255], v[196:199], v[200:203]
  v_max3_u32 v11, v11, v196, v197
  v_max3_u32 v11, v11, v198, v199
  v_cmp_eq_u32_e64 vcc, -1, v11
  s_cbranch_vccz L_f3l_rd_ok
  s_add_u32 s23, s23, 1
  s_cmp_lt_u32 s23, 0x40000
  s_cbranch_scc1 L_f3l_rd
  s_branch L_exit
L_f3l_rd_ok:
  s_lshl_b32 s24, s28, 15
  s_nop 2
  v_cvt_pk_bf16_f32 v200, v200, v201
  v_cvt_pk_bf16_f32 v201, v202, v203
  buffer_store_dwordx2 v[200:201], v22, s[8:11], s24 offen
  s_branch L_exit
L_exit:
  s_endpgm
.section .rodata,"a"
.p2align 6
.amdhsa_kernel gated_mix__memory_aug_recurrent_mem_tr__geglu_ffn__prompt_kernel
  .amdhsa_next_free_vgpr 512
  .amdhsa_next_free_sgpr 102
  .amdhsa_accum_offset 256
  .amdhsa_group_segment_fixed_size 0
  .amdhsa_kernarg_size 120
  .amdhsa_user_sgpr_count 2
  .amdhsa_user_sgpr_kernarg_segment_ptr 1
  .amdhsa_system_sgpr_workgroup_id_x 1
  .amdhsa_float_denorm_mode_32 3
.end_amdhsa_kernel
```
